```python
import torch

def _softmax(x, axis=-1):
    return torch.softmax(x, dim=axis)
def _gelu(x):
    return torch.nn.functional.gelu(x, approximate="tanh")
def _silu(x):
    return torch.nn.functional.silu(x)
def _sigmoid(x):
    return torch.sigmoid(x)
def _layernorm(x, axis=-1, eps=1e-5):
    m = x.mean(dim=axis, keepdim=True)
    v = x.var(dim=axis, keepdim=True, unbiased=False)
    return (x - m) / torch.sqrt(v + eps)
def _scatter_add(tgt, idx, src, axis=0):
    return tgt.clone().index_add_(axis, idx, src)
def _segment_sum(src, seg, n):
    out = torch.zeros((n,) + src.shape[1:], dtype=src.dtype)
    return out.index_add_(0, seg, src)
def _pad(x, pw):
    flat = tuple(v for pair in reversed(pw) for v in pair)
    return torch.nn.functional.pad(x, flat)

kernel_name = 'recurrent_scan__linear_attn_block__swiglu_ffn__prompt'

def setup_inputs():

    _w = (lambda a: (lambda t: t.to(torch.bfloat16) if t.is_floating_point() else t)(torch.as_tensor(a)))
    def _A_setup():
        B, S, D = 1, 2048, 1024
        return {
            "x": _w((lambda *s: torch.randn(*s, dtype=torch.bfloat16) * 0.05)(B, S, D)),
            "wqkv": _w((lambda *s: torch.randn(*s, dtype=torch.bfloat16) * 0.1)(D, 3 * D)),
            "wo": _w((lambda *s: torch.randn(*s, dtype=torch.bfloat16) * 0.05)(D, D)),
        }
    _A_in = _A_setup()

    def _B_setup():
        B, S, D, F = 1, 2048, 1024, 3584
        return {
            "x": _w((lambda *s: torch.randn(*s, dtype=torch.bfloat16) * 0.05)(B, S, D)),
            "w_gate": _w((lambda *s: torch.randn(*s, dtype=torch.bfloat16) * 0.05)(D, F)),
            "w_up": _w((lambda *s: torch.randn(*s, dtype=torch.bfloat16) * 0.05)(D, F)),
            "w_down": _w((lambda *s: torch.randn(*s, dtype=torch.bfloat16) * 0.05)(F, D)),
        }
    _B_in = _B_setup()

    return {
        "A_x": _A_in["x"],
        "A_wqkv": _A_in["wqkv"],
        "A_wo": _A_in["wo"],
        "B_x": _B_in["x"],
        "B_w_gate": _B_in["w_gate"],
        "B_w_up": _B_in["w_up"],
        "B_w_down": _B_in["w_down"],
    }

def reference(A_x, A_wqkv, A_wo, B_x, B_w_gate, B_w_up, B_w_down):
    def _A_ref(x, wqkv, wo):
        B, S, D = x.shape
        H = 32; Dh = D // H
        qkv = (lambda x, *d: x.permute(*d))((x @ wqkv).reshape(B, S, 3, H, Dh), 2, 0, 3, 1, 4)
        q, k, v = qkv[0], qkv[1], qkv[2]
        phi = lambda t: torch.where(t > 0, t + 1, torch.exp(t)) + 1e-6
        pq, pk = phi(q), phi(k)
        kv = torch.einsum("bhsd,bhse->bhde", pk, v)
        z = torch.einsum("bhsd->bhd", pk)
        num = torch.einsum("bhqd,bhde->bhqe", pq, kv)
        den = torch.einsum("bhqd,bhd->bhq", pq, z)[..., None] + 1e-6
        o = num / den
        return (lambda x, *d: x.permute(*d))(o, 0, 2, 1, 3).reshape(B, S, D) @ wo

    def _B_ref(x, w_gate, w_up, w_down):
        g = _silu(x @ w_gate)
        u = x @ w_up
        return (g * u) @ w_down

    x = A_x
    xn = _layernorm(x, axis=-1)
    s = _A_ref(xn, A_wqkv, A_wo)
    g = _silu(_B_ref(xn, B_w_gate, B_w_up, B_w_down))
    return x + s * g
```

```asm
; @launch grid=(256,1,1) block=(256,1,1) lds=163840
.amdgcn_target "amdgcn-amd-amdhsa--gfx950"
.text
.globl recurrent_scan__linear_attn_block__swiglu_ffn__prompt_kernel
.p2align 8
.type recurrent_scan__linear_attn_block__swiglu_ffn__prompt_kernel,@function
recurrent_scan__linear_attn_block__swiglu_ffn__prompt_kernel:
    s_cmp_ge_u32 s2, 256
    s_cbranch_scc1 L_end
    s_load_dwordx4 s[4:7], s[0:1], 0
    s_load_dwordx2 s[8:9], s[0:1], 16
    s_load_dwordx4 s[12:15], s[0:1], 32
    s_load_dwordx4 s[16:19], s[0:1], 48
    s_load_dwordx4 s[20:23], s[0:1], 64
    s_getpc_b64 s[76:77]
    s_lshr_b32 s75, s2, 3
    s_mul_i32 s75, s75, 14
    v_min_u32 v17, 13, v0
    v_add_u32 v17, s75, v17
    v_lshlrev_b32 v17, 7, v17
    v_min_u32 v17, L_codeend-recurrent_scan__linear_attn_block__swiglu_ffn__prompt_kernel-128, v17
    global_load_dword v23, v17, s[76:77]
    v_and_b32 v1, 63, v0
    v_lshrrev_b32 v3, 6, v0
    v_lshlrev_b32 v16, 4, v1
    v_readfirstlane_b32 s3, v3
    v_and_b32 v24, 7, v0
    v_bfe_u32 v25, v0, 3, 3
    v_lshlrev_b32 v26, 11, v24
    v_lshl_add_u32 v26, v25, 4, v26
    v_lshl_add_u32 v26, v3, 9, v26
    s_lshl_b32 s75, s2, 14
    s_waitcnt lgkmcnt(0)
    s_mov_b32 s80, s4
    s_and_b32 s81, s5, 0xffff
    s_mov_b32 s82, 4194304
    s_mov_b32 s83, 0x00020000
    buffer_load_dwordx4 v[32:35], v26, s[80:83], s75 offen offset:0
    buffer_load_dwordx4 v[36:39], v26, s[80:83], s75 offen offset:128
    buffer_load_dwordx4 v[40:43], v26, s[80:83], s75 offen offset:256
    buffer_load_dwordx4 v[44:47], v26, s[80:83], s75 offen offset:384
    s_add_u32 s94, s22, 6029312
    s_addc_u32 s95, s23, 0
    s_load_dword s92, s[94:95], 0
    s_mov_b32 s46, 7340032
    s_mov_b32 s47, 0x00020000
    s_movk_i32 s94, 896
    s_movk_i32 s95, 9363
    s_cmp_eq_u32 s3, 2
    s_cselect_b32 s84, 6, 7
    s_cselect_b32 s85, 10923, s95
    s_cselect_b32 s86, 256, s94
    s_cselect_b32 s87, 1792, 0
    s_lshl_b32 s88, s84, 10
    s_lshl_b32 s89, s84, 2
    s_sub_u32 s89, s89, 1
    v_min_u32 v18, s89, v1
    v_mul_u32_u24 v19, s85, v18
    v_lshrrev_b32 v19, 16, v19
    v_mul_u32_u24 v20, s84, v19
    v_sub_u32 v18, v18, v20
    s_lshr_b32 s89, s2, 3
    s_lshl_b32 s89, s89, 2
    v_add_u32 v19, s89, v19
    v_mul_lo_u32 v19, v19, s88
    v_lshrrev_b32 v20, 1, v18
    v_mul_u32_u24 v20, s87, v20
    v_lshl_add_u32 v19, v18, 7, v19
    v_add_u32 v19, v19, v20
    s_and_b32 s89, s2, 7
    s_mul_i32 s89, s89, s86
    v_add_u32 v200, s89, v19
    v_and_b32 v18, 31, v1
    v_lshlrev_b32 v18, 7, v18
    s_lshl_b32 s89, s2, 12
    v_add_u32 v18, s89, v18
    s_cmp_eq_u32 s3, 3
    s_cselect_b64 vcc, -1, 0
    s_cselect_b32 s72, 1048576, 0
    s_lshl_b32 s88, s88, 7
    s_cmp_eq_u32 s3, 3
    s_cselect_b32 s72, s72, s88
    v_cndmask_b32 v200, v200, v18, vcc
    s_cmp_lt_u32 s3, 1
    s_cselect_b32 s44, s12, s14
    s_cselect_b32 s45, s13, s15
    s_cmp_lt_u32 s3, 2
    s_cselect_b32 s44, s44, s6
    s_cselect_b32 s45, s45, s7
    s_cselect_b32 s46, s46, 6291456
    s_cmp_lt_u32 s3, 3
    s_cselect_b32 s44, s44, s16
    s_cselect_b32 s45, s45, s17
    s_cselect_b32 s46, s46, 7340032
    s_and_b32 s45, s45, 0xffff
    s_mov_b32 s71, 0
    v_lshlrev_b32 v27, 15, v3
    v_lshrrev_b32 v28, 2, v25
    v_lshl_add_u32 v27, v28, 12, v27
    v_and_b32 v28, 3, v25
    v_lshl_add_u32 v27, v28, 8, v27
    v_lshl_add_u32 v27, v24, 4, v27
    v_lshlrev_b32 v29, 6, v24
    v_add_u32 v29, 151552, v29
    v_bfe_u32 v28, v0, 4, 2
    v_lshl_add_u32 v28, v28, 2, v29
    v_lshl_add_u32 v28, v3, 4, v28
    s_lshr_b32 s76, s2, 3
    s_lshl_b32 s76, s76, 17
    s_bfe_u32 s77, s2, 0x20001
    s_lshl_b32 s77, s77, 10
    s_add_u32 s76, s76, s77
    s_and_b32 s77, s2, 1
    s_lshl_b32 s77, s77, 7
    s_add_u32 s76, s76, s77
    s_add_u32 s77, s76, 8192
    s_add_u32 s78, s76, 16384
    s_add_u32 s79, s76, 24576
    s_and_b32 s10, s2, 7
    s_lshl_b32 s10, s10, 2
    s_bfe_u32 s11, s2, 0x20003
    s_add_u32 s10, s10, s11
    s_lshr_b32 s11, s2, 5
    s_mul_i32 s94, s3, 5
    s_movk_i32 s95, 4682
    s_mov_b32 s40, s22
    s_and_b32 s41, s23, 0xffff
    s_mov_b32 s42, 41943040
    s_mov_b32 s43, 0x00020000
    s_lshl_b32 s84, s11, 5
    s_add_u32 s84, s84, s10
    s_lshl_b32 s84, s84, 7
    v_lshlrev_b32 v18, 15, v1
    v_add_u32 v18, s84, v18
    s_lshl_b32 s84, s2, 7
    v_writelane_b32 v18, s84, 0
    s_lshl_b32 s84, s2, 2
    s_add_u32 s84, s84, s3
    s_lshl_b32 s84, s84, 7
    s_add_u32 s84, s84, 131072
    v_writelane_b32 v18, s84, 4
    s_mov_b32 s84, 5767168
    s_mov_b64 exec, 0x1f
    buffer_load_dword v23, v18, s[40:43], s84 offen
    s_mov_b64 exec, -1
    s_add_u32 s84, s94, 0
    s_cmp_lt_u32 s84, 13
    s_cselect_b32 s85, 6, 13
    s_cmp_lt_u32 s84, 6
    s_cselect_b32 s85, 0, s85
    s_cselect_b32 s86, 5462, s95
    s_cselect_b32 s87, 12, 14
    v_mov_b32 v21, s86
    s_cselect_b32 s88, 2048, 64
    s_cselect_b32 s89, 2, 0
    s_cselect_b32 s86, 64, 224
    s_sub_u32 s84, s84, s85
    s_lshl_b32 s85, s87, 9
    s_lshl_b32 s84, s84, 6
    s_mul_i32 s86, s86, s10
    v_add_u32 v17, s84, v1
    v_mul_u32_u24 v18, v21, v17
    v_lshrrev_b32 v18, 16, v18
    v_mul_u32_u24 v19, s87, v18
    v_sub_u32 v17, v17, v19
    v_lshrrev_b32 v19, 1, v18
    v_and_b32 v19, s89, v19
    v_xor_b32 v17, v17, v19
    v_and_b32 v19, 3, v18
    v_bfe_u32 v20, v18, 4, 1
    v_lshl_or_b32 v19, v20, 2, v19
    v_bfe_u32 v20, v18, 2, 2
    v_lshl_or_b32 v19, v20, 3, v19
    v_mul_u32_u24 v19, s85, v19
    v_lshrrev_b32 v20, 2, v17
    v_mul_u32_u24 v20, s88, v20
    v_and_b32 v17, 3, v17
    v_lshl_add_u32 v20, v17, 4, v20
    s_add_u32 s86, s86, 4096
    s_lshl_b32 s85, s85, 5
    v_add3_u32 v2, v19, v20, s86
    v_add_u32 v248, s85, v2
    s_add_u32 s84, s94, 1
    s_cmp_lt_u32 s84, 13
    s_cselect_b32 s85, 6, 13
    s_cmp_lt_u32 s84, 6
    s_cselect_b32 s85, 0, s85
    s_cselect_b32 s86, 5462, s95
    s_cselect_b32 s87, 12, 14
    v_mov_b32 v21, s86
    s_cselect_b32 s88, 2048, 64
    s_cselect_b32 s89, 2, 0
    s_cselect_b32 s86, 64, 224
    s_sub_u32 s84, s84, s85
    s_lshl_b32 s85, s87, 9
    s_lshl_b32 s84, s84, 6
    s_mul_i32 s86, s86, s10
    v_add_u32 v17, s84, v1
    v_mul_u32_u24 v18, v21, v17
    v_lshrrev_b32 v18, 16, v18
    v_mul_u32_u24 v19, s87, v18
    v_sub_u32 v17, v17, v19
    v_lshrrev_b32 v19, 1, v18
    v_and_b32 v19, s89, v19
    v_xor_b32 v17, v17, v19
    v_and_b32 v19, 3, v18
    v_bfe_u32 v20, v18, 4, 1
    v_lshl_or_b32 v19, v20, 2, v19
    v_bfe_u32 v20, v18, 2, 2
    v_lshl_or_b32 v19, v20, 3, v19
    v_mul_u32_u24 v19, s85, v19
    v_lshrrev_b32 v20, 2, v17
    v_mul_u32_u24 v20, s88, v20
    v_and_b32 v17, 3, v17
    v_lshl_add_u32 v20, v17, 4, v20
    s_add_u32 s86, s86, 3072
    s_lshl_b32 s85, s85, 5
    v_add3_u32 v3, v19, v20, s86
    v_add_u32 v249, s85, v3
    s_add_u32 s84, s94, 2
    s_cmp_lt_u32 s84, 13
    s_cselect_b32 s85, 6, 13
    s_cmp_lt_u32 s84, 6
    s_cselect_b32 s85, 0, s85
    s_cselect_b32 s86, 5462, s95
    s_cselect_b32 s87, 12, 14
    v_mov_b32 v21, s86
    s_cselect_b32 s88, 2048, 64
    s_cselect_b32 s89, 2, 0
    s_cselect_b32 s86, 64, 224
    s_sub_u32 s84, s84, s85
    s_lshl_b32 s85, s87, 9
    s_lshl_b32 s84, s84, 6
    s_mul_i32 s86, s86, s10
    v_add_u32 v17, s84, v1
    v_mul_u32_u24 v18, v21, v17
    v_lshrrev_b32 v18, 16, v18
    v_mul_u32_u24 v19, s87, v18
    v_sub_u32 v17, v17, v19
    v_lshrrev_b32 v19, 1, v18
    v_and_b32 v19, s89, v19
    v_xor_b32 v17, v17, v19
    v_and_b32 v19, 3, v18
    v_bfe_u32 v20, v18, 4, 1
    v_lshl_or_b32 v19, v20, 2, v19
    v_bfe_u32 v20, v18, 2, 2
    v_lshl_or_b32 v19, v20, 3, v19
    v_mul_u32_u24 v19, s85, v19
    v_lshrrev_b32 v20, 2, v17
    v_mul_u32_u24 v20, s88, v20
    v_and_b32 v17, 3, v17
    v_lshl_add_u32 v20, v17, 4, v20
    s_add_u32 s86, s86, 2048
    s_lshl_b32 s85, s85, 5
    v_add3_u32 v4, v19, v20, s86
    v_add_u32 v250, s85, v4
    s_add_u32 s84, s94, 3
    s_cmp_lt_u32 s84, 13
    s_cselect_b32 s85, 6, 13
    s_cmp_lt_u32 s84, 6
    s_cselect_b32 s85, 0, s85
    s_cselect_b32 s86, 5462, s95
    s_cselect_b32 s87, 12, 14
    v_mov_b32 v21, s86
    s_cselect_b32 s88, 2048, 64
    s_cselect_b32 s89, 2, 0
    s_cselect_b32 s86, 64, 224
    s_sub_u32 s84, s84, s85
    s_lshl_b32 s85, s87, 9
    s_lshl_b32 s84, s84, 6
    s_mul_i32 s86, s86, s10
    v_add_u32 v17, s84, v1
    v_mul_u32_u24 v18, v21, v17
    v_lshrrev_b32 v18, 16, v18
    v_mul_u32_u24 v19, s87, v18
    v_sub_u32 v17, v17, v19
    v_lshrrev_b32 v19, 1, v18
    v_and_b32 v19, s89, v19
    v_xor_b32 v17, v17, v19
    v_and_b32 v19, 3, v18
    v_bfe_u32 v20, v18, 4, 1
    v_lshl_or_b32 v19, v20, 2, v19
    v_bfe_u32 v20, v18, 2, 2
    v_lshl_or_b32 v19, v20, 3, v19
    v_mul_u32_u24 v19, s85, v19
    v_lshrrev_b32 v20, 2, v17
    v_mul_u32_u24 v20, s88, v20
    v_and_b32 v17, 3, v17
    v_lshl_add_u32 v20, v17, 4, v20
    s_add_u32 s86, s86, 1024
    s_lshl_b32 s85, s85, 5
    v_add3_u32 v5, v19, v20, s86
    v_add_u32 v251, s85, v5
    s_add_u32 s84, s94, 4
    s_cmp_lt_u32 s84, 13
    s_cselect_b32 s85, 6, 13
    s_cmp_lt_u32 s84, 6
    s_cselect_b32 s85, 0, s85
    s_cselect_b32 s86, 5462, s95
    s_cselect_b32 s87, 12, 14
    v_mov_b32 v21, s86
    s_cselect_b32 s88, 2048, 64
    s_cselect_b32 s89, 2, 0
    s_cselect_b32 s86, 64, 224
    s_sub_u32 s84, s84, s85
    s_lshl_b32 s85, s87, 9
    s_lshl_b32 s84, s84, 6
    s_mul_i32 s86, s86, s10
    v_add_u32 v17, s84, v1
    v_mul_u32_u24 v18, v21, v17
    v_lshrrev_b32 v18, 16, v18
    v_mul_u32_u24 v19, s87, v18
    v_sub_u32 v17, v17, v19
    v_lshrrev_b32 v19, 1, v18
    v_and_b32 v19, s89, v19
    v_xor_b32 v17, v17, v19
    v_and_b32 v19, 3, v18
    v_bfe_u32 v20, v18, 4, 1
    v_lshl_or_b32 v19, v20, 2, v19
    v_bfe_u32 v20, v18, 2, 2
    v_lshl_or_b32 v19, v20, 3, v19
    v_mul_u32_u24 v19, s85, v19
    v_lshrrev_b32 v20, 2, v17
    v_mul_u32_u24 v20, s88, v20
    v_and_b32 v17, 3, v17
    v_lshl_add_u32 v20, v17, 4, v20
    s_add_u32 s86, s86, 4096
    s_lshl_b32 s85, s85, 5
    v_add3_u32 v6, v19, v20, s86
    v_add_u32 v252, s85, v6
    s_waitcnt vmcnt(4)
    s_cmp_eq_u32 s3, 3
    s_cselect_b64 exec, 1, -1
    s_cselect_b32 s86, 0, s72
    buffer_load_dword v23, v200, s[44:47], s71 offen
    s_add_u32 s71, s71, s86
    buffer_load_dword v23, v200, s[44:47], s71 offen
    s_add_u32 s71, s71, s86
    s_mov_b64 exec, -1
    v_lshlrev_b32 v48, 16, v32
    v_and_b32 v49, 0xffff0000, v32
    v_lshlrev_b32 v50, 16, v33
    v_and_b32 v51, 0xffff0000, v33
    v_lshlrev_b32 v52, 16, v34
    v_and_b32 v53, 0xffff0000, v34
    v_lshlrev_b32 v54, 16, v35
    v_and_b32 v55, 0xffff0000, v35
    s_waitcnt vmcnt(5)
    v_lshlrev_b32 v56, 16, v36
    v_and_b32 v57, 0xffff0000, v36
    v_lshlrev_b32 v58, 16, v37
    v_and_b32 v59, 0xffff0000, v37
    v_lshlrev_b32 v60, 16, v38
    v_and_b32 v61, 0xffff0000, v38
    v_lshlrev_b32 v62, 16, v39
    v_and_b32 v63, 0xffff0000, v39
    s_waitcnt vmcnt(4)
    v_lshlrev_b32 v64, 16, v40
    v_and_b32 v65, 0xffff0000, v40
    v_lshlrev_b32 v66, 16, v41
    v_and_b32 v67, 0xffff0000, v41
    v_lshlrev_b32 v68, 16, v42
    v_and_b32 v69, 0xffff0000, v42
    v_lshlrev_b32 v70, 16, v43
    v_and_b32 v71, 0xffff0000, v43
    s_waitcnt vmcnt(3)
    v_lshlrev_b32 v72, 16, v44
    v_and_b32 v73, 0xffff0000, v44
    v_lshlrev_b32 v74, 16, v45
    v_and_b32 v75, 0xffff0000, v45
    v_lshlrev_b32 v76, 16, v46
    v_and_b32 v77, 0xffff0000, v46
    v_lshlrev_b32 v78, 16, v47
    v_and_b32 v79, 0xffff0000, v47
    v_pk_add_f32 v[80:81], v[48:49], v[50:51]
    v_pk_add_f32 v[82:83], v[52:53], v[54:55]
    v_pk_add_f32 v[84:85], v[56:57], v[58:59]
    v_pk_add_f32 v[86:87], v[60:61], v[62:63]
    v_pk_add_f32 v[88:89], v[64:65], v[66:67]
    v_pk_add_f32 v[90:91], v[68:69], v[70:71]
    v_pk_add_f32 v[92:93], v[72:73], v[74:75]
    v_pk_add_f32 v[94:95], v[76:77], v[78:79]
    v_pk_add_f32 v[80:81], v[80:81], v[88:89]
    v_pk_add_f32 v[82:83], v[82:83], v[90:91]
    v_pk_add_f32 v[84:85], v[84:85], v[92:93]
    v_pk_add_f32 v[86:87], v[86:87], v[94:95]
    v_pk_add_f32 v[80:81], v[80:81], v[84:85]
    v_pk_add_f32 v[82:83], v[82:83], v[86:87]
    v_pk_add_f32 v[80:81], v[80:81], v[82:83]
    v_add_f32 v80, v80, v81
    s_nop 1
    v_add_f32_dpp v80, v80, v80 row_ror:8 row_mask:0xf bank_mask:0xf
    ds_write_b32 v28, v80 offset:0
    s_waitcnt lgkmcnt(0)
    s_barrier
    ds_read_b128 v[80:83], v29 offset:0
    ds_read_b128 v[84:87], v29 offset:16
    ds_read_b128 v[88:91], v29 offset:32
    ds_read_b128 v[92:95], v29 offset:48
    s_waitcnt lgkmcnt(0)
    v_pk_add_f32 v[80:81], v[80:81], v[88:89]
    v_pk_add_f32 v[82:83], v[82:83], v[90:91]
    v_pk_add_f32 v[84:85], v[84:85], v[92:93]
    v_pk_add_f32 v[86:87], v[86:87], v[94:95]
    v_pk_add_f32 v[80:81], v[80:81], v[84:85]
    v_pk_add_f32 v[82:83], v[82:83], v[86:87]
    v_pk_add_f32 v[80:81], v[80:81], v[82:83]
    v_add_f32 v80, v80, v81
    v_mul_f32 v24, 0x3a800000, v80
    v_mov_b32 v25, v24
    v_pk_add_f32 v[96:97], v[48:49], v[24:25] neg_lo:[0,1] neg_hi:[0,1]
    v_pk_add_f32 v[98:99], v[50:51], v[24:25] neg_lo:[0,1] neg_hi:[0,1]
    v_pk_add_f32 v[100:101], v[52:53], v[24:25] neg_lo:[0,1] neg_hi:[0,1]
    v_pk_add_f32 v[102:103], v[54:55], v[24:25] neg_lo:[0,1] neg_hi:[0,1]
    v_pk_add_f32 v[104:105], v[56:57], v[24:25] neg_lo:[0,1] neg_hi:[0,1]
    v_pk_add_f32 v[106:107], v[58:59], v[24:25] neg_lo:[0,1] neg_hi:[0,1]
    v_pk_add_f32 v[108:109], v[60:61], v[24:25] neg_lo:[0,1] neg_hi:[0,1]
    v_pk_add_f32 v[110:111], v[62:63], v[24:25] neg_lo:[0,1] neg_hi:[0,1]
    v_pk_add_f32 v[112:113], v[64:65], v[24:25] neg_lo:[0,1] neg_hi:[0,1]
    v_pk_add_f32 v[114:115], v[66:67], v[24:25] neg_lo:[0,1] neg_hi:[0,1]
    v_pk_add_f32 v[116:117], v[68:69], v[24:25] neg_lo:[0,1] neg_hi:[0,1]
    v_pk_add_f32 v[118:119], v[70:71], v[24:25] neg_lo:[0,1] neg_hi:[0,1]
    v_pk_add_f32 v[120:121], v[72:73], v[24:25] neg_lo:[0,1] neg_hi:[0,1]
    v_pk_add_f32 v[122:123], v[74:75], v[24:25] neg_lo:[0,1] neg_hi:[0,1]
    v_pk_add_f32 v[124:125], v[76:77], v[24:25] neg_lo:[0,1] neg_hi:[0,1]
    v_pk_add_f32 v[126:127], v[78:79], v[24:25] neg_lo:[0,1] neg_hi:[0,1]
    v_pk_mul_f32 v[80:81], v[96:97], v[96:97]
    v_pk_mul_f32 v[82:83], v[98:99], v[98:99]
    v_pk_mul_f32 v[84:85], v[100:101], v[100:101]
    v_pk_mul_f32 v[86:87], v[102:103], v[102:103]
    v_pk_fma_f32 v[80:81], v[104:105], v[104:105], v[80:81]
    v_pk_fma_f32 v[82:83], v[106:107], v[106:107], v[82:83]
    v_pk_fma_f32 v[84:85], v[108:109], v[108:109], v[84:85]
    v_pk_fma_f32 v[86:87], v[110:111], v[110:111], v[86:87]
    v_pk_fma_f32 v[80:81], v[112:113], v[112:113], v[80:81]
    v_pk_fma_f32 v[82:83], v[114:115], v[114:115], v[82:83]
    v_pk_fma_f32 v[84:85], v[116:117], v[116:117], v[84:85]
    v_pk_fma_f32 v[86:87], v[118:119], v[118:119], v[86:87]
    v_pk_fma_f32 v[80:81], v[120:121], v[120:121], v[80:81]
    v_pk_fma_f32 v[82:83], v[122:123], v[122:123], v[82:83]
    v_pk_fma_f32 v[84:85], v[124:125], v[124:125], v[84:85]
    v_pk_fma_f32 v[86:87], v[126:127], v[126:127], v[86:87]
    v_pk_add_f32 v[80:81], v[80:81], v[84:85]
    v_pk_add_f32 v[82:83], v[82:83], v[86:87]
    v_pk_add_f32 v[80:81], v[80:81], v[82:83]
    v_add_f32 v80, v80, v81
    v_cvt_pk_bf16_f32 v31, v24, v24
    v_lshlrev_b32 v24, 16, v31
    v_mov_b32 v25, v24
    s_nop 1
    v_add_f32_dpp v80, v80, v80 row_ror:8 row_mask:0xf bank_mask:0xf
    ds_write_b32 v28, v80 offset:512
    v_pk_add_f32 v[48:49], v[48:49], v[24:25] neg_lo:[0,1] neg_hi:[0,1]
    v_pk_add_f32 v[50:51], v[50:51], v[24:25] neg_lo:[0,1] neg_hi:[0,1]
    v_pk_add_f32 v[52:53], v[52:53], v[24:25] neg_lo:[0,1] neg_hi:[0,1]
    v_pk_add_f32 v[54:55], v[54:55], v[24:25] neg_lo:[0,1] neg_hi:[0,1]
    v_pk_add_f32 v[56:57], v[56:57], v[24:25] neg_lo:[0,1] neg_hi:[0,1]
    v_pk_add_f32 v[58:59], v[58:59], v[24:25] neg_lo:[0,1] neg_hi:[0,1]
    v_pk_add_f32 v[60:61], v[60:61], v[24:25] neg_lo:[0,1] neg_hi:[0,1]
    v_pk_add_f32 v[62:63], v[62:63], v[24:25] neg_lo:[0,1] neg_hi:[0,1]
    v_pk_add_f32 v[64:65], v[64:65], v[24:25] neg_lo:[0,1] neg_hi:[0,1]
    v_pk_add_f32 v[66:67], v[66:67], v[24:25] neg_lo:[0,1] neg_hi:[0,1]
    v_pk_add_f32 v[68:69], v[68:69], v[24:25] neg_lo:[0,1] neg_hi:[0,1]
    v_pk_add_f32 v[70:71], v[70:71], v[24:25] neg_lo:[0,1] neg_hi:[0,1]
    v_pk_add_f32 v[72:73], v[72:73], v[24:25] neg_lo:[0,1] neg_hi:[0,1]
    v_pk_add_f32 v[74:75], v[74:75], v[24:25] neg_lo:[0,1] neg_hi:[0,1]
    v_pk_add_f32 v[76:77], v[76:77], v[24:25] neg_lo:[0,1] neg_hi:[0,1]
    v_pk_add_f32 v[78:79], v[78:79], v[24:25] neg_lo:[0,1] neg_hi:[0,1]
    s_waitcnt lgkmcnt(0)
    s_barrier
    ds_read_b128 v[80:83], v29 offset:512
    ds_read_b128 v[84:87], v29 offset:528
    ds_read_b128 v[88:91], v29 offset:544
    ds_read_b128 v[92:95], v29 offset:560
    v_cvt_pk_bf16_f32 v32, v48, v49
    v_cvt_pk_bf16_f32 v33, v50, v51
    v_cvt_pk_bf16_f32 v34, v52, v53
    v_cvt_pk_bf16_f32 v35, v54, v55
    v_cvt_pk_bf16_f32 v36, v56, v57
    v_cvt_pk_bf16_f32 v37, v58, v59
    v_cvt_pk_bf16_f32 v38, v60, v61
    v_cvt_pk_bf16_f32 v39, v62, v63
    v_cvt_pk_bf16_f32 v40, v64, v65
    v_cvt_pk_bf16_f32 v41, v66, v67
    v_cvt_pk_bf16_f32 v42, v68, v69
    v_cvt_pk_bf16_f32 v43, v70, v71
    v_cvt_pk_bf16_f32 v44, v72, v73
    v_cvt_pk_bf16_f32 v45, v74, v75
    v_cvt_pk_bf16_f32 v46, v76, v77
    v_cvt_pk_bf16_f32 v47, v78, v79
    v_lshlrev_b32 v48, 16, v32
    v_and_b32 v49, 0xffff0000, v32
    v_lshlrev_b32 v50, 16, v33
    v_and_b32 v51, 0xffff0000, v33
    v_lshlrev_b32 v52, 16, v34
    v_and_b32 v53, 0xffff0000, v34
    v_lshlrev_b32 v54, 16, v35
    v_and_b32 v55, 0xffff0000, v35
    v_lshlrev_b32 v56, 16, v36
    v_and_b32 v57, 0xffff0000, v36
    v_lshlrev_b32 v58, 16, v37
    v_and_b32 v59, 0xffff0000, v37
    v_lshlrev_b32 v60, 16, v38
    v_and_b32 v61, 0xffff0000, v38
    v_lshlrev_b32 v62, 16, v39
    v_and_b32 v63, 0xffff0000, v39
    v_lshlrev_b32 v64, 16, v40
    v_and_b32 v65, 0xffff0000, v40
    v_lshlrev_b32 v66, 16, v41
    v_and_b32 v67, 0xffff0000, v41
    v_lshlrev_b32 v68, 16, v42
    v_and_b32 v69, 0xffff0000, v42
    v_lshlrev_b32 v70, 16, v43
    v_and_b32 v71, 0xffff0000, v43
    v_lshlrev_b32 v72, 16, v44
    v_and_b32 v73, 0xffff0000, v44
    v_lshlrev_b32 v74, 16, v45
    v_and_b32 v75, 0xffff0000, v45
    v_lshlrev_b32 v76, 16, v46
    v_and_b32 v77, 0xffff0000, v46
    v_lshlrev_b32 v78, 16, v47
    v_and_b32 v79, 0xffff0000, v47
    s_waitcnt lgkmcnt(0)
    v_pk_add_f32 v[80:81], v[80:81], v[88:89]
    v_pk_add_f32 v[82:83], v[82:83], v[90:91]
    v_pk_add_f32 v[84:85], v[84:85], v[92:93]
    v_pk_add_f32 v[86:87], v[86:87], v[94:95]
    v_pk_add_f32 v[80:81], v[80:81], v[84:85]
    v_pk_add_f32 v[82:83], v[82:83], v[86:87]
    v_pk_add_f32 v[80:81], v[80:81], v[82:83]
    v_add_f32 v80, v80, v81
    v_mul_f32 v30, 0x3a800000, v80
    v_cvt_pk_bf16_f32 v30, v30, v30
    v_and_b32 v30, 0xffff0000, v30
    v_add_f32 v30, 0x3727c5ac, v30
    v_cvt_pk_bf16_f32 v30, v30, v30
    v_and_b32 v30, 0xffff0000, v30
    v_sqrt_f32 v30, v30
    s_add_u32 s92, s92, 1
    v_cvt_pk_bf16_f32 v30, v30, v30
    v_and_b32 v30, 0xffff0000, v30
    v_rcp_f32 v30, v30
    s_not_b32 s93, s92
    v_mov_b32 v31, v30
    v_pk_mul_f32 v[48:49], v[48:49], v[30:31]
    v_pk_mul_f32 v[50:51], v[50:51], v[30:31]
    v_pk_mul_f32 v[52:53], v[52:53], v[30:31]
    v_pk_mul_f32 v[54:55], v[54:55], v[30:31]
    v_cvt_pk_bf16_f32 v32, v48, v49
    v_cvt_pk_bf16_f32 v33, v50, v51
    v_cvt_pk_bf16_f32 v34, v52, v53
    v_cvt_pk_bf16_f32 v35, v54, v55
    buffer_store_dwordx4 v[32:35], v27, s[40:43], s76 offen sc1
    v_pk_mul_f32 v[56:57], v[56:57], v[30:31]
    v_pk_mul_f32 v[58:59], v[58:59], v[30:31]
    v_pk_mul_f32 v[60:61], v[60:61], v[30:31]
    v_pk_mul_f32 v[62:63], v[62:63], v[30:31]
    v_cvt_pk_bf16_f32 v36, v56, v57
    v_cvt_pk_bf16_f32 v37, v58, v59
    v_cvt_pk_bf16_f32 v38, v60, v61
    v_cvt_pk_bf16_f32 v39, v62, v63
    buffer_store_dwordx4 v[36:39], v27, s[40:43], s77 offen sc1
    v_pk_mul_f32 v[64:65], v[64:65], v[30:31]
    v_pk_mul_f32 v[66:67], v[66:67], v[30:31]
    v_pk_mul_f32 v[68:69], v[68:69], v[30:31]
    v_pk_mul_f32 v[70:71], v[70:71], v[30:31]
    v_cvt_pk_bf16_f32 v40, v64, v65
    v_cvt_pk_bf16_f32 v41, v66, v67
    v_cvt_pk_bf16_f32 v42, v68, v69
    v_cvt_pk_bf16_f32 v43, v70, v71
    buffer_store_dwordx4 v[40:43], v27, s[40:43], s78 offen sc1
    v_pk_mul_f32 v[72:73], v[72:73], v[30:31]
    v_pk_mul_f32 v[74:75], v[74:75], v[30:31]
    v_pk_mul_f32 v[76:77], v[76:77], v[30:31]
    v_pk_mul_f32 v[78:79], v[78:79], v[30:31]
    v_cvt_pk_bf16_f32 v44, v72, v73
    v_cvt_pk_bf16_f32 v45, v74, v75
    v_cvt_pk_bf16_f32 v46, v76, v77
    v_cvt_pk_bf16_f32 v47, v78, v79
    buffer_store_dwordx4 v[44:47], v27, s[40:43], s79 offen sc1
    v_bfe_u32 v17, v1, 2, 4
    v_and_b32 v18, 3, v1
    v_lshlrev_b32 v18, 3, v18
    v_mul_u32_u24 v9, 224, v17
    v_add_u32 v9, v9, v18
    v_mul_u32_u24 v7, 192, v17
    v_add_u32 v7, v7, v18
    v_bfe_u32 v19, v1, 4, 1
    v_lshlrev_b32 v19, 5, v19
    v_sub_u32 v8, v7, v19
    v_add_u32 v7, v7, v19
    v_mov_b32 v10, v7
    v_mov_b32 v11, v8
    v_mov_b32 v12, v9
    v_add_u32 v13, 40960, v7
    v_add_u32 v14, 40960, v8
    v_add_u32 v15, 40960, v9
    v_add_u32 v253, 4096, v16
    s_mov_b32 s84, 7344128
    s_cmp_lt_u32 s3, 3
    s_cselect_b32 s24, s12, s14
    s_cselect_b32 s25, s13, s15
    s_cmp_lt_u32 s3, 2
    s_cselect_b32 s24, s6, s24
    s_cselect_b32 s25, s7, s25
    s_cselect_b32 s26, 6295552, s84
    s_sub_u32 s24, s24, 4096
    s_subb_u32 s25, s25, 0
    s_and_b32 s25, s25, 0xffff
    s_mov_b32 s27, 0x00020000
    s_cmp_lt_u32 s3, 3
    s_cselect_b32 s28, s12, s14
    s_cselect_b32 s29, s13, s15
    s_cmp_lt_u32 s3, 1
    s_cselect_b32 s28, s6, s28
    s_cselect_b32 s29, s7, s29
    s_cselect_b32 s30, 6295552, s84
    s_sub_u32 s28, s28, 4096
    s_subb_u32 s29, s29, 0
    s_and_b32 s29, s29, 0xffff
    s_mov_b32 s31, 0x00020000
    s_cmp_lt_u32 s3, 2
    s_cselect_b32 s32, s12, s14
    s_cselect_b32 s33, s13, s15
    s_cmp_lt_u32 s3, 1
    s_cselect_b32 s32, s6, s32
    s_cselect_b32 s33, s7, s33
    s_cselect_b32 s34, 6295552, s84
    s_sub_u32 s32, s32, 4096
    s_subb_u32 s33, s33, 0
    s_and_b32 s33, s33, 0xffff
    s_mov_b32 s35, 0x00020000
    s_mov_b32 s84, 458752
    s_cmp_lt_u32 s3, 2
    s_cselect_b32 s62, 393216, s84
    s_cmp_lt_u32 s3, 1
    s_cselect_b32 s63, 393216, s84
    s_mov_b32 s60, 0
    s_mov_b32 s61, 0
    s_mov_b32 s64, 0
    s_mul_i32 s69, s3, 5120
    s_lshl_b32 s84, s11, 2
    s_add_u32 s84, s84, s3
    s_lshl_b32 s84, s84, 17
    s_add_u32 s36, s22, s84
    s_addc_u32 s37, s23, 0
    s_and_b32 s37, s37, 0xffff
    s_mov_b32 s38, 131072
    s_mov_b32 s39, 0x00020000
    s_mov_b32 s56, s16
    s_and_b32 s57, s17, 0xffff
    s_mov_b32 s58, 7340032
    s_mov_b32 s59, 0x00020000
    s_and_b32 s98, s2, 1
    s_bfe_u32 s98, s2, 0x10002
    s_xor_b32 s98, s98, 1
    s_bfe_u32 s20, s2, 0x10001
    s_lshl_b32 s20, s20, 3
    s_bfe_u32 s84, s2, 0x30003
    s_add_u32 s20, s20, s84
    s_and_b32 s21, s2, 1
    s_lshl_b32 s21, s21, 2
    s_lshr_b32 s84, s2, 6
    s_add_u32 s21, s21, s84
    s_lshl_b32 s84, s20, 2
    s_add_u32 s84, s84, s3
    s_lshl_b32 s96, s84, 16
    s_lshl_b32 s84, s21, 8
    s_lshl_b32 s86, s98, 7
    s_add_u32 s84, s84, s86
    s_add_u32 s96, s96, s84
    s_add_u32 s97, s96, 32768
    v_and_b32 v22, 15, v1
    v_lshlrev_b32 v22, 11, v22
    v_bfe_u32 v18, v1, 4, 1
    v_lshl_add_u32 v22, v18, 5, v22
    v_bfe_u32 v18, v1, 5, 1
    v_lshl_add_u32 v22, v18, 4, v22
    v_and_b32 v17, 31, v1
    v_lshlrev_b32 v17, 7, v17
    s_mov_b32 s68, 0
    s_and_b32 s89, s9, 0xffff
    s_lshl_b32 s84, s2, 7
    s_add_u32 s84, s84, 5767168
    s_lshl_b32 s85, s11, 12
    s_add_u32 s85, s85, 5767168
    s_cmp_eq_u32 s3, 2
    s_cselect_b32 s73, 6291456, -1
    s_lshl_b32 s88, s3, 12
    s_mul_i32 s75, s98, 3670016
    s_add_u32 m0, s69, 0
    s_nop 0
    buffer_load_dwordx4 v2, s[24:27], s60 offen offset:0  lds
    buffer_load_dwordx4 v3, s[28:31], s61 offen offset:1024  lds
    buffer_load_dwordx4 v4, s[28:31], s61 offen offset:2048  lds
    buffer_load_dwordx4 v5, s[32:35], s61 offen offset:3072  lds
    s_add_u32 m0, s69, 4096
    s_nop 0
    buffer_load_dwordx4 v6, s[32:35], s61 offen offset:0  lds
    s_waitcnt vmcnt(5)
    s_barrier
    s_cmp_eq_u32 s3, 0
    s_cbranch_scc0 L_sig0
    v_mov_b32 v18, s92
    v_mov_b32 v19, s93
    v_mov_b32 v20, s92
    v_mov_b32 v21, s93
    s_mov_b64 exec, 0xff
    buffer_store_dwordx4 v[18:21], v16, s[40:43], s84 offen sc0 sc1
    s_mov_b64 exec, -1
    s_nop 0
L_sig0:
    s_add_u32 m0, s69, 20480
    s_nop 0
    buffer_load_dwordx4 v248, s[24:27], s60 offen offset:0  lds
    buffer_load_dwordx4 v249, s[28:31], s61 offen offset:1024  lds
    buffer_load_dwordx4 v250, s[28:31], s61 offen offset:2048  lds
    buffer_load_dwordx4 v251, s[32:35], s61 offen offset:3072  lds
    s_add_u32 m0, s69, 24576
    s_nop 0
    buffer_load_dwordx4 v252, s[32:35], s61 offen offset:0  lds
    s_add_u32 s60, s60, s62
    s_add_u32 s61, s61, s63
    s_add_u32 m0, s69, 40960
    s_nop 0
    buffer_load_dwordx4 v2, s[24:27], s60 offen offset:0  lds
    buffer_load_dwordx4 v3, s[28:31], s61 offen offset:1024  lds
    buffer_load_dwordx4 v4, s[28:31], s61 offen offset:2048  lds
    buffer_load_dwordx4 v5, s[32:35], s61 offen offset:3072  lds
    s_add_u32 m0, s69, 45056
    s_nop 0
    buffer_load_dwordx4 v6, s[32:35], s61 offen offset:0  lds
    s_add_u32 m0, s69, 61440
    s_nop 0
    buffer_load_dwordx4 v248, s[24:27], s60 offen offset:0  lds
    buffer_load_dwordx4 v249, s[28:31], s61 offen offset:1024  lds
    buffer_load_dwordx4 v250, s[28:31], s61 offen offset:2048  lds
    buffer_load_dwordx4 v251, s[32:35], s61 offen offset:3072  lds
    s_add_u32 m0, s69, 65536
    s_nop 0
    buffer_load_dwordx4 v252, s[32:35], s61 offen offset:0  lds
    s_add_u32 s60, s60, s62
    s_add_u32 s61, s61, s63
    s_cmp_eq_u32 s3, 0
    s_cbranch_scc0 L_p0s
    buffer_load_dwordx2 v[20:21], v17, s[40:43], s85 offen sc0 sc1
    s_waitcnt vmcnt(0)
    s_mov_b32 s99, 0
L_p0:
    v_xor_b32 v20, s92, v20
    v_xor_b32 v21, s93, v21
    v_or_b32 v20, v20, v21
    v_cmp_ne_u32 vcc, 0, v20
    s_cbranch_vccz L_p0_ok
    buffer_load_dwordx2 v[20:21], v17, s[40:43], s85 offen sc0 sc1
    s_add_u32 s99, s99, 1
    s_cmp_lt_u32 s99, 0x200000
    s_waitcnt vmcnt(0)
    s_cbranch_scc1 L_p0
L_p0_ok:
L_p0s:
    s_waitcnt vmcnt(10)
    s_barrier
    buffer_load_dwordx4 a[40:43], v16, s[36:39], s64 offen offset:0 sc1
    buffer_load_dwordx4 a[56:59], v253, s[36:39], s64 offen offset:0 sc1
    buffer_load_dwordx4 a[44:47], v16, s[36:39], s64 offen offset:1024 sc1
    buffer_load_dwordx4 a[60:63], v253, s[36:39], s64 offen offset:1024 sc1
    buffer_load_dwordx4 a[48:51], v16, s[36:39], s64 offen offset:2048 sc1
    buffer_load_dwordx4 a[64:67], v253, s[36:39], s64 offen offset:2048 sc1
    buffer_load_dwordx4 a[52:55], v16, s[36:39], s64 offen offset:3072 sc1
    buffer_load_dwordx4 a[68:71], v253, s[36:39], s64 offen offset:3072 sc1
    s_add_u32 s64, s64, 8192
    v_mov_b32 v7, v200
    ds_read_b64_tr_b16 a[0:1], v10 offset:0
    ds_read_b64_tr_b16 a[2:3], v10 offset:3072
    ds_read_b64_tr_b16 a[4:5], v10 offset:20480
    ds_read_b64_tr_b16 a[6:7], v10 offset:23552
    ds_read_b64_tr_b16 a[8:9], v11 offset:32
    ds_read_b64_tr_b16 a[10:11], v11 offset:3104
    ds_read_b64_tr_b16 a[12:13], v11 offset:20512
    ds_read_b64_tr_b16 a[14:15], v11 offset:23584
    ds_read_b64_tr_b16 a[16:17], v10 offset:64
    ds_read_b64_tr_b16 a[18:19], v10 offset:3136
    ds_read_b64_tr_b16 a[20:21], v10 offset:20544
    ds_read_b64_tr_b16 a[22:23], v10 offset:23616
    ds_read_b64_tr_b16 a[24:25], v11 offset:96
    ds_read_b64_tr_b16 a[26:27], v11 offset:3168
    ds_read_b64_tr_b16 a[28:29], v11 offset:20576
    ds_read_b64_tr_b16 a[30:31], v11 offset:23648
    s_waitcnt vmcnt(0) lgkmcnt(8)
    v_mfma_f32_16x16x32_bf16 a[104:107], a[0:3], a[40:43], 0
    ds_read_b64_tr_b16 a[32:33], v10 offset:128
    v_mfma_f32_16x16x32_bf16 a[104:107], a[4:7], a[56:59], a[104:107]
    ds_read_b64_tr_b16 a[34:35], v10 offset:3200
    v_mfma_f32_16x16x32_bf16 a[108:111], a[4:7], a[60:63], 0
    buffer_load_dwordx4 a[72:75], v16, s[36:39], s64 offen offset:0 sc1
    v_mfma_f32_16x16x32_bf16 a[108:111], a[0:3], a[44:47], a[108:111]
    buffer_load_dwordx4 a[88:91], v253, s[36:39], s64 offen offset:0 sc1
    v_mfma_f32_16x16x32_bf16 a[112:115], a[0:3], a[48:51], 0
    ds_read_b64_tr_b16 a[36:37], v10 offset:20608
    v_mfma_f32_16x16x32_bf16 a[112:115], a[4:7], a[64:67], a[112:115]
    ds_read_b64_tr_b16 a[38:39], v10 offset:23680
    v_mfma_f32_16x16x32_bf16 a[116:119], a[4:7], a[68:71], 0
    v_mfma_f32_16x16x32_bf16 a[116:119], a[0:3], a[52:55], a[116:119]
    buffer_load_dwordx4 a[76:79], v16, s[36:39], s64 offen offset:1024 sc1
    v_mfma_f32_16x16x32_bf16 a[132:135], a[8:11], a[52:55], 0
    ds_read_b64_tr_b16 a[0:1], v11 offset:160
    v_mfma_f32_16x16x32_bf16 a[132:135], a[12:15], a[68:71], a[132:135]
    ds_read_b64_tr_b16 a[2:3], v11 offset:3232
    v_mfma_f32_16x16x32_bf16 a[128:131], a[12:15], a[64:67], 0
    buffer_load_dwordx4 a[92:95], v253, s[36:39], s64 offen offset:1024 sc1
    v_mfma_f32_16x16x32_bf16 a[128:131], a[8:11], a[48:51], a[128:131]
    v_mfma_f32_16x16x32_bf16 a[124:127], a[8:11], a[44:47], 0
    ds_read_b64_tr_b16 a[4:5], v11 offset:20640
    v_mfma_f32_16x16x32_bf16 a[124:127], a[12:15], a[60:63], a[124:127]
    ds_read_b64_tr_b16 a[6:7], v11 offset:23712
    v_mfma_f32_16x16x32_bf16 a[120:123], a[12:15], a[56:59], 0
    buffer_load_dwordx4 a[80:83], v16, s[36:39], s64 offen offset:2048 sc1
    v_mfma_f32_16x16x32_bf16 a[120:123], a[8:11], a[40:43], a[120:123]
    s_waitcnt lgkmcnt(8)
    v_mfma_f32_16x16x32_bf16 a[136:139], a[40:43], a[16:19], 0
    ds_read_b64_tr_b16 a[8:9], v12 offset:6144
    v_mfma_f32_16x16x32_bf16 a[136:139], a[56:59], a[20:23], a[136:139]
    ds_read_b64_tr_b16 a[10:11], v12 offset:9728
    v_mfma_f32_16x16x32_bf16 a[140:143], a[60:63], a[20:23], 0
    buffer_load_dwordx4 a[96:99], v253, s[36:39], s64 offen offset:2048 sc1
    v_mfma_f32_16x16x32_bf16 a[140:143], a[44:47], a[16:19], a[140:143]
    v_mfma_f32_16x16x32_bf16 a[144:147], a[48:51], a[16:19], 0
    ds_read_b64_tr_b16 a[12:13], v12 offset:26624
    v_mfma_f32_16x16x32_bf16 a[144:147], a[64:67], a[20:23], a[144:147]
    ds_read_b64_tr_b16 a[14:15], v12 offset:30208
    v_mfma_f32_16x16x32_bf16 a[148:151], a[68:71], a[20:23], 0
    buffer_load_dwordx4 a[84:87], v16, s[36:39], s64 offen offset:3072 sc1
    v_mfma_f32_16x16x32_bf16 a[148:151], a[52:55], a[16:19], a[148:151]
    buffer_load_dwordx4 a[100:103], v253, s[36:39], s64 offen offset:3072 sc1
    v_mfma_f32_16x16x32_bf16 a[164:167], a[52:55], a[24:27], 0
    ds_read_b64_tr_b16 a[16:17], v12 offset:6176
    v_mfma_f32_16x16x32_bf16 a[164:167], a[68:71], a[28:31], a[164:167]
    ds_read_b64_tr_b16 a[18:19], v12 offset:9760
    v_mfma_f32_16x16x32_bf16 a[160:163], a[64:67], a[28:31], 0
    v_mfma_f32_16x16x32_bf16 a[160:163], a[48:51], a[24:27], a[160:163]
    s_add_u32 s64, s64, 8192
    v_mfma_f32_16x16x32_bf16 a[156:159], a[44:47], a[24:27], 0
    ds_read_b64_tr_b16 a[20:21], v12 offset:26656
    v_mfma_f32_16x16x32_bf16 a[156:159], a[60:63], a[28:31], a[156:159]
    ds_read_b64_tr_b16 a[22:23], v12 offset:30240
    v_mfma_f32_16x16x32_bf16 a[152:155], a[56:59], a[28:31], 0
    v_mfma_f32_16x16x32_bf16 a[152:155], a[40:43], a[24:27], a[152:155]
    s_waitcnt lgkmcnt(8)
    v_mfma_f32_16x16x32_bf16 a[168:171], a[40:43], a[32:35], 0
    ds_read_b64_tr_b16 a[24:25], v12 offset:6208
    v_mfma_f32_16x16x32_bf16 a[168:171], a[56:59], a[36:39], a[168:171]
    ds_read_b64_tr_b16 a[26:27], v12 offset:9792
    v_mfma_f32_16x16x32_bf16 a[172:175], a[60:63], a[36:39], 0
    buffer_load_dword v23, v7, s[44:47], s71 offen
    v_mfma_f32_16x16x32_bf16 a[172:175], a[44:47], a[32:35], a[172:175]
    v_mfma_f32_16x16x32_bf16 a[176:179], a[48:51], a[32:35], 0
    ds_read_b64_tr_b16 a[28:29], v12 offset:26688
    v_mfma_f32_16x16x32_bf16 a[176:179], a[64:67], a[36:39], a[176:179]
    ds_read_b64_tr_b16 a[30:31], v12 offset:30272
    v_mfma_f32_16x16x32_bf16 a[180:183], a[68:71], a[36:39], 0
    s_add_u32 s71, s71, s72
    v_mfma_f32_16x16x32_bf16 a[180:183], a[52:55], a[32:35], a[180:183]
    v_mfma_f32_16x16x32_bf16 a[196:199], a[52:55], a[0:3], 0
    ds_read_b64_tr_b16 a[32:33], v12 offset:6240
    v_mfma_f32_16x16x32_bf16 a[196:199], a[68:71], a[4:7], a[196:199]
    ds_read_b64_tr_b16 a[34:35], v12 offset:9824
    v_mfma_f32_16x16x32_bf16 a[192:195], a[64:67], a[4:7], 0
    v_mfma_f32_16x16x32_bf16 a[192:195], a[48:51], a[0:3], a[192:195]
    v_mfma_f32_16x16x32_bf16 a[188:191], a[44:47], a[0:3], 0
    ds_read_b64_tr_b16 a[36:37], v12 offset:26720
    v_mfma_f32_16x16x32_bf16 a[188:191], a[60:63], a[4:7], a[188:191]
    ds_read_b64_tr_b16 a[38:39], v12 offset:30304
    v_mfma_f32_16x16x32_bf16 a[184:187], a[56:59], a[4:7], 0
    v_mfma_f32_16x16x32_bf16 a[184:187], a[40:43], a[0:3], a[184:187]
    s_waitcnt lgkmcnt(8)
    v_mfma_f32_16x16x32_bf16 v[136:139], a[8:11], a[40:43], 0
    ds_read_b64_tr_b16 a[0:1], v12 offset:6272
    v_mfma_f32_16x16x32_bf16 v[136:139], a[12:15], a[56:59], v[136:139]
    ds_read_b64_tr_b16 a[2:3], v12 offset:9856
    v_mfma_f32_16x16x32_bf16 v[164:167], a[12:15], a[60:63], 0
    v_mfma_f32_16x16x32_bf16 v[164:167], a[8:11], a[44:47], v[164:167]
    v_mfma_f32_16x16x32_bf16 v[192:195], a[8:11], a[48:51], 0
    ds_read_b64_tr_b16 a[4:5], v12 offset:26752
    v_mfma_f32_16x16x32_bf16 v[192:195], a[12:15], a[64:67], v[192:195]
    ds_read_b64_tr_b16 a[6:7], v12 offset:30336
    v_mfma_f32_16x16x32_bf16 v[220:223], a[12:15], a[68:71], 0
    v_mfma_f32_16x16x32_bf16 v[220:223], a[8:11], a[52:55], v[220:223]
    v_mfma_f32_16x16x32_bf16 v[224:227], a[16:19], a[52:55], 0
    ds_read_b64_tr_b16 a[8:9], v12 offset:6304
    v_mfma_f32_16x16x32_bf16 v[224:227], a[20:23], a[68:71], v[224:227]
    ds_read_b64_tr_b16 a[10:11], v12 offset:9888
    v_mfma_f32_16x16x32_bf16 v[196:199], a[20:23], a[64:67], 0
    v_mfma_f32_16x16x32_bf16 v[196:199], a[16:19], a[48:51], v[196:199]
    v_mfma_f32_16x16x32_bf16 v[168:171], a[16:19], a[44:47], 0
    ds_read_b64_tr_b16 a[12:13], v12 offset:26784
    v_mfma_f32_16x16x32_bf16 v[168:171], a[20:23], a[60:63], v[168:171]
    ds_read_b64_tr_b16 a[14:15], v12 offset:30368
    v_mfma_f32_16x16x32_bf16 v[140:143], a[20:23], a[56:59], 0
    v_mfma_f32_16x16x32_bf16 v[140:143], a[16:19], a[40:43], v[140:143]
    s_waitcnt lgkmcnt(8)
    v_mfma_f32_16x16x32_bf16 v[144:147], a[24:27], a[40:43], 0
    ds_read_b64_tr_b16 a[16:17], v12 offset:6336
    v_mfma_f32_16x16x32_bf16 v[144:147], a[28:31], a[56:59], v[144:147]
    ds_read_b64_tr_b16 a[18:19], v12 offset:9920
    v_mfma_f32_16x16x32_bf16 v[172:175], a[28:31], a[60:63], 0
    v_mfma_f32_16x16x32_bf16 v[172:175], a[24:27], a[44:47], v[172:175]
    v_mfma_f32_16x16x32_bf16 v[200:203], a[24:27], a[48:51], 0
    ds_read_b64_tr_b16 a[20:21], v12 offset:26816
    v_mfma_f32_16x16x32_bf16 v[200:203], a[28:31], a[64:67], v[200:203]
    ds_read_b64_tr_b16 a[22:23], v12 offset:30400
    v_mfma_f32_16x16x32_bf16 v[228:231], a[28:31], a[68:71], 0
    v_mfma_f32_16x16x32_bf16 v[228:231], a[24:27], a[52:55], v[228:231]
    v_mfma_f32_16x16x32_bf16 v[232:235], a[32:35], a[52:55], 0
    ds_read_b64_tr_b16 a[24:25], v12 offset:13312
    v_mfma_f32_16x16x32_bf16 v[232:235], a[36:39], a[68:71], v[232:235]
    ds_read_b64_tr_b16 a[26:27], v12 offset:16896
    v_mfma_f32_16x16x32_bf16 v[204:207], a[36:39], a[64:67], 0
    v_mfma_f32_16x16x32_bf16 v[204:207], a[32:35], a[48:51], v[204:207]
    v_mfma_f32_16x16x32_bf16 v[176:179], a[32:35], a[44:47], 0
    ds_read_b64_tr_b16 a[28:29], v12 offset:33792
    v_mfma_f32_16x16x32_bf16 v[176:179], a[36:39], a[60:63], v[176:179]
    ds_read_b64_tr_b16 a[30:31], v12 offset:37376
    v_mfma_f32_16x16x32_bf16 v[148:151], a[36:39], a[56:59], 0
    v_mfma_f32_16x16x32_bf16 v[148:151], a[32:35], a[40:43], v[148:151]
    s_waitcnt lgkmcnt(8)
    v_mfma_f32_16x16x32_bf16 v[152:155], a[0:3], a[40:43], 0
    ds_read_b64_tr_b16 a[32:33], v12 offset:13344
    v_mfma_f32_16x16x32_bf16 v[152:155], a[4:7], a[56:59], v[152:155]
    ds_read_b64_tr_b16 a[34:35], v12 offset:16928
    v_mfma_f32_16x16x32_bf16 v[180:183], a[4:7], a[60:63], 0
    v_mfma_f32_16x16x32_bf16 v[180:183], a[0:3], a[44:47], v[180:183]
    v_mfma_f32_16x16x32_bf16 v[208:211], a[0:3], a[48:51], 0
    ds_read_b64_tr_b16 a[36:37], v12 offset:33824
    v_mfma_f32_16x16x32_bf16 v[208:211], a[4:7], a[64:67], v[208:211]
    ds_read_b64_tr_b16 a[38:39], v12 offset:37408
    v_mfma_f32_16x16x32_bf16 v[236:239], a[4:7], a[68:71], 0
    v_mfma_f32_16x16x32_bf16 v[236:239], a[0:3], a[52:55], v[236:239]
    v_mfma_f32_16x16x32_bf16 v[240:243], a[8:11], a[52:55], 0
    ds_read_b64_tr_b16 a[0:1], v12 offset:13376
    v_mfma_f32_16x16x32_bf16 v[240:243], a[12:15], a[68:71], v[240:243]
    ds_read_b64_tr_b16 a[2:3], v12 offset:16960
    v_mfma_f32_16x16x32_bf16 v[212:215], a[12:15], a[64:67], 0
    v_mfma_f32_16x16x32_bf16 v[212:215], a[8:11], a[48:51], v[212:215]
    v_mfma_f32_16x16x32_bf16 v[184:187], a[8:11], a[44:47], 0
    ds_read_b64_tr_b16 a[4:5], v12 offset:33856
    v_mfma_f32_16x16x32_bf16 v[184:187], a[12:15], a[60:63], v[184:187]
    ds_read_b64_tr_b16 a[6:7], v12 offset:37440
    v_mfma_f32_16x16x32_bf16 v[156:159], a[12:15], a[56:59], 0
    v_mfma_f32_16x16x32_bf16 v[156:159], a[8:11], a[40:43], v[156:159]
    s_waitcnt lgkmcnt(8)
    v_mfma_f32_16x16x32_bf16 v[160:163], a[16:19], a[40:43], 0
    ds_read_b64_tr_b16 a[8:9], v12 offset:13408
    v_mfma_f32_16x16x32_bf16 v[160:163], a[20:23], a[56:59], v[160:163]
    ds_read_b64_tr_b16 a[10:11], v12 offset:16992
    v_mfma_f32_16x16x32_bf16 v[188:191], a[20:23], a[60:63], 0
    v_mfma_f32_16x16x32_bf16 v[188:191], a[16:19], a[44:47], v[188:191]
    v_mfma_f32_16x16x32_bf16 v[216:219], a[16:19], a[48:51], 0
    ds_read_b64_tr_b16 a[12:13], v12 offset:33888
    v_mfma_f32_16x16x32_bf16 v[216:219], a[20:23], a[64:67], v[216:219]
    ds_read_b64_tr_b16 a[14:15], v12 offset:37472
    v_mfma_f32_16x16x32_bf16 v[244:247], a[20:23], a[68:71], 0
    v_mfma_f32_16x16x32_bf16 v[244:247], a[16:19], a[52:55], v[244:247]
    v_mfma_f32_16x16x32_bf16 v[36:39], a[24:27], a[52:55], 0
    ds_read_b64_tr_b16 a[16:17], v12 offset:13440
    v_mfma_f32_16x16x32_bf16 v[36:39], a[28:31], a[68:71], v[36:39]
    ds_read_b64_tr_b16 a[18:19], v12 offset:17024
    v_mfma_f32_16x16x32_bf16 v[32:35], a[28:31], a[64:67], 0
    v_mfma_f32_16x16x32_bf16 v[32:35], a[24:27], a[48:51], v[32:35]
    v_mfma_f32_16x16x32_bf16 v[28:31], a[24:27], a[44:47], 0
    ds_read_b64_tr_b16 a[20:21], v12 offset:33920
    v_mfma_f32_16x16x32_bf16 v[28:31], a[28:31], a[60:63], v[28:31]
    ds_read_b64_tr_b16 a[22:23], v12 offset:37504
    v_mfma_f32_16x16x32_bf16 v[24:27], a[28:31], a[56:59], 0
    v_mfma_f32_16x16x32_bf16 v[24:27], a[24:27], a[40:43], v[24:27]
    s_waitcnt lgkmcnt(8)
    v_mfma_f32_16x16x32_bf16 v[40:43], a[32:35], a[40:43], 0
    ds_read_b64_tr_b16 a[24:25], v12 offset:13472
    v_mfma_f32_16x16x32_bf16 v[40:43], a[36:39], a[56:59], v[40:43]
    ds_read_b64_tr_b16 a[26:27], v12 offset:17056
    v_mfma_f32_16x16x32_bf16 v[44:47], a[36:39], a[60:63], 0
    v_mfma_f32_16x16x32_bf16 v[44:47], a[32:35], a[44:47], v[44:47]
    v_mfma_f32_16x16x32_bf16 v[48:51], a[32:35], a[48:51], 0
    ds_read_b64_tr_b16 a[28:29], v12 offset:33952
    v_mfma_f32_16x16x32_bf16 v[48:51], a[36:39], a[64:67], v[48:51]
    ds_read_b64_tr_b16 a[30:31], v12 offset:37536
    v_mfma_f32_16x16x32_bf16 v[52:55], a[36:39], a[68:71], 0
    v_mfma_f32_16x16x32_bf16 v[52:55], a[32:35], a[52:55], v[52:55]
    v_mfma_f32_16x16x32_bf16 v[68:71], a[0:3], a[52:55], 0
    ds_read_b64_tr_b16 a[32:33], v12 offset:13504
    v_mfma_f32_16x16x32_bf16 v[68:71], a[4:7], a[68:71], v[68:71]
    ds_read_b64_tr_b16 a[34:35], v12 offset:17088
    v_mfma_f32_16x16x32_bf16 v[64:67], a[4:7], a[64:67], 0
    ds_read_b64_tr_b16 a[36:37], v12 offset:33984
    v_mfma_f32_16x16x32_bf16 v[64:67], a[0:3], a[48:51], v[64:67]
    ds_read_b64_tr_b16 a[38:39], v12 offset:37568
    v_mfma_f32_16x16x32_bf16 v[60:63], a[0:3], a[44:47], 0
    v_mfma_f32_16x16x32_bf16 v[60:63], a[4:7], a[60:63], v[60:63]
    v_mfma_f32_16x16x32_bf16 v[56:59], a[4:7], a[56:59], 0
    s_waitcnt vmcnt(17) lgkmcnt(0)
    v_mfma_f32_16x16x32_bf16 v[56:59], a[0:3], a[40:43], v[56:59]
    s_barrier
    v_mfma_f32_16x16x32_bf16 v[72:75], a[8:11], a[40:43], 0
    ds_read_b64_tr_b16 a[0:1], v13 offset:0
    v_mfma_f32_16x16x32_bf16 v[72:75], a[12:15], a[56:59], v[72:75]
    ds_read_b64_tr_b16 a[2:3], v13 offset:3072
    v_mfma_f32_16x16x32_bf16 v[76:79], a[12:15], a[60:63], 0
    s_add_u32 m0, s69, 0
    v_mfma_f32_16x16x32_bf16 v[76:79], a[8:11], a[44:47], v[76:79]
    v_mfma_f32_16x16x32_bf16 v[80:83], a[8:11], a[48:51], 0
    ds_read_b64_tr_b16 a[4:5], v13 offset:20480
    v_mfma_f32_16x16x32_bf16 v[80:83], a[12:15], a[64:67], v[80:83]
    ds_read_b64_tr_b16 a[6:7], v13 offset:23552
    v_mfma_f32_16x16x32_bf16 v[84:87], a[12:15], a[68:71], 0
    buffer_load_dwordx4 v2, s[24:27], s60 offen offset:0  lds
    v_mfma_f32_16x16x32_bf16 v[84:87], a[8:11], a[52:55], v[84:87]
    v_mfma_f32_16x16x32_bf16 v[100:103], a[16:19], a[52:55], 0
    ds_read_b64_tr_b16 a[8:9], v14 offset:32
    v_mfma_f32_16x16x32_bf16 v[100:103], a[20:23], a[68:71], v[100:103]
    ds_read_b64_tr_b16 a[10:11], v14 offset:3104
    v_mfma_f32_16x16x32_bf16 v[96:99], a[20:23], a[64:67], 0
    buffer_load_dwordx4 v3, s[28:31], s61 offen offset:1024  lds
    v_mfma_f32_16x16x32_bf16 v[96:99], a[16:19], a[48:51], v[96:99]
    v_mfma_f32_16x16x32_bf16 v[92:95], a[16:19], a[44:47], 0
    ds_read_b64_tr_b16 a[12:13], v14 offset:20512
    v_mfma_f32_16x16x32_bf16 v[92:95], a[20:23], a[60:63], v[92:95]
    ds_read_b64_tr_b16 a[14:15], v14 offset:23584
    v_mfma_f32_16x16x32_bf16 v[88:91], a[20:23], a[56:59], 0
    buffer_load_dwordx4 v4, s[28:31], s61 offen offset:2048  lds
    v_mfma_f32_16x16x32_bf16 v[88:91], a[16:19], a[40:43], v[88:91]
    s_waitcnt lgkmcnt(8)
    v_mfma_f32_16x16x32_bf16 v[104:107], a[24:27], a[40:43], 0
    ds_read_b64_tr_b16 a[16:17], v13 offset:64
    v_mfma_f32_16x16x32_bf16 v[104:107], a[28:31], a[56:59], v[104:107]
    ds_read_b64_tr_b16 a[18:19], v13 offset:3136
    v_mfma_f32_16x16x32_bf16 v[108:111], a[28:31], a[60:63], 0
    v_mfma_f32_16x16x32_bf16 v[108:111], a[24:27], a[44:47], v[108:111]
    buffer_load_dwordx4 v5, s[32:35], s61 offen offset:3072  lds
    v_mfma_f32_16x16x32_bf16 v[112:115], a[24:27], a[48:51], 0
    ds_read_b64_tr_b16 a[20:21], v13 offset:20544
    v_mfma_f32_16x16x32_bf16 v[112:115], a[28:31], a[64:67], v[112:115]
    ds_read_b64_tr_b16 a[22:23], v13 offset:23616
    v_mfma_f32_16x16x32_bf16 v[116:119], a[28:31], a[68:71], 0
    v_mfma_f32_16x16x32_bf16 v[116:119], a[24:27], a[52:55], v[116:119]
    s_add_u32 m0, s69, 4096
    v_mfma_f32_16x16x32_bf16 v[132:135], a[32:35], a[52:55], 0
    ds_read_b64_tr_b16 a[24:25], v14 offset:96
    v_mfma_f32_16x16x32_bf16 v[132:135], a[36:39], a[68:71], v[132:135]
    ds_read_b64_tr_b16 a[26:27], v14 offset:3168
    v_mfma_f32_16x16x32_bf16 v[128:131], a[36:39], a[64:67], 0
    v_mfma_f32_16x16x32_bf16 v[128:131], a[32:35], a[48:51], v[128:131]
    buffer_load_dwordx4 v6, s[32:35], s61 offen offset:0  lds
    v_mfma_f32_16x16x32_bf16 v[124:127], a[32:35], a[44:47], 0
    ds_read_b64_tr_b16 a[28:29], v14 offset:20576
    v_mfma_f32_16x16x32_bf16 v[124:127], a[36:39], a[60:63], v[124:127]
    ds_read_b64_tr_b16 a[30:31], v14 offset:23648
    v_mfma_f32_16x16x32_bf16 v[120:123], a[36:39], a[56:59], 0
    v_mfma_f32_16x16x32_bf16 v[120:123], a[32:35], a[40:43], v[120:123]
    s_waitcnt vmcnt(6) lgkmcnt(8)
    v_mfma_f32_16x16x32_bf16 a[104:107], a[0:3], a[72:75], a[104:107]
    ds_read_b64_tr_b16 a[32:33], v13 offset:128
    v_mfma_f32_16x16x32_bf16 a[104:107], a[4:7], a[88:91], a[104:107]
    ds_read_b64_tr_b16 a[34:35], v13 offset:3200
    v_mfma_f32_16x16x32_bf16 a[108:111], a[4:7], a[92:95], a[108:111]
    s_add_u32 m0, s69, 20480
    v_mfma_f32_16x16x32_bf16 a[108:111], a[0:3], a[76:79], a[108:111]
    buffer_load_dwordx4 v248, s[24:27], s60 offen offset:0  lds
    v_mfma_f32_16x16x32_bf16 a[112:115], a[0:3], a[80:83], a[112:115]
    ds_read_b64_tr_b16 a[36:37], v13 offset:20608
    v_mfma_f32_16x16x32_bf16 a[112:115], a[4:7], a[96:99], a[112:115]
    ds_read_b64_tr_b16 a[38:39], v13 offset:23680
    v_mfma_f32_16x16x32_bf16 a[116:119], a[4:7], a[100:103], a[116:119]
    v_mfma_f32_16x16x32_bf16 a[116:119], a[0:3], a[84:87], a[116:119]
    buffer_load_dwordx4 v249, s[28:31], s61 offen offset:1024  lds
    v_mfma_f32_16x16x32_bf16 a[132:135], a[8:11], a[84:87], a[132:135]
    ds_read_b64_tr_b16 a[0:1], v14 offset:160
    v_mfma_f32_16x16x32_bf16 a[132:135], a[12:15], a[100:103], a[132:135]
    ds_read_b64_tr_b16 a[2:3], v14 offset:3232
    v_mfma_f32_16x16x32_bf16 a[128:131], a[12:15], a[96:99], a[128:131]
    buffer_load_dwordx4 v250, s[28:31], s61 offen offset:2048  lds
    v_mfma_f32_16x16x32_bf16 a[128:131], a[8:11], a[80:83], a[128:131]
    v_mfma_f32_16x16x32_bf16 a[124:127], a[8:11], a[76:79], a[124:127]
    ds_read_b64_tr_b16 a[4:5], v14 offset:20640
    v_mfma_f32_16x16x32_bf16 a[124:127], a[12:15], a[92:95], a[124:127]
    ds_read_b64_tr_b16 a[6:7], v14 offset:23712
    v_mfma_f32_16x16x32_bf16 a[120:123], a[12:15], a[88:91], a[120:123]
    buffer_load_dwordx4 v251, s[32:35], s61 offen offset:3072  lds
    v_mfma_f32_16x16x32_bf16 a[120:123], a[8:11], a[72:75], a[120:123]
    s_waitcnt lgkmcnt(8)
    v_mfma_f32_16x16x32_bf16 a[136:139], a[72:75], a[16:19], a[136:139]
    ds_read_b64_tr_b16 a[8:9], v15 offset:6144
    v_mfma_f32_16x16x32_bf16 a[136:139], a[88:91], a[20:23], a[136:139]
    ds_read_b64_tr_b16 a[10:11], v15 offset:9728
    v_mfma_f32_16x16x32_bf16 a[140:143], a[92:95], a[20:23], a[140:143]
    s_add_u32 m0, s69, 24576
    v_mfma_f32_16x16x32_bf16 a[140:143], a[76:79], a[16:19], a[140:143]
    v_mfma_f32_16x16x32_bf16 a[144:147], a[80:83], a[16:19], a[144:147]
    ds_read_b64_tr_b16 a[12:13], v15 offset:26624
    v_mfma_f32_16x16x32_bf16 a[144:147], a[96:99], a[20:23], a[144:147]
    ds_read_b64_tr_b16 a[14:15], v15 offset:30208
    v_mfma_f32_16x16x32_bf16 a[148:151], a[100:103], a[20:23], a[148:151]
    buffer_load_dwordx4 v252, s[32:35], s61 offen offset:0  lds
    v_mfma_f32_16x16x32_bf16 a[148:151], a[84:87], a[16:19], a[148:151]
    s_add_u32 s60, s60, s62
    v_mfma_f32_16x16x32_bf16 a[164:167], a[84:87], a[24:27], a[164:167]
    ds_read_b64_tr_b16 a[16:17], v15 offset:6176
    v_mfma_f32_16x16x32_bf16 a[164:167], a[100:103], a[28:31], a[164:167]
    ds_read_b64_tr_b16 a[18:19], v15 offset:9760
    v_mfma_f32_16x16x32_bf16 a[160:163], a[96:99], a[28:31], a[160:163]
    v_mfma_f32_16x16x32_bf16 a[160:163], a[80:83], a[24:27], a[160:163]
    s_add_u32 s61, s61, s63
    v_mfma_f32_16x16x32_bf16 a[156:159], a[76:79], a[24:27], a[156:159]
    ds_read_b64_tr_b16 a[20:21], v15 offset:26656
    v_mfma_f32_16x16x32_bf16 a[156:159], a[92:95], a[28:31], a[156:159]
    ds_read_b64_tr_b16 a[22:23], v15 offset:30240
    v_mfma_f32_16x16x32_bf16 a[152:155], a[88:91], a[28:31], a[152:155]
    v_mfma_f32_16x16x32_bf16 a[152:155], a[72:75], a[24:27], a[152:155]
    s_waitcnt lgkmcnt(8)
    v_mfma_f32_16x16x32_bf16 a[168:171], a[72:75], a[32:35], a[168:171]
    ds_read_b64_tr_b16 a[24:25], v15 offset:6208
    v_mfma_f32_16x16x32_bf16 a[168:171], a[88:91], a[36:39], a[168:171]
    ds_read_b64_tr_b16 a[26:27], v15 offset:9792
    v_mfma_f32_16x16x32_bf16 a[172:175], a[92:95], a[36:39], a[172:175]
    buffer_load_dword v23, v7, s[44:47], s71 offen
    v_mfma_f32_16x16x32_bf16 a[172:175], a[76:79], a[32:35], a[172:175]
    v_mfma_f32_16x16x32_bf16 a[176:179], a[80:83], a[32:35], a[176:179]
    ds_read_b64_tr_b16 a[28:29], v15 offset:26688
    v_mfma_f32_16x16x32_bf16 a[176:179], a[96:99], a[36:39], a[176:179]
    ds_read_b64_tr_b16 a[30:31], v15 offset:30272
    v_mfma_f32_16x16x32_bf16 a[180:183], a[100:103], a[36:39], a[180:183]
    s_add_u32 s71, s71, s72
    v_mfma_f32_16x16x32_bf16 a[180:183], a[84:87], a[32:35], a[180:183]
    v_mfma_f32_16x16x32_bf16 a[196:199], a[84:87], a[0:3], a[196:199]
    ds_read_b64_tr_b16 a[32:33], v15 offset:6240
    v_mfma_f32_16x16x32_bf16 a[196:199], a[100:103], a[4:7], a[196:199]
    ds_read_b64_tr_b16 a[34:35], v15 offset:9824
    v_mfma_f32_16x16x32_bf16 a[192:195], a[96:99], a[4:7], a[192:195]
    buffer_load_dwordx4 a[40:43], v16, s[36:39], s64 offen offset:0 sc1
    v_mfma_f32_16x16x32_bf16 a[192:195], a[80:83], a[0:3], a[192:195]
    v_mfma_f32_16x16x32_bf16 a[188:191], a[76:79], a[0:3], a[188:191]
    ds_read_b64_tr_b16 a[36:37], v15 offset:26720
    v_mfma_f32_16x16x32_bf16 a[188:191], a[92:95], a[4:7], a[188:191]
    ds_read_b64_tr_b16 a[38:39], v15 offset:30304
    v_mfma_f32_16x16x32_bf16 a[184:187], a[88:91], a[4:7], a[184:187]
    v_mfma_f32_16x16x32_bf16 a[184:187], a[72:75], a[0:3], a[184:187]
    s_waitcnt lgkmcnt(8)
    v_mfma_f32_16x16x32_bf16 v[136:139], a[8:11], a[72:75], v[136:139]
    ds_read_b64_tr_b16 a[0:1], v15 offset:6272
    v_mfma_f32_16x16x32_bf16 v[136:139], a[12:15], a[88:91], v[136:139]
    ds_read_b64_tr_b16 a[2:3], v15 offset:9856
    v_mfma_f32_16x16x32_bf16 v[164:167], a[12:15], a[92:95], v[164:167]
    buffer_load_dwordx4 a[56:59], v253, s[36:39], s64 offen offset:0 sc1
    v_mfma_f32_16x16x32_bf16 v[164:167], a[8:11], a[76:79], v[164:167]
    v_mfma_f32_16x16x32_bf16 v[192:195], a[8:11], a[80:83], v[192:195]
    ds_read_b64_tr_b16 a[4:5], v15 offset:26752
    v_mfma_f32_16x16x32_bf16 v[192:195], a[12:15], a[96:99], v[192:195]
    ds_read_b64_tr_b16 a[6:7], v15 offset:30336
    v_mfma_f32_16x16x32_bf16 v[220:223], a[12:15], a[100:103], v[220:223]
    v_mfma_f32_16x16x32_bf16 v[220:223], a[8:11], a[84:87], v[220:223]
    v_mfma_f32_16x16x32_bf16 v[224:227], a[16:19], a[84:87], v[224:227]
    ds_read_b64_tr_b16 a[8:9], v15 offset:6304
    v_mfma_f32_16x16x32_bf16 v[224:227], a[20:23], a[100:103], v[224:227]
    ds_read_b64_tr_b16 a[10:11], v15 offset:9888
    v_mfma_f32_16x16x32_bf16 v[196:199], a[20:23], a[96:99], v[196:199]
    buffer_load_dwordx4 a[44:47], v16, s[36:39], s64 offen offset:1024 sc1
    v_mfma_f32_16x16x32_bf16 v[196:199], a[16:19], a[80:83], v[196:199]
    v_mfma_f32_16x16x32_bf16 v[168:171], a[16:19], a[76:79], v[168:171]
    ds_read_b64_tr_b16 a[12:13], v15 offset:26784
    v_mfma_f32_16x16x32_bf16 v[168:171], a[20:23], a[92:95], v[168:171]
    ds_read_b64_tr_b16 a[14:15], v15 offset:30368
    v_mfma_f32_16x16x32_bf16 v[140:143], a[20:23], a[88:91], v[140:143]
    v_mfma_f32_16x16x32_bf16 v[140:143], a[16:19], a[72:75], v[140:143]
    s_waitcnt lgkmcnt(8)
    v_mfma_f32_16x16x32_bf16 v[144:147], a[24:27], a[72:75], v[144:147]
    ds_read_b64_tr_b16 a[16:17], v15 offset:6336
    v_mfma_f32_16x16x32_bf16 v[144:147], a[28:31], a[88:91], v[144:147]
    ds_read_b64_tr_b16 a[18:19], v15 offset:9920
    v_mfma_f32_16x16x32_bf16 v[172:175], a[28:31], a[92:95], v[172:175]
    v_mfma_f32_16x16x32_bf16 v[172:175], a[24:27], a[76:79], v[172:175]
    buffer_load_dwordx4 a[60:63], v253, s[36:39], s64 offen offset:1024 sc1
    v_mfma_f32_16x16x32_bf16 v[200:203], a[24:27], a[80:83], v[200:203]
    ds_read_b64_tr_b16 a[20:21], v15 offset:26816
    v_mfma_f32_16x16x32_bf16 v[200:203], a[28:31], a[96:99], v[200:203]
    ds_read_b64_tr_b16 a[22:23], v15 offset:30400
    v_mfma_f32_16x16x32_bf16 v[228:231], a[28:31], a[100:103], v[228:231]
    v_mfma_f32_16x16x32_bf16 v[228:231], a[24:27], a[84:87], v[228:231]
    v_mfma_f32_16x16x32_bf16 v[232:235], a[32:35], a[84:87], v[232:235]
    ds_read_b64_tr_b16 a[24:25], v15 offset:13312
    v_mfma_f32_16x16x32_bf16 v[232:235], a[36:39], a[100:103], v[232:235]
    ds_read_b64_tr_b16 a[26:27], v15 offset:16896
    v_mfma_f32_16x16x32_bf16 v[204:207], a[36:39], a[96:99], v[204:207]
    v_mfma_f32_16x16x32_bf16 v[204:207], a[32:35], a[80:83], v[204:207]
    buffer_load_dwordx4 a[48:51], v16, s[36:39], s64 offen offset:2048 sc1
    v_mfma_f32_16x16x32_bf16 v[176:179], a[32:35], a[76:79], v[176:179]
    ds_read_b64_tr_b16 a[28:29], v15 offset:33792
    v_mfma_f32_16x16x32_bf16 v[176:179], a[36:39], a[92:95], v[176:179]
    ds_read_b64_tr_b16 a[30:31], v15 offset:37376
    v_mfma_f32_16x16x32_bf16 v[148:151], a[36:39], a[88:91], v[148:151]
    v_mfma_f32_16x16x32_bf16 v[148:151], a[32:35], a[72:75], v[148:151]
    s_waitcnt lgkmcnt(8)
    v_mfma_f32_16x16x32_bf16 v[152:155], a[0:3], a[72:75], v[152:155]
    ds_read_b64_tr_b16 a[32:33], v15 offset:13344
    v_mfma_f32_16x16x32_bf16 v[152:155], a[4:7], a[88:91], v[152:155]
    ds_read_b64_tr_b16 a[34:35], v15 offset:16928
    v_mfma_f32_16x16x32_bf16 v[180:183], a[4:7], a[92:95], v[180:183]
    v_mfma_f32_16x16x32_bf16 v[180:183], a[0:3], a[76:79], v[180:183]
    v_mfma_f32_16x16x32_bf16 v[208:211], a[0:3], a[80:83], v[208:211]
    ds_read_b64_tr_b16 a[36:37], v15 offset:33824
    v_mfma_f32_16x16x32_bf16 v[208:211], a[4:7], a[96:99], v[208:211]
    ds_read_b64_tr_b16 a[38:39], v15 offset:37408
    v_mfma_f32_16x16x32_bf16 v[236:239], a[4:7], a[100:103], v[236:239]
    buffer_load_dwordx4 a[64:67], v253, s[36:39], s64 offen offset:2048 sc1
    v_mfma_f32_16x16x32_bf16 v[236:239], a[0:3], a[84:87], v[236:239]
    v_mfma_f32_16x16x32_bf16 v[240:243], a[8:11], a[84:87], v[240:243]
    ds_read_b64_tr_b16 a[0:1], v15 offset:13376
    v_mfma_f32_16x16x32_bf16 v[240:243], a[12:15], a[100:103], v[240:243]
    ds_read_b64_tr_b16 a[2:3], v15 offset:16960
    v_mfma_f32_16x16x32_bf16 v[212:215], a[12:15], a[96:99], v[212:215]
    v_mfma_f32_16x16x32_bf16 v[212:215], a[8:11], a[80:83], v[212:215]
    v_mfma_f32_16x16x32_bf16 v[184:187], a[8:11], a[76:79], v[184:187]
    ds_read_b64_tr_b16 a[4:5], v15 offset:33856
    v_mfma_f32_16x16x32_bf16 v[184:187], a[12:15], a[92:95], v[184:187]
    ds_read_b64_tr_b16 a[6:7], v15 offset:37440
    v_mfma_f32_16x16x32_bf16 v[156:159], a[12:15], a[88:91], v[156:159]
    buffer_load_dwordx4 a[52:55], v16, s[36:39], s64 offen offset:3072 sc1
    v_mfma_f32_16x16x32_bf16 v[156:159], a[8:11], a[72:75], v[156:159]
    s_waitcnt lgkmcnt(8)
    v_mfma_f32_16x16x32_bf16 v[160:163], a[16:19], a[72:75], v[160:163]
    ds_read_b64_tr_b16 a[8:9], v15 offset:13408
    v_mfma_f32_16x16x32_bf16 v[160:163], a[20:23], a[88:91], v[160:163]
    ds_read_b64_tr_b16 a[10:11], v15 offset:16992
    v_mfma_f32_16x16x32_bf16 v[188:191], a[20:23], a[92:95], v[188:191]
    v_mfma_f32_16x16x32_bf16 v[188:191], a[16:19], a[76:79], v[188:191]
    v_mfma_f32_16x16x32_bf16 v[216:219], a[16:19], a[80:83], v[216:219]
    ds_read_b64_tr_b16 a[12:13], v15 offset:33888
    v_mfma_f32_16x16x32_bf16 v[216:219], a[20:23], a[96:99], v[216:219]
    ds_read_b64_tr_b16 a[14:15], v15 offset:37472
    v_mfma_f32_16x16x32_bf16 v[244:247], a[20:23], a[100:103], v[244:247]
    v_mfma_f32_16x16x32_bf16 v[244:247], a[16:19], a[84:87], v[244:247]
    buffer_load_dwordx4 a[68:71], v253, s[36:39], s64 offen offset:3072 sc1
    v_mfma_f32_16x16x32_bf16 v[36:39], a[24:27], a[84:87], v[36:39]
    ds_read_b64_tr_b16 a[16:17], v15 offset:13440
    v_mfma_f32_16x16x32_bf16 v[36:39], a[28:31], a[100:103], v[36:39]
    ds_read_b64_tr_b16 a[18:19], v15 offset:17024
    v_mfma_f32_16x16x32_bf16 v[32:35], a[28:31], a[96:99], v[32:35]
    v_mfma_f32_16x16x32_bf16 v[32:35], a[24:27], a[80:83], v[32:35]
    v_mfma_f32_16x16x32_bf16 v[28:31], a[24:27], a[76:79], v[28:31]
    ds_read_b64_tr_b16 a[20:21], v15 offset:33920
    v_mfma_f32_16x16x32_bf16 v[28:31], a[28:31], a[92:95], v[28:31]
    ds_read_b64_tr_b16 a[22:23], v15 offset:37504
    v_mfma_f32_16x16x32_bf16 v[24:27], a[28:31], a[88:91], v[24:27]
    v_mfma_f32_16x16x32_bf16 v[24:27], a[24:27], a[72:75], v[24:27]
    s_waitcnt lgkmcnt(8)
    v_mfma_f32_16x16x32_bf16 v[40:43], a[32:35], a[72:75], v[40:43]
    ds_read_b64_tr_b16 a[24:25], v15 offset:13472
    v_mfma_f32_16x16x32_bf16 v[40:43], a[36:39], a[88:91], v[40:43]
    ds_read_b64_tr_b16 a[26:27], v15 offset:17056
    v_mfma_f32_16x16x32_bf16 v[44:47], a[36:39], a[92:95], v[44:47]
    s_add_u32 s64, s64, 8192
    v_mfma_f32_16x16x32_bf16 v[44:47], a[32:35], a[76:79], v[44:47]
    v_mfma_f32_16x16x32_bf16 v[48:51], a[32:35], a[80:83], v[48:51]
    ds_read_b64_tr_b16 a[28:29], v15 offset:33952
    v_mfma_f32_16x16x32_bf16 v[48:51], a[36:39], a[96:99], v[48:51]
    ds_read_b64_tr_b16 a[30:31], v15 offset:37536
    v_mfma_f32_16x16x32_bf16 v[52:55], a[36:39], a[100:103], v[52:55]
    v_mfma_f32_16x16x32_bf16 v[52:55], a[32:35], a[84:87], v[52:55]
    v_mfma_f32_16x16x32_bf16 v[68:71], a[0:3], a[84:87], v[68:71]
    ds_read_b64_tr_b16 a[32:33], v15 offset:13504
    v_mfma_f32_16x16x32_bf16 v[68:71], a[4:7], a[100:103], v[68:71]
    ds_read_b64_tr_b16 a[34:35], v15 offset:17088
    v_mfma_f32_16x16x32_bf16 v[64:67], a[4:7], a[96:99], v[64:67]
    ds_read_b64_tr_b16 a[36:37], v15 offset:33984
    v_mfma_f32_16x16x32_bf16 v[64:67], a[0:3], a[80:83], v[64:67]
    ds_read_b64_tr_b16 a[38:39], v15 offset:37568
    v_mfma_f32_16x16x32_bf16 v[60:63], a[0:3], a[76:79], v[60:63]
    v_mfma_f32_16x16x32_bf16 v[60:63], a[4:7], a[92:95], v[60:63]
    v_mfma_f32_16x16x32_bf16 v[56:59], a[4:7], a[88:91], v[56:59]
    s_waitcnt vmcnt(9) lgkmcnt(0)
    v_mfma_f32_16x16x32_bf16 v[56:59], a[0:3], a[72:75], v[56:59]
    s_barrier
    v_mfma_f32_16x16x32_bf16 v[72:75], a[8:11], a[72:75], v[72:75]
    ds_read_b64_tr_b16 a[0:1], v10 offset:0
    v_mfma_f32_16x16x32_bf16 v[72:75], a[12:15], a[88:91], v[72:75]
    ds_read_b64_tr_b16 a[2:3], v10 offset:3072
    v_mfma_f32_16x16x32_bf16 v[76:79], a[12:15], a[92:95], v[76:79]
    s_add_u32 m0, s69, 40960
    v_mfma_f32_16x16x32_bf16 v[76:79], a[8:11], a[76:79], v[76:79]
    v_mfma_f32_16x16x32_bf16 v[80:83], a[8:11], a[80:83], v[80:83]
    ds_read_b64_tr_b16 a[4:5], v10 offset:20480
    v_mfma_f32_16x16x32_bf16 v[80:83], a[12:15], a[96:99], v[80:83]
    ds_read_b64_tr_b16 a[6:7], v10 offset:23552
    v_mfma_f32_16x16x32_bf16 v[84:87], a[12:15], a[100:103], v[84:87]
    buffer_load_dwordx4 v2, s[24:27], s60 offen offset:0  lds
    v_mfma_f32_16x16x32_bf16 v[84:87], a[8:11], a[84:87], v[84:87]
    v_mfma_f32_16x16x32_bf16 v[100:103], a[16:19], a[84:87], v[100:103]
    ds_read_b64_tr_b16 a[8:9], v11 offset:32
    v_mfma_f32_16x16x32_bf16 v[100:103], a[20:23], a[100:103], v[100:103]
    ds_read_b64_tr_b16 a[10:11], v11 offset:3104
    v_mfma_f32_16x16x32_bf16 v[96:99], a[20:23], a[96:99], v[96:99]
    buffer_load_dwordx4 v3, s[28:31], s61 offen offset:1024  lds
    v_mfma_f32_16x16x32_bf16 v[96:99], a[16:19], a[80:83], v[96:99]
    v_mfma_f32_16x16x32_bf16 v[92:95], a[16:19], a[76:79], v[92:95]
    ds_read_b64_tr_b16 a[12:13], v11 offset:20512
    v_mfma_f32_16x16x32_bf16 v[92:95], a[20:23], a[92:95], v[92:95]
    ds_read_b64_tr_b16 a[14:15], v11 offset:23584
    v_mfma_f32_16x16x32_bf16 v[88:91], a[20:23], a[88:91], v[88:91]
    buffer_load_dwordx4 v4, s[28:31], s61 offen offset:2048  lds
    v_mfma_f32_16x16x32_bf16 v[88:91], a[16:19], a[72:75], v[88:91]
    s_waitcnt lgkmcnt(8)
    v_mfma_f32_16x16x32_bf16 v[104:107], a[24:27], a[72:75], v[104:107]
    ds_read_b64_tr_b16 a[16:17], v10 offset:64
    v_mfma_f32_16x16x32_bf16 v[104:107], a[28:31], a[88:91], v[104:107]
    ds_read_b64_tr_b16 a[18:19], v10 offset:3136
    v_mfma_f32_16x16x32_bf16 v[108:111], a[28:31], a[92:95], v[108:111]
    v_mfma_f32_16x16x32_bf16 v[108:111], a[24:27], a[76:79], v[108:111]
    buffer_load_dwordx4 v5, s[32:35], s61 offen offset:3072  lds
    v_mfma_f32_16x16x32_bf16 v[112:115], a[24:27], a[80:83], v[112:115]
    ds_read_b64_tr_b16 a[20:21], v10 offset:20544
    v_mfma_f32_16x16x32_bf16 v[112:115], a[28:31], a[96:99], v[112:115]
    ds_read_b64_tr_b16 a[22:23], v10 offset:23616
    v_mfma_f32_16x16x32_bf16 v[116:119], a[28:31], a[100:103], v[116:119]
    v_mfma_f32_16x16x32_bf16 v[116:119], a[24:27], a[84:87], v[116:119]
    s_add_u32 m0, s69, 45056
    v_mfma_f32_16x16x32_bf16 v[132:135], a[32:35], a[84:87], v[132:135]
    ds_read_b64_tr_b16 a[24:25], v11 offset:96
    v_mfma_f32_16x16x32_bf16 v[132:135], a[36:39], a[100:103], v[132:135]
    ds_read_b64_tr_b16 a[26:27], v11 offset:3168
    v_mfma_f32_16x16x32_bf16 v[128:131], a[36:39], a[96:99], v[128:131]
    v_mfma_f32_16x16x32_bf16 v[128:131], a[32:35], a[80:83], v[128:131]
    buffer_load_dwordx4 v6, s[32:35], s61 offen offset:0  lds
    v_mfma_f32_16x16x32_bf16 v[124:127], a[32:35], a[76:79], v[124:127]
    ds_read_b64_tr_b16 a[28:29], v11 offset:20576
    v_mfma_f32_16x16x32_bf16 v[124:127], a[36:39], a[92:95], v[124:127]
    ds_read_b64_tr_b16 a[30:31], v11 offset:23648
    v_mfma_f32_16x16x32_bf16 v[120:123], a[36:39], a[88:91], v[120:123]
    v_mfma_f32_16x16x32_bf16 v[120:123], a[32:35], a[72:75], v[120:123]
    s_waitcnt vmcnt(5) lgkmcnt(8)
.p2align 6
L_loop1:
    v_mfma_f32_16x16x32_bf16 a[104:107], a[0:3], a[40:43], a[104:107]
    ds_read_b64_tr_b16 a[32:33], v10 offset:128
    v_mfma_f32_16x16x32_bf16 a[104:107], a[4:7], a[56:59], a[104:107]
    ds_read_b64_tr_b16 a[34:35], v10 offset:3200
    v_mfma_f32_16x16x32_bf16 a[108:111], a[4:7], a[60:63], a[108:111]
    s_add_u32 m0, s69, 61440
    v_mfma_f32_16x16x32_bf16 a[108:111], a[0:3], a[44:47], a[108:111]
    buffer_load_dwordx4 v248, s[24:27], s60 offen offset:0  lds
    v_mfma_f32_16x16x32_bf16 a[112:115], a[0:3], a[48:51], a[112:115]
    ds_read_b64_tr_b16 a[36:37], v10 offset:20608
    v_mfma_f32_16x16x32_bf16 a[112:115], a[4:7], a[64:67], a[112:115]
    ds_read_b64_tr_b16 a[38:39], v10 offset:23680
    v_mfma_f32_16x16x32_bf16 a[116:119], a[4:7], a[68:71], a[116:119]
    v_mfma_f32_16x16x32_bf16 a[116:119], a[0:3], a[52:55], a[116:119]
    buffer_load_dwordx4 v249, s[28:31], s61 offen offset:1024  lds
    v_mfma_f32_16x16x32_bf16 a[132:135], a[8:11], a[52:55], a[132:135]
    ds_read_b64_tr_b16 a[0:1], v11 offset:160
    v_mfma_f32_16x16x32_bf16 a[132:135], a[12:15], a[68:71], a[132:135]
    ds_read_b64_tr_b16 a[2:3], v11 offset:3232
    v_mfma_f32_16x16x32_bf16 a[128:131], a[12:15], a[64:67], a[128:131]
    buffer_load_dwordx4 v250, s[28:31], s61 offen offset:2048  lds
    v_mfma_f32_16x16x32_bf16 a[128:131], a[8:11], a[48:51], a[128:131]
    v_mfma_f32_16x16x32_bf16 a[124:127], a[8:11], a[44:47], a[124:127]
    ds_read_b64_tr_b16 a[4:5], v11 offset:20640
    v_mfma_f32_16x16x32_bf16 a[124:127], a[12:15], a[60:63], a[124:127]
    ds_read_b64_tr_b16 a[6:7], v11 offset:23712
    v_mfma_f32_16x16x32_bf16 a[120:123], a[12:15], a[56:59], a[120:123]
    buffer_load_dwordx4 v251, s[32:35], s61 offen offset:3072  lds
    v_mfma_f32_16x16x32_bf16 a[120:123], a[8:11], a[40:43], a[120:123]
    s_waitcnt lgkmcnt(8)
    v_mfma_f32_16x16x32_bf16 a[136:139], a[40:43], a[16:19], a[136:139]
    ds_read_b64_tr_b16 a[8:9], v12 offset:6144
    v_mfma_f32_16x16x32_bf16 a[136:139], a[56:59], a[20:23], a[136:139]
    ds_read_b64_tr_b16 a[10:11], v12 offset:9728
    v_mfma_f32_16x16x32_bf16 a[140:143], a[60:63], a[20:23], a[140:143]
    s_add_u32 m0, s69, 65536
    v_mfma_f32_16x16x32_bf16 a[140:143], a[44:47], a[16:19], a[140:143]
    v_mfma_f32_16x16x32_bf16 a[144:147], a[48:51], a[16:19], a[144:147]
    ds_read_b64_tr_b16 a[12:13], v12 offset:26624
    v_mfma_f32_16x16x32_bf16 a[144:147], a[64:67], a[20:23], a[144:147]
    ds_read_b64_tr_b16 a[14:15], v12 offset:30208
    v_mfma_f32_16x16x32_bf16 a[148:151], a[68:71], a[20:23], a[148:151]
    buffer_load_dwordx4 v252, s[32:35], s61 offen offset:0  lds
    v_mfma_f32_16x16x32_bf16 a[148:151], a[52:55], a[16:19], a[148:151]
    s_add_u32 s60, s60, s62
    v_mfma_f32_16x16x32_bf16 a[164:167], a[52:55], a[24:27], a[164:167]
    ds_read_b64_tr_b16 a[16:17], v12 offset:6176
    v_mfma_f32_16x16x32_bf16 a[164:167], a[68:71], a[28:31], a[164:167]
    ds_read_b64_tr_b16 a[18:19], v12 offset:9760
    v_mfma_f32_16x16x32_bf16 a[160:163], a[64:67], a[28:31], a[160:163]
    v_mfma_f32_16x16x32_bf16 a[160:163], a[48:51], a[24:27], a[160:163]
    s_add_u32 s61, s61, s63
    v_mfma_f32_16x16x32_bf16 a[156:159], a[44:47], a[24:27], a[156:159]
    ds_read_b64_tr_b16 a[20:21], v12 offset:26656
    v_mfma_f32_16x16x32_bf16 a[156:159], a[60:63], a[28:31], a[156:159]
    ds_read_b64_tr_b16 a[22:23], v12 offset:30240
    v_mfma_f32_16x16x32_bf16 a[152:155], a[56:59], a[28:31], a[152:155]
    v_mfma_f32_16x16x32_bf16 a[152:155], a[40:43], a[24:27], a[152:155]
    s_waitcnt lgkmcnt(8)
    v_mfma_f32_16x16x32_bf16 a[168:171], a[40:43], a[32:35], a[168:171]
    ds_read_b64_tr_b16 a[24:25], v12 offset:6208
    v_mfma_f32_16x16x32_bf16 a[168:171], a[56:59], a[36:39], a[168:171]
    ds_read_b64_tr_b16 a[26:27], v12 offset:9792
    v_mfma_f32_16x16x32_bf16 a[172:175], a[60:63], a[36:39], a[172:175]
    buffer_load_dword v23, v7, s[44:47], s71 offen
    v_mfma_f32_16x16x32_bf16 a[172:175], a[44:47], a[32:35], a[172:175]
    v_mfma_f32_16x16x32_bf16 a[176:179], a[48:51], a[32:35], a[176:179]
    ds_read_b64_tr_b16 a[28:29], v12 offset:26688
    v_mfma_f32_16x16x32_bf16 a[176:179], a[64:67], a[36:39], a[176:179]
    ds_read_b64_tr_b16 a[30:31], v12 offset:30272
    v_mfma_f32_16x16x32_bf16 a[180:183], a[68:71], a[36:39], a[180:183]
    s_add_u32 s71, s71, s72
    v_mfma_f32_16x16x32_bf16 a[180:183], a[52:55], a[32:35], a[180:183]
    v_mfma_f32_16x16x32_bf16 a[196:199], a[52:55], a[0:3], a[196:199]
    ds_read_b64_tr_b16 a[32:33], v12 offset:6240
    v_mfma_f32_16x16x32_bf16 a[196:199], a[68:71], a[4:7], a[196:199]
    ds_read_b64_tr_b16 a[34:35], v12 offset:9824
    v_mfma_f32_16x16x32_bf16 a[192:195], a[64:67], a[4:7], a[192:195]
    buffer_load_dwordx4 a[72:75], v16, s[36:39], s64 offen offset:0 sc1
    v_mfma_f32_16x16x32_bf16 a[192:195], a[48:51], a[0:3], a[192:195]
    v_mfma_f32_16x16x32_bf16 a[188:191], a[44:47], a[0:3], a[188:191]
    ds_read_b64_tr_b16 a[36:37], v12 offset:26720
    v_mfma_f32_16x16x32_bf16 a[188:191], a[60:63], a[4:7], a[188:191]
    ds_read_b64_tr_b16 a[38:39], v12 offset:30304
    v_mfma_f32_16x16x32_bf16 a[184:187], a[56:59], a[4:7], a[184:187]
    v_mfma_f32_16x16x32_bf16 a[184:187], a[40:43], a[0:3], a[184:187]
    s_waitcnt lgkmcnt(8)
    v_mfma_f32_16x16x32_bf16 v[136:139], a[8:11], a[40:43], v[136:139]
    ds_read_b64_tr_b16 a[0:1], v12 offset:6272
    v_mfma_f32_16x16x32_bf16 v[136:139], a[12:15], a[56:59], v[136:139]
    ds_read_b64_tr_b16 a[2:3], v12 offset:9856
    v_mfma_f32_16x16x32_bf16 v[164:167], a[12:15], a[60:63], v[164:167]
    buffer_load_dwordx4 a[88:91], v253, s[36:39], s64 offen offset:0 sc1
    v_mfma_f32_16x16x32_bf16 v[164:167], a[8:11], a[44:47], v[164:167]
    v_mfma_f32_16x16x32_bf16 v[192:195], a[8:11], a[48:51], v[192:195]
    ds_read_b64_tr_b16 a[4:5], v12 offset:26752
    v_mfma_f32_16x16x32_bf16 v[192:195], a[12:15], a[64:67], v[192:195]
    ds_read_b64_tr_b16 a[6:7], v12 offset:30336
    v_mfma_f32_16x16x32_bf16 v[220:223], a[12:15], a[68:71], v[220:223]
    v_mfma_f32_16x16x32_bf16 v[220:223], a[8:11], a[52:55], v[220:223]
    v_mfma_f32_16x16x32_bf16 v[224:227], a[16:19], a[52:55], v[224:227]
    ds_read_b64_tr_b16 a[8:9], v12 offset:6304
    v_mfma_f32_16x16x32_bf16 v[224:227], a[20:23], a[68:71], v[224:227]
    ds_read_b64_tr_b16 a[10:11], v12 offset:9888
    v_mfma_f32_16x16x32_bf16 v[196:199], a[20:23], a[64:67], v[196:199]
    buffer_load_dwordx4 a[76:79], v16, s[36:39], s64 offen offset:1024 sc1
    v_mfma_f32_16x16x32_bf16 v[196:199], a[16:19], a[48:51], v[196:199]
    v_mfma_f32_16x16x32_bf16 v[168:171], a[16:19], a[44:47], v[168:171]
    ds_read_b64_tr_b16 a[12:13], v12 offset:26784
    v_mfma_f32_16x16x32_bf16 v[168:171], a[20:23], a[60:63], v[168:171]
    ds_read_b64_tr_b16 a[14:15], v12 offset:30368
    v_mfma_f32_16x16x32_bf16 v[140:143], a[20:23], a[56:59], v[140:143]
    v_mfma_f32_16x16x32_bf16 v[140:143], a[16:19], a[40:43], v[140:143]
    s_waitcnt lgkmcnt(8)
    v_mfma_f32_16x16x32_bf16 v[144:147], a[24:27], a[40:43], v[144:147]
    ds_read_b64_tr_b16 a[16:17], v12 offset:6336
    v_mfma_f32_16x16x32_bf16 v[144:147], a[28:31], a[56:59], v[144:147]
    ds_read_b64_tr_b16 a[18:19], v12 offset:9920
    v_mfma_f32_16x16x32_bf16 v[172:175], a[28:31], a[60:63], v[172:175]
    v_mfma_f32_16x16x32_bf16 v[172:175], a[24:27], a[44:47], v[172:175]
    buffer_load_dwordx4 a[92:95], v253, s[36:39], s64 offen offset:1024 sc1
    v_mfma_f32_16x16x32_bf16 v[200:203], a[24:27], a[48:51], v[200:203]
    ds_read_b64_tr_b16 a[20:21], v12 offset:26816
    v_mfma_f32_16x16x32_bf16 v[200:203], a[28:31], a[64:67], v[200:203]
    ds_read_b64_tr_b16 a[22:23], v12 offset:30400
    v_mfma_f32_16x16x32_bf16 v[228:231], a[28:31], a[68:71], v[228:231]
    v_mfma_f32_16x16x32_bf16 v[228:231], a[24:27], a[52:55], v[228:231]
    v_mfma_f32_16x16x32_bf16 v[232:235], a[32:35], a[52:55], v[232:235]
    ds_read_b64_tr_b16 a[24:25], v12 offset:13312
    v_mfma_f32_16x16x32_bf16 v[232:235], a[36:39], a[68:71], v[232:235]
    ds_read_b64_tr_b16 a[26:27], v12 offset:16896
    v_mfma_f32_16x16x32_bf16 v[204:207], a[36:39], a[64:67], v[204:207]
    v_mfma_f32_16x16x32_bf16 v[204:207], a[32:35], a[48:51], v[204:207]
    buffer_load_dwordx4 a[80:83], v16, s[36:39], s64 offen offset:2048 sc1
    v_mfma_f32_16x16x32_bf16 v[176:179], a[32:35], a[44:47], v[176:179]
    ds_read_b64_tr_b16 a[28:29], v12 offset:33792
    v_mfma_f32_16x16x32_bf16 v[176:179], a[36:39], a[60:63], v[176:179]
    ds_read_b64_tr_b16 a[30:31], v12 offset:37376
    v_mfma_f32_16x16x32_bf16 v[148:151], a[36:39], a[56:59], v[148:151]
    v_mfma_f32_16x16x32_bf16 v[148:151], a[32:35], a[40:43], v[148:151]
    s_waitcnt lgkmcnt(8)
    v_mfma_f32_16x16x32_bf16 v[152:155], a[0:3], a[40:43], v[152:155]
    ds_read_b64_tr_b16 a[32:33], v12 offset:13344
    v_mfma_f32_16x16x32_bf16 v[152:155], a[4:7], a[56:59], v[152:155]
    ds_read_b64_tr_b16 a[34:35], v12 offset:16928
    v_mfma_f32_16x16x32_bf16 v[180:183], a[4:7], a[60:63], v[180:183]
    v_mfma_f32_16x16x32_bf16 v[180:183], a[0:3], a[44:47], v[180:183]
    v_mfma_f32_16x16x32_bf16 v[208:211], a[0:3], a[48:51], v[208:211]
    ds_read_b64_tr_b16 a[36:37], v12 offset:33824
    v_mfma_f32_16x16x32_bf16 v[208:211], a[4:7], a[64:67], v[208:211]
    ds_read_b64_tr_b16 a[38:39], v12 offset:37408
    v_mfma_f32_16x16x32_bf16 v[236:239], a[4:7], a[68:71], v[236:239]
    buffer_load_dwordx4 a[96:99], v253, s[36:39], s64 offen offset:2048 sc1
    v_mfma_f32_16x16x32_bf16 v[236:239], a[0:3], a[52:55], v[236:239]
    v_mfma_f32_16x16x32_bf16 v[240:243], a[8:11], a[52:55], v[240:243]
    ds_read_b64_tr_b16 a[0:1], v12 offset:13376
    v_mfma_f32_16x16x32_bf16 v[240:243], a[12:15], a[68:71], v[240:243]
    ds_read_b64_tr_b16 a[2:3], v12 offset:16960
    v_mfma_f32_16x16x32_bf16 v[212:215], a[12:15], a[64:67], v[212:215]
    v_mfma_f32_16x16x32_bf16 v[212:215], a[8:11], a[48:51], v[212:215]
    v_mfma_f32_16x16x32_bf16 v[184:187], a[8:11], a[44:47], v[184:187]
    ds_read_b64_tr_b16 a[4:5], v12 offset:33856
    v_mfma_f32_16x16x32_bf16 v[184:187], a[12:15], a[60:63], v[184:187]
    ds_read_b64_tr_b16 a[6:7], v12 offset:37440
    v_mfma_f32_16x16x32_bf16 v[156:159], a[12:15], a[56:59], v[156:159]
    buffer_load_dwordx4 a[84:87], v16, s[36:39], s64 offen offset:3072 sc1
    v_mfma_f32_16x16x32_bf16 v[156:159], a[8:11], a[40:43], v[156:159]
    s_waitcnt lgkmcnt(8)
    v_mfma_f32_16x16x32_bf16 v[160:163], a[16:19], a[40:43], v[160:163]
    ds_read_b64_tr_b16 a[8:9], v12 offset:13408
    v_mfma_f32_16x16x32_bf16 v[160:163], a[20:23], a[56:59], v[160:163]
    ds_read_b64_tr_b16 a[10:11], v12 offset:16992
    v_mfma_f32_16x16x32_bf16 v[188:191], a[20:23], a[60:63], v[188:191]
    v_mfma_f32_16x16x32_bf16 v[188:191], a[16:19], a[44:47], v[188:191]
    v_mfma_f32_16x16x32_bf16 v[216:219], a[16:19], a[48:51], v[216:219]
    ds_read_b64_tr_b16 a[12:13], v12 offset:33888
    v_mfma_f32_16x16x32_bf16 v[216:219], a[20:23], a[64:67], v[216:219]
    ds_read_b64_tr_b16 a[14:15], v12 offset:37472
    v_mfma_f32_16x16x32_bf16 v[244:247], a[20:23], a[68:71], v[244:247]
    v_mfma_f32_16x16x32_bf16 v[244:247], a[16:19], a[52:55], v[244:247]
    buffer_load_dwordx4 a[100:103], v253, s[36:39], s64 offen offset:3072 sc1
    v_mfma_f32_16x16x32_bf16 v[36:39], a[24:27], a[52:55], v[36:39]
    ds_read_b64_tr_b16 a[16:17], v12 offset:13440
    v_mfma_f32_16x16x32_bf16 v[36:39], a[28:31], a[68:71], v[36:39]
    ds_read_b64_tr_b16 a[18:19], v12 offset:17024
    v_mfma_f32_16x16x32_bf16 v[32:35], a[28:31], a[64:67], v[32:35]
    v_mfma_f32_16x16x32_bf16 v[32:35], a[24:27], a[48:51], v[32:35]
    v_mfma_f32_16x16x32_bf16 v[28:31], a[24:27], a[44:47], v[28:31]
    ds_read_b64_tr_b16 a[20:21], v12 offset:33920
    v_mfma_f32_16x16x32_bf16 v[28:31], a[28:31], a[60:63], v[28:31]
    ds_read_b64_tr_b16 a[22:23], v12 offset:37504
    v_mfma_f32_16x16x32_bf16 v[24:27], a[28:31], a[56:59], v[24:27]
    v_mfma_f32_16x16x32_bf16 v[24:27], a[24:27], a[40:43], v[24:27]
    s_waitcnt lgkmcnt(8)
    v_mfma_f32_16x16x32_bf16 v[40:43], a[32:35], a[40:43], v[40:43]
    ds_read_b64_tr_b16 a[24:25], v12 offset:13472
    v_mfma_f32_16x16x32_bf16 v[40:43], a[36:39], a[56:59], v[40:43]
    ds_read_b64_tr_b16 a[26:27], v12 offset:17056
    v_mfma_f32_16x16x32_bf16 v[44:47], a[36:39], a[60:63], v[44:47]
    s_add_u32 s64, s64, 8192
    v_mfma_f32_16x16x32_bf16 v[44:47], a[32:35], a[44:47], v[44:47]
    v_mfma_f32_16x16x32_bf16 v[48:51], a[32:35], a[48:51], v[48:51]
    ds_read_b64_tr_b16 a[28:29], v12 offset:33952
    v_mfma_f32_16x16x32_bf16 v[48:51], a[36:39], a[64:67], v[48:51]
    ds_read_b64_tr_b16 a[30:31], v12 offset:37536
    v_mfma_f32_16x16x32_bf16 v[52:55], a[36:39], a[68:71], v[52:55]
    v_mfma_f32_16x16x32_bf16 v[52:55], a[32:35], a[52:55], v[52:55]
    v_mfma_f32_16x16x32_bf16 v[68:71], a[0:3], a[52:55], v[68:71]
    ds_read_b64_tr_b16 a[32:33], v12 offset:13504
    v_mfma_f32_16x16x32_bf16 v[68:71], a[4:7], a[68:71], v[68:71]
    ds_read_b64_tr_b16 a[34:35], v12 offset:17088
    v_mfma_f32_16x16x32_bf16 v[64:67], a[4:7], a[64:67], v[64:67]
    ds_read_b64_tr_b16 a[36:37], v12 offset:33984
    v_mfma_f32_16x16x32_bf16 v[64:67], a[0:3], a[48:51], v[64:67]
    ds_read_b64_tr_b16 a[38:39], v12 offset:37568
    v_mfma_f32_16x16x32_bf16 v[60:63], a[0:3], a[44:47], v[60:63]
    v_mfma_f32_16x16x32_bf16 v[60:63], a[4:7], a[60:63], v[60:63]
    v_mfma_f32_16x16x32_bf16 v[56:59], a[4:7], a[56:59], v[56:59]
    s_waitcnt vmcnt(9) lgkmcnt(0)
    v_mfma_f32_16x16x32_bf16 v[56:59], a[0:3], a[40:43], v[56:59]
    s_barrier
    v_mfma_f32_16x16x32_bf16 v[72:75], a[8:11], a[40:43], v[72:75]
    ds_read_b64_tr_b16 a[0:1], v13 offset:0
    v_mfma_f32_16x16x32_bf16 v[72:75], a[12:15], a[56:59], v[72:75]
    ds_read_b64_tr_b16 a[2:3], v13 offset:3072
    v_mfma_f32_16x16x32_bf16 v[76:79], a[12:15], a[60:63], v[76:79]
    s_add_u32 m0, s69, 0
    v_mfma_f32_16x16x32_bf16 v[76:79], a[8:11], a[44:47], v[76:79]
    v_mfma_f32_16x16x32_bf16 v[80:83], a[8:11], a[48:51], v[80:83]
    ds_read_b64_tr_b16 a[4:5], v13 offset:20480
    v_mfma_f32_16x16x32_bf16 v[80:83], a[12:15], a[64:67], v[80:83]
    ds_read_b64_tr_b16 a[6:7], v13 offset:23552
    v_mfma_f32_16x16x32_bf16 v[84:87], a[12:15], a[68:71], v[84:87]
    buffer_load_dwordx4 v2, s[24:27], s60 offen offset:0  lds
    v_mfma_f32_16x16x32_bf16 v[84:87], a[8:11], a[52:55], v[84:87]
    v_mfma_f32_16x16x32_bf16 v[100:103], a[16:19], a[52:55], v[100:103]
    ds_read_b64_tr_b16 a[8:9], v14 offset:32
    v_mfma_f32_16x16x32_bf16 v[100:103], a[20:23], a[68:71], v[100:103]
    ds_read_b64_tr_b16 a[10:11], v14 offset:3104
    v_mfma_f32_16x16x32_bf16 v[96:99], a[20:23], a[64:67], v[96:99]
    buffer_load_dwordx4 v3, s[28:31], s61 offen offset:1024  lds
    v_mfma_f32_16x16x32_bf16 v[96:99], a[16:19], a[48:51], v[96:99]
    v_mfma_f32_16x16x32_bf16 v[92:95], a[16:19], a[44:47], v[92:95]
    ds_read_b64_tr_b16 a[12:13], v14 offset:20512
    v_mfma_f32_16x16x32_bf16 v[92:95], a[20:23], a[60:63], v[92:95]
    ds_read_b64_tr_b16 a[14:15], v14 offset:23584
    v_mfma_f32_16x16x32_bf16 v[88:91], a[20:23], a[56:59], v[88:91]
    buffer_load_dwordx4 v4, s[28:31], s61 offen offset:2048  lds
    v_mfma_f32_16x16x32_bf16 v[88:91], a[16:19], a[40:43], v[88:91]
    s_waitcnt lgkmcnt(8)
    v_mfma_f32_16x16x32_bf16 v[104:107], a[24:27], a[40:43], v[104:107]
    ds_read_b64_tr_b16 a[16:17], v13 offset:64
    v_mfma_f32_16x16x32_bf16 v[104:107], a[28:31], a[56:59], v[104:107]
    ds_read_b64_tr_b16 a[18:19], v13 offset:3136
    v_mfma_f32_16x16x32_bf16 v[108:111], a[28:31], a[60:63], v[108:111]
    v_mfma_f32_16x16x32_bf16 v[108:111], a[24:27], a[44:47], v[108:111]
    buffer_load_dwordx4 v5, s[32:35], s61 offen offset:3072  lds
    v_mfma_f32_16x16x32_bf16 v[112:115], a[24:27], a[48:51], v[112:115]
    ds_read_b64_tr_b16 a[20:21], v13 offset:20544
    v_mfma_f32_16x16x32_bf16 v[112:115], a[28:31], a[64:67], v[112:115]
    ds_read_b64_tr_b16 a[22:23], v13 offset:23616
    v_mfma_f32_16x16x32_bf16 v[116:119], a[28:31], a[68:71], v[116:119]
    v_mfma_f32_16x16x32_bf16 v[116:119], a[24:27], a[52:55], v[116:119]
    s_add_u32 m0, s69, 4096
    v_mfma_f32_16x16x32_bf16 v[132:135], a[32:35], a[52:55], v[132:135]
    ds_read_b64_tr_b16 a[24:25], v14 offset:96
    v_mfma_f32_16x16x32_bf16 v[132:135], a[36:39], a[68:71], v[132:135]
    ds_read_b64_tr_b16 a[26:27], v14 offset:3168
    v_mfma_f32_16x16x32_bf16 v[128:131], a[36:39], a[64:67], v[128:131]
    v_mfma_f32_16x16x32_bf16 v[128:131], a[32:35], a[48:51], v[128:131]
    buffer_load_dwordx4 v6, s[32:35], s61 offen offset:0  lds
    v_mfma_f32_16x16x32_bf16 v[124:127], a[32:35], a[44:47], v[124:127]
    ds_read_b64_tr_b16 a[28:29], v14 offset:20576
    v_mfma_f32_16x16x32_bf16 v[124:127], a[36:39], a[60:63], v[124:127]
    ds_read_b64_tr_b16 a[30:31], v14 offset:23648
    v_mfma_f32_16x16x32_bf16 v[120:123], a[36:39], a[56:59], v[120:123]
    v_mfma_f32_16x16x32_bf16 v[120:123], a[32:35], a[40:43], v[120:123]
    s_waitcnt vmcnt(5) lgkmcnt(8)
    v_mfma_f32_16x16x32_bf16 a[104:107], a[0:3], a[72:75], a[104:107]
    ds_read_b64_tr_b16 a[32:33], v13 offset:128
    v_mfma_f32_16x16x32_bf16 a[104:107], a[4:7], a[88:91], a[104:107]
    ds_read_b64_tr_b16 a[34:35], v13 offset:3200
    v_mfma_f32_16x16x32_bf16 a[108:111], a[4:7], a[92:95], a[108:111]
    s_add_u32 m0, s69, 20480
    v_mfma_f32_16x16x32_bf16 a[108:111], a[0:3], a[76:79], a[108:111]
    buffer_load_dwordx4 v248, s[24:27], s60 offen offset:0  lds
    v_mfma_f32_16x16x32_bf16 a[112:115], a[0:3], a[80:83], a[112:115]
    ds_read_b64_tr_b16 a[36:37], v13 offset:20608
    v_mfma_f32_16x16x32_bf16 a[112:115], a[4:7], a[96:99], a[112:115]
    ds_read_b64_tr_b16 a[38:39], v13 offset:23680
    v_mfma_f32_16x16x32_bf16 a[116:119], a[4:7], a[100:103], a[116:119]
    v_mfma_f32_16x16x32_bf16 a[116:119], a[0:3], a[84:87], a[116:119]
    buffer_load_dwordx4 v249, s[28:31], s61 offen offset:1024  lds
    v_mfma_f32_16x16x32_bf16 a[132:135], a[8:11], a[84:87], a[132:135]
    ds_read_b64_tr_b16 a[0:1], v14 offset:160
    v_mfma_f32_16x16x32_bf16 a[132:135], a[12:15], a[100:103], a[132:135]
    ds_read_b64_tr_b16 a[2:3], v14 offset:3232
    v_mfma_f32_16x16x32_bf16 a[128:131], a[12:15], a[96:99], a[128:131]
    buffer_load_dwordx4 v250, s[28:31], s61 offen offset:2048  lds
    v_mfma_f32_16x16x32_bf16 a[128:131], a[8:11], a[80:83], a[128:131]
    v_mfma_f32_16x16x32_bf16 a[124:127], a[8:11], a[76:79], a[124:127]
    ds_read_b64_tr_b16 a[4:5], v14 offset:20640
    v_mfma_f32_16x16x32_bf16 a[124:127], a[12:15], a[92:95], a[124:127]
    ds_read_b64_tr_b16 a[6:7], v14 offset:23712
    v_mfma_f32_16x16x32_bf16 a[120:123], a[12:15], a[88:91], a[120:123]
    buffer_load_dwordx4 v251, s[32:35], s61 offen offset:3072  lds
    v_mfma_f32_16x16x32_bf16 a[120:123], a[8:11], a[72:75], a[120:123]
    s_waitcnt lgkmcnt(8)
    v_mfma_f32_16x16x32_bf16 a[136:139], a[72:75], a[16:19], a[136:139]
    ds_read_b64_tr_b16 a[8:9], v15 offset:6144
    v_mfma_f32_16x16x32_bf16 a[136:139], a[88:91], a[20:23], a[136:139]
    ds_read_b64_tr_b16 a[10:11], v15 offset:9728
    v_mfma_f32_16x16x32_bf16 a[140:143], a[92:95], a[20:23], a[140:143]
    s_add_u32 m0, s69, 24576
    v_mfma_f32_16x16x32_bf16 a[140:143], a[76:79], a[16:19], a[140:143]
    v_mfma_f32_16x16x32_bf16 a[144:147], a[80:83], a[16:19], a[144:147]
    ds_read_b64_tr_b16 a[12:13], v15 offset:26624
    v_mfma_f32_16x16x32_bf16 a[144:147], a[96:99], a[20:23], a[144:147]
    ds_read_b64_tr_b16 a[14:15], v15 offset:30208
    v_mfma_f32_16x16x32_bf16 a[148:151], a[100:103], a[20:23], a[148:151]
    buffer_load_dwordx4 v252, s[32:35], s61 offen offset:0  lds
    v_mfma_f32_16x16x32_bf16 a[148:151], a[84:87], a[16:19], a[148:151]
    s_add_u32 s60, s60, s62
    v_mfma_f32_16x16x32_bf16 a[164:167], a[84:87], a[24:27], a[164:167]
    ds_read_b64_tr_b16 a[16:17], v15 offset:6176
    v_mfma_f32_16x16x32_bf16 a[164:167], a[100:103], a[28:31], a[164:167]
    ds_read_b64_tr_b16 a[18:19], v15 offset:9760
    v_mfma_f32_16x16x32_bf16 a[160:163], a[96:99], a[28:31], a[160:163]
    v_mfma_f32_16x16x32_bf16 a[160:163], a[80:83], a[24:27], a[160:163]
    s_add_u32 s61, s61, s63
    v_mfma_f32_16x16x32_bf16 a[156:159], a[76:79], a[24:27], a[156:159]
    ds_read_b64_tr_b16 a[20:21], v15 offset:26656
    v_mfma_f32_16x16x32_bf16 a[156:159], a[92:95], a[28:31], a[156:159]
    ds_read_b64_tr_b16 a[22:23], v15 offset:30240
    v_mfma_f32_16x16x32_bf16 a[152:155], a[88:91], a[28:31], a[152:155]
    v_mfma_f32_16x16x32_bf16 a[152:155], a[72:75], a[24:27], a[152:155]
    s_waitcnt lgkmcnt(8)
    v_mfma_f32_16x16x32_bf16 a[168:171], a[72:75], a[32:35], a[168:171]
    ds_read_b64_tr_b16 a[24:25], v15 offset:6208
    v_mfma_f32_16x16x32_bf16 a[168:171], a[88:91], a[36:39], a[168:171]
    ds_read_b64_tr_b16 a[26:27], v15 offset:9792
    v_mfma_f32_16x16x32_bf16 a[172:175], a[92:95], a[36:39], a[172:175]
    s_cmp_eq_u32 s71, s73
    s_cbranch_scc0 L_sw1
    s_mov_b32 s44, s8
    s_mov_b32 s45, s89
    s_mov_b32 s46, 2097152
    s_mov_b32 s71, 0
    s_mov_b32 s72, 1048576
    s_lshl_b32 s84, s2, 12
    v_add_u32 v7, s84, v17
L_sw1:
    v_mfma_f32_16x16x32_bf16 a[172:175], a[76:79], a[32:35], a[172:175]
    v_mfma_f32_16x16x32_bf16 a[176:179], a[80:83], a[32:35], a[176:179]
    ds_read_b64_tr_b16 a[28:29], v15 offset:26688
    v_mfma_f32_16x16x32_bf16 a[176:179], a[96:99], a[36:39], a[176:179]
    ds_read_b64_tr_b16 a[30:31], v15 offset:30272
    v_mfma_f32_16x16x32_bf16 a[180:183], a[100:103], a[36:39], a[180:183]
    v_mfma_f32_16x16x32_bf16 a[180:183], a[84:87], a[32:35], a[180:183]
    v_mfma_f32_16x16x32_bf16 a[196:199], a[84:87], a[0:3], a[196:199]
    ds_read_b64_tr_b16 a[32:33], v15 offset:6240
    v_mfma_f32_16x16x32_bf16 a[196:199], a[100:103], a[4:7], a[196:199]
    ds_read_b64_tr_b16 a[34:35], v15 offset:9824
    v_mfma_f32_16x16x32_bf16 a[192:195], a[96:99], a[4:7], a[192:195]
    buffer_load_dwordx4 a[40:43], v16, s[36:39], s64 offen offset:0 sc1
    v_mfma_f32_16x16x32_bf16 a[192:195], a[80:83], a[0:3], a[192:195]
    v_mfma_f32_16x16x32_bf16 a[188:191], a[76:79], a[0:3], a[188:191]
    ds_read_b64_tr_b16 a[36:37], v15 offset:26720
    v_mfma_f32_16x16x32_bf16 a[188:191], a[92:95], a[4:7], a[188:191]
    ds_read_b64_tr_b16 a[38:39], v15 offset:30304
    v_mfma_f32_16x16x32_bf16 a[184:187], a[88:91], a[4:7], a[184:187]
    v_mfma_f32_16x16x32_bf16 a[184:187], a[72:75], a[0:3], a[184:187]
    s_waitcnt lgkmcnt(8)
    v_mfma_f32_16x16x32_bf16 v[136:139], a[8:11], a[72:75], v[136:139]
    ds_read_b64_tr_b16 a[0:1], v15 offset:6272
    v_mfma_f32_16x16x32_bf16 v[136:139], a[12:15], a[88:91], v[136:139]
    ds_read_b64_tr_b16 a[2:3], v15 offset:9856
    v_mfma_f32_16x16x32_bf16 v[164:167], a[12:15], a[92:95], v[164:167]
    buffer_load_dwordx4 a[56:59], v253, s[36:39], s64 offen offset:0 sc1
    v_mfma_f32_16x16x32_bf16 v[164:167], a[8:11], a[76:79], v[164:167]
    v_mfma_f32_16x16x32_bf16 v[192:195], a[8:11], a[80:83], v[192:195]
    ds_read_b64_tr_b16 a[4:5], v15 offset:26752
    v_mfma_f32_16x16x32_bf16 v[192:195], a[12:15], a[96:99], v[192:195]
    ds_read_b64_tr_b16 a[6:7], v15 offset:30336
    v_mfma_f32_16x16x32_bf16 v[220:223], a[12:15], a[100:103], v[220:223]
    v_mfma_f32_16x16x32_bf16 v[220:223], a[8:11], a[84:87], v[220:223]
    v_mfma_f32_16x16x32_bf16 v[224:227], a[16:19], a[84:87], v[224:227]
    ds_read_b64_tr_b16 a[8:9], v15 offset:6304
    v_mfma_f32_16x16x32_bf16 v[224:227], a[20:23], a[100:103], v[224:227]
    ds_read_b64_tr_b16 a[10:11], v15 offset:9888
    v_mfma_f32_16x16x32_bf16 v[196:199], a[20:23], a[96:99], v[196:199]
    buffer_load_dwordx4 a[44:47], v16, s[36:39], s64 offen offset:1024 sc1
    v_mfma_f32_16x16x32_bf16 v[196:199], a[16:19], a[80:83], v[196:199]
    v_mfma_f32_16x16x32_bf16 v[168:171], a[16:19], a[76:79], v[168:171]
    ds_read_b64_tr_b16 a[12:13], v15 offset:26784
    v_mfma_f32_16x16x32_bf16 v[168:171], a[20:23], a[92:95], v[168:171]
    ds_read_b64_tr_b16 a[14:15], v15 offset:30368
    v_mfma_f32_16x16x32_bf16 v[140:143], a[20:23], a[88:91], v[140:143]
    v_mfma_f32_16x16x32_bf16 v[140:143], a[16:19], a[72:75], v[140:143]
    s_waitcnt lgkmcnt(8)
    v_mfma_f32_16x16x32_bf16 v[144:147], a[24:27], a[72:75], v[144:147]
    ds_read_b64_tr_b16 a[16:17], v15 offset:6336
    v_mfma_f32_16x16x32_bf16 v[144:147], a[28:31], a[88:91], v[144:147]
    ds_read_b64_tr_b16 a[18:19], v15 offset:9920
    v_mfma_f32_16x16x32_bf16 v[172:175], a[28:31], a[92:95], v[172:175]
    v_mfma_f32_16x16x32_bf16 v[172:175], a[24:27], a[76:79], v[172:175]
    buffer_load_dwordx4 a[60:63], v253, s[36:39], s64 offen offset:1024 sc1
    v_mfma_f32_16x16x32_bf16 v[200:203], a[24:27], a[80:83], v[200:203]
    ds_read_b64_tr_b16 a[20:21], v15 offset:26816
    v_mfma_f32_16x16x32_bf16 v[200:203], a[28:31], a[96:99], v[200:203]
    ds_read_b64_tr_b16 a[22:23], v15 offset:30400
    v_mfma_f32_16x16x32_bf16 v[228:231], a[28:31], a[100:103], v[228:231]
    v_mfma_f32_16x16x32_bf16 v[228:231], a[24:27], a[84:87], v[228:231]
    v_mfma_f32_16x16x32_bf16 v[232:235], a[32:35], a[84:87], v[232:235]
    ds_read_b64_tr_b16 a[24:25], v15 offset:13312
    v_mfma_f32_16x16x32_bf16 v[232:235], a[36:39], a[100:103], v[232:235]
    ds_read_b64_tr_b16 a[26:27], v15 offset:16896
    v_mfma_f32_16x16x32_bf16 v[204:207], a[36:39], a[96:99], v[204:207]
    v_mfma_f32_16x16x32_bf16 v[204:207], a[32:35], a[80:83], v[204:207]
    buffer_load_dwordx4 a[48:51], v16, s[36:39], s64 offen offset:2048 sc1
    v_mfma_f32_16x16x32_bf16 v[176:179], a[32:35], a[76:79], v[176:179]
    ds_read_b64_tr_b16 a[28:29], v15 offset:33792
    v_mfma_f32_16x16x32_bf16 v[176:179], a[36:39], a[92:95], v[176:179]
    ds_read_b64_tr_b16 a[30:31], v15 offset:37376
    v_mfma_f32_16x16x32_bf16 v[148:151], a[36:39], a[88:91], v[148:151]
    v_mfma_f32_16x16x32_bf16 v[148:151], a[32:35], a[72:75], v[148:151]
    s_waitcnt lgkmcnt(8)
    v_mfma_f32_16x16x32_bf16 v[152:155], a[0:3], a[72:75], v[152:155]
    ds_read_b64_tr_b16 a[32:33], v15 offset:13344
    v_mfma_f32_16x16x32_bf16 v[152:155], a[4:7], a[88:91], v[152:155]
    ds_read_b64_tr_b16 a[34:35], v15 offset:16928
    v_mfma_f32_16x16x32_bf16 v[180:183], a[4:7], a[92:95], v[180:183]
    v_mfma_f32_16x16x32_bf16 v[180:183], a[0:3], a[76:79], v[180:183]
    v_mfma_f32_16x16x32_bf16 v[208:211], a[0:3], a[80:83], v[208:211]
    ds_read_b64_tr_b16 a[36:37], v15 offset:33824
    v_mfma_f32_16x16x32_bf16 v[208:211], a[4:7], a[96:99], v[208:211]
    ds_read_b64_tr_b16 a[38:39], v15 offset:37408
    v_mfma_f32_16x16x32_bf16 v[236:239], a[4:7], a[100:103], v[236:239]
    buffer_load_dwordx4 a[64:67], v253, s[36:39], s64 offen offset:2048 sc1
    v_mfma_f32_16x16x32_bf16 v[236:239], a[0:3], a[84:87], v[236:239]
    v_mfma_f32_16x16x32_bf16 v[240:243], a[8:11], a[84:87], v[240:243]
    ds_read_b64_tr_b16 a[0:1], v15 offset:13376
    v_mfma_f32_16x16x32_bf16 v[240:243], a[12:15], a[100:103], v[240:243]
    ds_read_b64_tr_b16 a[2:3], v15 offset:16960
    v_mfma_f32_16x16x32_bf16 v[212:215], a[12:15], a[96:99], v[212:215]
    v_mfma_f32_16x16x32_bf16 v[212:215], a[8:11], a[80:83], v[212:215]
    v_mfma_f32_16x16x32_bf16 v[184:187], a[8:11], a[76:79], v[184:187]
    ds_read_b64_tr_b16 a[4:5], v15 offset:33856
    v_mfma_f32_16x16x32_bf16 v[184:187], a[12:15], a[92:95], v[184:187]
    ds_read_b64_tr_b16 a[6:7], v15 offset:37440
    v_mfma_f32_16x16x32_bf16 v[156:159], a[12:15], a[88:91], v[156:159]
    buffer_load_dwordx4 a[52:55], v16, s[36:39], s64 offen offset:3072 sc1
    v_mfma_f32_16x16x32_bf16 v[156:159], a[8:11], a[72:75], v[156:159]
    s_waitcnt lgkmcnt(8)
    v_mfma_f32_16x16x32_bf16 v[160:163], a[16:19], a[72:75], v[160:163]
    ds_read_b64_tr_b16 a[8:9], v15 offset:13408
    v_mfma_f32_16x16x32_bf16 v[160:163], a[20:23], a[88:91], v[160:163]
    ds_read_b64_tr_b16 a[10:11], v15 offset:16992
    v_mfma_f32_16x16x32_bf16 v[188:191], a[20:23], a[92:95], v[188:191]
    v_mfma_f32_16x16x32_bf16 v[188:191], a[16:19], a[76:79], v[188:191]
    v_mfma_f32_16x16x32_bf16 v[216:219], a[16:19], a[80:83], v[216:219]
    ds_read_b64_tr_b16 a[12:13], v15 offset:33888
    v_mfma_f32_16x16x32_bf16 v[216:219], a[20:23], a[96:99], v[216:219]
    ds_read_b64_tr_b16 a[14:15], v15 offset:37472
    v_mfma_f32_16x16x32_bf16 v[244:247], a[20:23], a[100:103], v[244:247]
    v_mfma_f32_16x16x32_bf16 v[244:247], a[16:19], a[84:87], v[244:247]
    buffer_load_dwordx4 a[68:71], v253, s[36:39], s64 offen offset:3072 sc1
    v_mfma_f32_16x16x32_bf16 v[36:39], a[24:27], a[84:87], v[36:39]
    ds_read_b64_tr_b16 a[16:17], v15 offset:13440
    v_mfma_f32_16x16x32_bf16 v[36:39], a[28:31], a[100:103], v[36:39]
    ds_read_b64_tr_b16 a[18:19], v15 offset:17024
    v_mfma_f32_16x16x32_bf16 v[32:35], a[28:31], a[96:99], v[32:35]
    v_mfma_f32_16x16x32_bf16 v[32:35], a[24:27], a[80:83], v[32:35]
    v_mfma_f32_16x16x32_bf16 v[28:31], a[24:27], a[76:79], v[28:31]
    ds_read_b64_tr_b16 a[20:21], v15 offset:33920
    v_mfma_f32_16x16x32_bf16 v[28:31], a[28:31], a[92:95], v[28:31]
    ds_read_b64_tr_b16 a[22:23], v15 offset:37504
    v_mfma_f32_16x16x32_bf16 v[24:27], a[28:31], a[88:91], v[24:27]
    v_mfma_f32_16x16x32_bf16 v[24:27], a[24:27], a[72:75], v[24:27]
    s_waitcnt lgkmcnt(8)
    v_mfma_f32_16x16x32_bf16 v[40:43], a[32:35], a[72:75], v[40:43]
    ds_read_b64_tr_b16 a[24:25], v15 offset:13472
    v_mfma_f32_16x16x32_bf16 v[40:43], a[36:39], a[88:91], v[40:43]
    ds_read_b64_tr_b16 a[26:27], v15 offset:17056
    v_mfma_f32_16x16x32_bf16 v[44:47], a[36:39], a[92:95], v[44:47]
    s_add_u32 s64, s64, 8192
    v_mfma_f32_16x16x32_bf16 v[44:47], a[32:35], a[76:79], v[44:47]
    v_mfma_f32_16x16x32_bf16 v[48:51], a[32:35], a[80:83], v[48:51]
    ds_read_b64_tr_b16 a[28:29], v15 offset:33952
    v_mfma_f32_16x16x32_bf16 v[48:51], a[36:39], a[96:99], v[48:51]
    ds_read_b64_tr_b16 a[30:31], v15 offset:37536
    v_mfma_f32_16x16x32_bf16 v[52:55], a[36:39], a[100:103], v[52:55]
    v_mfma_f32_16x16x32_bf16 v[52:55], a[32:35], a[84:87], v[52:55]
    v_mfma_f32_16x16x32_bf16 v[68:71], a[0:3], a[84:87], v[68:71]
    ds_read_b64_tr_b16 a[32:33], v15 offset:13504
    v_mfma_f32_16x16x32_bf16 v[68:71], a[4:7], a[100:103], v[68:71]
    ds_read_b64_tr_b16 a[34:35], v15 offset:17088
    v_mfma_f32_16x16x32_bf16 v[64:67], a[4:7], a[96:99], v[64:67]
    ds_read_b64_tr_b16 a[36:37], v15 offset:33984
    v_mfma_f32_16x16x32_bf16 v[64:67], a[0:3], a[80:83], v[64:67]
    ds_read_b64_tr_b16 a[38:39], v15 offset:37568
    v_mfma_f32_16x16x32_bf16 v[60:63], a[0:3], a[76:79], v[60:63]
    v_mfma_f32_16x16x32_bf16 v[60:63], a[4:7], a[92:95], v[60:63]
    v_mfma_f32_16x16x32_bf16 v[56:59], a[4:7], a[88:91], v[56:59]
    s_waitcnt vmcnt(8) lgkmcnt(0)
    v_mfma_f32_16x16x32_bf16 v[56:59], a[0:3], a[72:75], v[56:59]
    s_barrier
    v_mfma_f32_16x16x32_bf16 v[72:75], a[8:11], a[72:75], v[72:75]
    ds_read_b64_tr_b16 a[0:1], v10 offset:0
    v_mfma_f32_16x16x32_bf16 v[72:75], a[12:15], a[88:91], v[72:75]
    ds_read_b64_tr_b16 a[2:3], v10 offset:3072
    v_mfma_f32_16x16x32_bf16 v[76:79], a[12:15], a[92:95], v[76:79]
    s_add_u32 m0, s69, 40960
    v_mfma_f32_16x16x32_bf16 v[76:79], a[8:11], a[76:79], v[76:79]
    v_mfma_f32_16x16x32_bf16 v[80:83], a[8:11], a[80:83], v[80:83]
    ds_read_b64_tr_b16 a[4:5], v10 offset:20480
    v_mfma_f32_16x16x32_bf16 v[80:83], a[12:15], a[96:99], v[80:83]
    ds_read_b64_tr_b16 a[6:7], v10 offset:23552
    v_mfma_f32_16x16x32_bf16 v[84:87], a[12:15], a[100:103], v[84:87]
    buffer_load_dwordx4 v2, s[24:27], s60 offen offset:0  lds
    v_mfma_f32_16x16x32_bf16 v[84:87], a[8:11], a[84:87], v[84:87]
    v_mfma_f32_16x16x32_bf16 v[100:103], a[16:19], a[84:87], v[100:103]
    ds_read_b64_tr_b16 a[8:9], v11 offset:32
    v_mfma_f32_16x16x32_bf16 v[100:103], a[20:23], a[100:103], v[100:103]
    ds_read_b64_tr_b16 a[10:11], v11 offset:3104
    v_mfma_f32_16x16x32_bf16 v[96:99], a[20:23], a[96:99], v[96:99]
    buffer_load_dwordx4 v3, s[28:31], s61 offen offset:1024  lds
    v_mfma_f32_16x16x32_bf16 v[96:99], a[16:19], a[80:83], v[96:99]
    v_mfma_f32_16x16x32_bf16 v[92:95], a[16:19], a[76:79], v[92:95]
    ds_read_b64_tr_b16 a[12:13], v11 offset:20512
    v_mfma_f32_16x16x32_bf16 v[92:95], a[20:23], a[92:95], v[92:95]
    ds_read_b64_tr_b16 a[14:15], v11 offset:23584
    v_mfma_f32_16x16x32_bf16 v[88:91], a[20:23], a[88:91], v[88:91]
    buffer_load_dwordx4 v4, s[28:31], s61 offen offset:2048  lds
    v_mfma_f32_16x16x32_bf16 v[88:91], a[16:19], a[72:75], v[88:91]
    s_waitcnt lgkmcnt(8)
    v_mfma_f32_16x16x32_bf16 v[104:107], a[24:27], a[72:75], v[104:107]
    ds_read_b64_tr_b16 a[16:17], v10 offset:64
    v_mfma_f32_16x16x32_bf16 v[104:107], a[28:31], a[88:91], v[104:107]
    ds_read_b64_tr_b16 a[18:19], v10 offset:3136
    v_mfma_f32_16x16x32_bf16 v[108:111], a[28:31], a[92:95], v[108:111]
    v_mfma_f32_16x16x32_bf16 v[108:111], a[24:27], a[76:79], v[108:111]
    buffer_load_dwordx4 v5, s[32:35], s61 offen offset:3072  lds
    v_mfma_f32_16x16x32_bf16 v[112:115], a[24:27], a[80:83], v[112:115]
    ds_read_b64_tr_b16 a[20:21], v10 offset:20544
    v_mfma_f32_16x16x32_bf16 v[112:115], a[28:31], a[96:99], v[112:115]
    ds_read_b64_tr_b16 a[22:23], v10 offset:23616
    v_mfma_f32_16x16x32_bf16 v[116:119], a[28:31], a[100:103], v[116:119]
    v_mfma_f32_16x16x32_bf16 v[116:119], a[24:27], a[84:87], v[116:119]
    s_add_u32 m0, s69, 45056
    v_mfma_f32_16x16x32_bf16 v[132:135], a[32:35], a[84:87], v[132:135]
    ds_read_b64_tr_b16 a[24:25], v11 offset:96
    v_mfma_f32_16x16x32_bf16 v[132:135], a[36:39], a[100:103], v[132:135]
    ds_read_b64_tr_b16 a[26:27], v11 offset:3168
    v_mfma_f32_16x16x32_bf16 v[128:131], a[36:39], a[96:99], v[128:131]
    v_mfma_f32_16x16x32_bf16 v[128:131], a[32:35], a[80:83], v[128:131]
    buffer_load_dwordx4 v6, s[32:35], s61 offen offset:0  lds
    v_mfma_f32_16x16x32_bf16 v[124:127], a[32:35], a[76:79], v[124:127]
    ds_read_b64_tr_b16 a[28:29], v11 offset:20576
    v_mfma_f32_16x16x32_bf16 v[124:127], a[36:39], a[92:95], v[124:127]
    ds_read_b64_tr_b16 a[30:31], v11 offset:23648
    s_add_u32 s68, s68, 1
    v_mfma_f32_16x16x32_bf16 v[120:123], a[36:39], a[88:91], v[120:123]
    v_mfma_f32_16x16x32_bf16 v[120:123], a[32:35], a[72:75], v[120:123]
    s_waitcnt vmcnt(5) lgkmcnt(8)
    s_cmp_lt_u32 s68, 6
    s_cbranch_scc1 L_loop1
    s_getpc_b64 s[76:77]
L_pc:
    s_add_u32 s76, s76, L_g1end-L_pc
    s_addc_u32 s77, s77, 0
    v_mfma_f32_16x16x32_bf16 a[104:107], a[0:3], a[40:43], a[104:107]
    ds_read_b64_tr_b16 a[32:33], v10 offset:128
    s_add_u32 m0, s69, 61440
    v_mfma_f32_16x16x32_bf16 a[104:107], a[4:7], a[56:59], a[104:107]
    ds_read_b64_tr_b16 a[34:35], v10 offset:3200
    v_mfma_f32_16x16x32_bf16 a[108:111], a[4:7], a[60:63], a[108:111]
    buffer_load_dwordx4 v248, s[24:27], s60 offen offset:0  lds
    v_mfma_f32_16x16x32_bf16 a[108:111], a[0:3], a[44:47], a[108:111]
    v_lshrrev_b32 v21, 4, v1
    v_mfma_f32_16x16x32_bf16 a[112:115], a[0:3], a[48:51], a[112:115]
    ds_read_b64_tr_b16 a[36:37], v10 offset:20608
    v_bfe_u32 v19, v1, 1, 3
    v_mfma_f32_16x16x32_bf16 a[112:115], a[4:7], a[64:67], a[112:115]
    ds_read_b64_tr_b16 a[38:39], v10 offset:23680
    v_mfma_f32_16x16x32_bf16 a[116:119], a[4:7], a[68:71], a[116:119]
    buffer_load_dwordx4 v249, s[28:31], s61 offen offset:1024  lds
    v_mfma_f32_16x16x32_bf16 a[116:119], a[0:3], a[52:55], a[116:119]
    v_xor_b32 v19, v19, v21
    v_mfma_f32_16x16x32_bf16 a[132:135], a[8:11], a[52:55], a[132:135]
    ds_read_b64_tr_b16 a[0:1], v11 offset:160
    s_lshl_b32 s84, s98, 2
    v_mfma_f32_16x16x32_bf16 a[132:135], a[12:15], a[68:71], a[132:135]
    ds_read_b64_tr_b16 a[2:3], v11 offset:3232
    v_mfma_f32_16x16x32_bf16 a[128:131], a[12:15], a[64:67], a[128:131]
    buffer_load_dwordx4 v250, s[28:31], s61 offen offset:2048  lds
    v_mfma_f32_16x16x32_bf16 a[128:131], a[8:11], a[48:51], a[128:131]
    v_xor_b32 v19, s84, v19
    v_mfma_f32_16x16x32_bf16 a[124:127], a[8:11], a[44:47], a[124:127]
    ds_read_b64_tr_b16 a[4:5], v11 offset:20640
    v_mfma_f32_16x16x32_bf16 a[124:127], a[12:15], a[60:63], a[124:127]
    ds_read_b64_tr_b16 a[6:7], v11 offset:23712
    v_lshlrev_b32 v21, 11, v21
    v_mfma_f32_16x16x32_bf16 a[120:123], a[12:15], a[56:59], a[120:123]
    buffer_load_dwordx4 v251, s[32:35], s61 offen offset:3072  lds
    v_mfma_f32_16x16x32_bf16 a[120:123], a[8:11], a[40:43], a[120:123]
    s_waitcnt lgkmcnt(8)
    v_mfma_f32_16x16x32_bf16 a[136:139], a[40:43], a[16:19], a[136:139]
    ds_read_b64_tr_b16 a[8:9], v12 offset:6144
    v_and_b32 v20, 1, v1
    v_mfma_f32_16x16x32_bf16 a[136:139], a[56:59], a[20:23], a[136:139]
    ds_read_b64_tr_b16 a[10:11], v12 offset:9728
    v_mfma_f32_16x16x32_bf16 a[140:143], a[60:63], a[20:23], a[140:143]
    v_lshl_add_u32 v21, v20, 4, v21
    v_mfma_f32_16x16x32_bf16 a[140:143], a[44:47], a[16:19], a[140:143]
    s_add_u32 m0, s69, 65536
    v_mfma_f32_16x16x32_bf16 a[144:147], a[48:51], a[16:19], a[144:147]
    ds_read_b64_tr_b16 a[12:13], v12 offset:26624
    v_mfma_f32_16x16x32_bf16 a[144:147], a[64:67], a[20:23], a[144:147]
    ds_read_b64_tr_b16 a[14:15], v12 offset:30208
    buffer_load_dwordx4 v252, s[32:35], s61 offen offset:0  lds
    v_mfma_f32_16x16x32_bf16 a[148:151], a[68:71], a[20:23], a[148:151]
    s_add_u32 s60, s60, s62
    v_mfma_f32_16x16x32_bf16 a[148:151], a[52:55], a[16:19], a[148:151]
    s_add_u32 s61, s61, s63
    v_mfma_f32_16x16x32_bf16 a[164:167], a[52:55], a[24:27], a[164:167]
    ds_read_b64_tr_b16 a[16:17], v12 offset:6176
    v_mfma_f32_16x16x32_bf16 a[164:167], a[68:71], a[28:31], a[164:167]
    ds_read_b64_tr_b16 a[18:19], v12 offset:9760
    s_lshl_b32 s84, s3, 15
    v_mfma_f32_16x16x32_bf16 a[160:163], a[64:67], a[28:31], a[160:163]
    s_lshl_b32 s85, s21, 8
    v_mfma_f32_16x16x32_bf16 a[160:163], a[48:51], a[24:27], a[160:163]
    s_add_u32 s84, s84, s85
    v_mfma_f32_16x16x32_bf16 a[156:159], a[44:47], a[24:27], a[156:159]
    ds_read_b64_tr_b16 a[20:21], v12 offset:26656
    v_mfma_f32_16x16x32_bf16 a[156:159], a[60:63], a[28:31], a[156:159]
    ds_read_b64_tr_b16 a[22:23], v12 offset:30240
    v_mfma_f32_16x16x32_bf16 a[152:155], a[56:59], a[28:31], a[152:155]
    v_add_u32 v21, s84, v21
    v_mfma_f32_16x16x32_bf16 a[152:155], a[40:43], a[24:27], a[152:155]
    s_waitcnt lgkmcnt(8)
    v_lshl_add_u32 v18, v19, 5, v21
    v_mfma_f32_16x16x32_bf16 a[168:171], a[40:43], a[32:35], a[168:171]
    ds_read_b64_tr_b16 a[24:25], v12 offset:6208
    v_mfma_f32_16x16x32_bf16 a[168:171], a[56:59], a[36:39], a[168:171]
    ds_read_b64_tr_b16 a[26:27], v12 offset:9792
    v_xor_b32 v19, 4, v19
    v_mfma_f32_16x16x32_bf16 a[172:175], a[60:63], a[36:39], a[172:175]
    v_lshl_add_u32 v19, v19, 5, v21
    v_mfma_f32_16x16x32_bf16 a[172:175], a[44:47], a[32:35], a[172:175]
    v_add_u32 v19, 7168, v19
    v_mfma_f32_16x16x32_bf16 a[176:179], a[48:51], a[32:35], a[176:179]
    ds_read_b64_tr_b16 a[28:29], v12 offset:26688
    v_mfma_f32_16x16x32_bf16 a[176:179], a[64:67], a[36:39], a[176:179]
    ds_read_b64_tr_b16 a[30:31], v12 offset:30272
    v_mfma_f32_16x16x32_bf16 a[180:183], a[68:71], a[36:39], a[180:183]
    v_add_u32 v20, 14336, v18
    v_mfma_f32_16x16x32_bf16 a[180:183], a[52:55], a[32:35], a[180:183]
    v_add_u32 v21, 14336, v19
    v_mfma_f32_16x16x32_bf16 a[196:199], a[52:55], a[0:3], a[196:199]
    ds_read_b64_tr_b16 a[32:33], v12 offset:6240
    v_mfma_f32_16x16x32_bf16 a[196:199], a[68:71], a[4:7], a[196:199]
    ds_read_b64_tr_b16 a[34:35], v12 offset:9824
    v_mfma_f32_16x16x32_bf16 a[192:195], a[64:67], a[4:7], a[192:195]
    buffer_load_dwordx4 a[72:75], v16, s[36:39], s64 offen offset:0 sc1
    v_mfma_f32_16x16x32_bf16 a[192:195], a[48:51], a[0:3], a[192:195]
    v_mfma_f32_16x16x32_bf16 a[188:191], a[44:47], a[0:3], a[188:191]
    ds_read_b64_tr_b16 a[36:37], v12 offset:26720
    v_mfma_f32_16x16x32_bf16 a[188:191], a[60:63], a[4:7], a[188:191]
    ds_read_b64_tr_b16 a[38:39], v12 offset:30304
    v_mfma_f32_16x16x32_bf16 a[184:187], a[56:59], a[4:7], a[184:187]
    buffer_load_dwordx4 a[88:91], v253, s[36:39], s64 offen offset:0 sc1
    v_mfma_f32_16x16x32_bf16 a[184:187], a[40:43], a[0:3], a[184:187]
    s_waitcnt lgkmcnt(8)
    v_mfma_f32_16x16x32_bf16 v[136:139], a[8:11], a[40:43], v[136:139]
    ds_read_b64_tr_b16 a[0:1], v12 offset:6272
    v_mfma_f32_16x16x32_bf16 v[136:139], a[12:15], a[56:59], v[136:139]
    ds_read_b64_tr_b16 a[2:3], v12 offset:9856
    v_mfma_f32_16x16x32_bf16 v[164:167], a[12:15], a[60:63], v[164:167]
    v_mfma_f32_16x16x32_bf16 v[164:167], a[8:11], a[44:47], v[164:167]
    buffer_load_dwordx4 a[76:79], v16, s[36:39], s64 offen offset:1024 sc1
    v_mfma_f32_16x16x32_bf16 v[192:195], a[8:11], a[48:51], v[192:195]
    ds_read_b64_tr_b16 a[4:5], v12 offset:26752
    v_mfma_f32_16x16x32_bf16 v[192:195], a[12:15], a[64:67], v[192:195]
    ds_read_b64_tr_b16 a[6:7], v12 offset:30336
    v_mfma_f32_16x16x32_bf16 v[220:223], a[12:15], a[68:71], v[220:223]
    v_mfma_f32_16x16x32_bf16 v[220:223], a[8:11], a[52:55], v[220:223]
    buffer_load_dwordx4 a[92:95], v253, s[36:39], s64 offen offset:1024 sc1
    v_mfma_f32_16x16x32_bf16 v[224:227], a[16:19], a[52:55], v[224:227]
    ds_read_b64_tr_b16 a[8:9], v12 offset:6304
    v_mfma_f32_16x16x32_bf16 v[224:227], a[20:23], a[68:71], v[224:227]
    ds_read_b64_tr_b16 a[10:11], v12 offset:9888
    v_mfma_f32_16x16x32_bf16 v[196:199], a[20:23], a[64:67], v[196:199]
    v_mfma_f32_16x16x32_bf16 v[196:199], a[16:19], a[48:51], v[196:199]
    buffer_load_dwordx4 a[80:83], v16, s[36:39], s64 offen offset:2048 sc1
    v_mfma_f32_16x16x32_bf16 v[168:171], a[16:19], a[44:47], v[168:171]
    ds_read_b64_tr_b16 a[12:13], v12 offset:26784
    v_mfma_f32_16x16x32_bf16 v[168:171], a[20:23], a[60:63], v[168:171]
    ds_read_b64_tr_b16 a[14:15], v12 offset:30368
    v_mfma_f32_16x16x32_bf16 v[140:143], a[20:23], a[56:59], v[140:143]
    v_mfma_f32_16x16x32_bf16 v[140:143], a[16:19], a[40:43], v[140:143]
    s_waitcnt lgkmcnt(8)
    v_mfma_f32_16x16x32_bf16 v[144:147], a[24:27], a[40:43], v[144:147]
    ds_read_b64_tr_b16 a[16:17], v12 offset:6336
    v_mfma_f32_16x16x32_bf16 v[144:147], a[28:31], a[56:59], v[144:147]
    ds_read_b64_tr_b16 a[18:19], v12 offset:9920
    v_mfma_f32_16x16x32_bf16 v[172:175], a[28:31], a[60:63], v[172:175]
    buffer_load_dwordx4 a[96:99], v253, s[36:39], s64 offen offset:2048 sc1
    v_mfma_f32_16x16x32_bf16 v[172:175], a[24:27], a[44:47], v[172:175]
    v_mfma_f32_16x16x32_bf16 v[200:203], a[24:27], a[48:51], v[200:203]
    ds_read_b64_tr_b16 a[20:21], v12 offset:26816
    v_mfma_f32_16x16x32_bf16 v[200:203], a[28:31], a[64:67], v[200:203]
    ds_read_b64_tr_b16 a[22:23], v12 offset:30400
    v_mfma_f32_16x16x32_bf16 v[228:231], a[28:31], a[68:71], v[228:231]
    buffer_load_dwordx4 a[84:87], v16, s[36:39], s64 offen offset:3072 sc1
    v_mfma_f32_16x16x32_bf16 v[228:231], a[24:27], a[52:55], v[228:231]
    v_mfma_f32_16x16x32_bf16 v[232:235], a[32:35], a[52:55], v[232:235]
    ds_read_b64_tr_b16 a[24:25], v12 offset:13312
    v_mfma_f32_16x16x32_bf16 v[232:235], a[36:39], a[68:71], v[232:235]
    ds_read_b64_tr_b16 a[26:27], v12 offset:16896
    v_mfma_f32_16x16x32_bf16 v[204:207], a[36:39], a[64:67], v[204:207]
    buffer_load_dwordx4 a[100:103], v253, s[36:39], s64 offen offset:3072 sc1
    v_mfma_f32_16x16x32_bf16 v[204:207], a[32:35], a[48:51], v[204:207]
    v_mfma_f32_16x16x32_bf16 v[176:179], a[32:35], a[44:47], v[176:179]
    ds_read_b64_tr_b16 a[28:29], v12 offset:33792
    v_mfma_f32_16x16x32_bf16 v[176:179], a[36:39], a[60:63], v[176:179]
    ds_read_b64_tr_b16 a[30:31], v12 offset:37376
    v_mfma_f32_16x16x32_bf16 v[148:151], a[36:39], a[56:59], v[148:151]
    s_add_u32 s64, s64, 8192
    v_mfma_f32_16x16x32_bf16 v[148:151], a[32:35], a[40:43], v[148:151]
    s_waitcnt lgkmcnt(8)
    v_mfma_f32_16x16x32_bf16 v[152:155], a[0:3], a[40:43], v[152:155]
    ds_read_b64_tr_b16 a[32:33], v12 offset:13344
    v_mfma_f32_16x16x32_bf16 v[152:155], a[4:7], a[56:59], v[152:155]
    ds_read_b64_tr_b16 a[34:35], v12 offset:16928
    v_mfma_f32_16x16x32_bf16 v[180:183], a[4:7], a[60:63], v[180:183]
    v_mfma_f32_16x16x32_bf16 v[180:183], a[0:3], a[44:47], v[180:183]
    s_add_u32 m0, s88, 81920
    v_mfma_f32_16x16x32_bf16 v[208:211], a[0:3], a[48:51], v[208:211]
    ds_read_b64_tr_b16 a[36:37], v12 offset:33824
    v_mfma_f32_16x16x32_bf16 v[208:211], a[4:7], a[64:67], v[208:211]
    ds_read_b64_tr_b16 a[38:39], v12 offset:37408
    v_mfma_f32_16x16x32_bf16 v[236:239], a[4:7], a[68:71], v[236:239]
    v_mfma_f32_16x16x32_bf16 v[236:239], a[0:3], a[52:55], v[236:239]
    buffer_load_dwordx4 v18, s[56:59], s75 offen offset:0 lds
    v_mfma_f32_16x16x32_bf16 v[240:243], a[8:11], a[52:55], v[240:243]
    ds_read_b64_tr_b16 a[0:1], v12 offset:13376
    v_mfma_f32_16x16x32_bf16 v[240:243], a[12:15], a[68:71], v[240:243]
    ds_read_b64_tr_b16 a[2:3], v12 offset:16960
    v_mfma_f32_16x16x32_bf16 v[212:215], a[12:15], a[64:67], v[212:215]
    v_mfma_f32_16x16x32_bf16 v[212:215], a[8:11], a[48:51], v[212:215]
    buffer_load_dwordx4 v19, s[56:59], s75 offen offset:1024 lds
    v_mfma_f32_16x16x32_bf16 v[184:187], a[8:11], a[44:47], v[184:187]
    ds_read_b64_tr_b16 a[4:5], v12 offset:33856
    v_mfma_f32_16x16x32_bf16 v[184:187], a[12:15], a[60:63], v[184:187]
    ds_read_b64_tr_b16 a[6:7], v12 offset:37440
    v_mfma_f32_16x16x32_bf16 v[156:159], a[12:15], a[56:59], v[156:159]
    v_mfma_f32_16x16x32_bf16 v[156:159], a[8:11], a[40:43], v[156:159]
    s_waitcnt lgkmcnt(8)
    v_mfma_f32_16x16x32_bf16 v[160:163], a[16:19], a[40:43], v[160:163]
    ds_read_b64_tr_b16 a[8:9], v12 offset:13408
    v_mfma_f32_16x16x32_bf16 v[160:163], a[20:23], a[56:59], v[160:163]
    ds_read_b64_tr_b16 a[10:11], v12 offset:16992
    v_mfma_f32_16x16x32_bf16 v[188:191], a[20:23], a[60:63], v[188:191]
    buffer_load_dwordx4 v20, s[56:59], s75 offen offset:2048 lds
    v_mfma_f32_16x16x32_bf16 v[188:191], a[16:19], a[44:47], v[188:191]
    v_mfma_f32_16x16x32_bf16 v[216:219], a[16:19], a[48:51], v[216:219]
    ds_read_b64_tr_b16 a[12:13], v12 offset:33888
    v_mfma_f32_16x16x32_bf16 v[216:219], a[20:23], a[64:67], v[216:219]
    ds_read_b64_tr_b16 a[14:15], v12 offset:37472
    v_mfma_f32_16x16x32_bf16 v[244:247], a[20:23], a[68:71], v[244:247]
    buffer_load_dwordx4 v21, s[56:59], s75 offen offset:3072 lds
    v_mfma_f32_16x16x32_bf16 v[244:247], a[16:19], a[52:55], v[244:247]
    v_mfma_f32_16x16x32_bf16 v[36:39], a[24:27], a[52:55], v[36:39]
    ds_read_b64_tr_b16 a[16:17], v12 offset:13440
    v_mfma_f32_16x16x32_bf16 v[36:39], a[28:31], a[68:71], v[36:39]
    ds_read_b64_tr_b16 a[18:19], v12 offset:17024
    v_mfma_f32_16x16x32_bf16 v[32:35], a[28:31], a[64:67], v[32:35]
    s_add_u32 s75, s75, 131072
    v_mfma_f32_16x16x32_bf16 v[32:35], a[24:27], a[48:51], v[32:35]
    v_mfma_f32_16x16x32_bf16 v[28:31], a[24:27], a[44:47], v[28:31]
    ds_read_b64_tr_b16 a[20:21], v12 offset:33920
    v_mfma_f32_16x16x32_bf16 v[28:31], a[28:31], a[60:63], v[28:31]
    ds_read_b64_tr_b16 a[22:23], v12 offset:37504
    v_mfma_f32_16x16x32_bf16 v[24:27], a[28:31], a[56:59], v[24:27]
    v_mfma_f32_16x16x32_bf16 v[24:27], a[24:27], a[40:43], v[24:27]
    s_waitcnt lgkmcnt(8)
    v_mfma_f32_16x16x32_bf16 v[40:43], a[32:35], a[40:43], v[40:43]
    ds_read_b64_tr_b16 a[24:25], v12 offset:13472
    v_mfma_f32_16x16x32_bf16 v[40:43], a[36:39], a[56:59], v[40:43]
    ds_read_b64_tr_b16 a[26:27], v12 offset:17056
    v_mfma_f32_16x16x32_bf16 v[44:47], a[36:39], a[60:63], v[44:47]
    v_mfma_f32_16x16x32_bf16 v[44:47], a[32:35], a[44:47], v[44:47]
    v_mfma_f32_16x16x32_bf16 v[48:51], a[32:35], a[48:51], v[48:51]
    ds_read_b64_tr_b16 a[28:29], v12 offset:33952
    v_mfma_f32_16x16x32_bf16 v[48:51], a[36:39], a[64:67], v[48:51]
    ds_read_b64_tr_b16 a[30:31], v12 offset:37536
    v_mfma_f32_16x16x32_bf16 v[52:55], a[36:39], a[68:71], v[52:55]
    v_mfma_f32_16x16x32_bf16 v[52:55], a[32:35], a[52:55], v[52:55]
    v_mfma_f32_16x16x32_bf16 v[68:71], a[0:3], a[52:55], v[68:71]
    ds_read_b64_tr_b16 a[32:33], v12 offset:13504
    v_mfma_f32_16x16x32_bf16 v[68:71], a[4:7], a[68:71], v[68:71]
    ds_read_b64_tr_b16 a[34:35], v12 offset:17088
    v_mfma_f32_16x16x32_bf16 v[64:67], a[4:7], a[64:67], v[64:67]
    ds_read_b64_tr_b16 a[36:37], v12 offset:33984
    v_mfma_f32_16x16x32_bf16 v[64:67], a[0:3], a[48:51], v[64:67]
    ds_read_b64_tr_b16 a[38:39], v12 offset:37568
    v_mfma_f32_16x16x32_bf16 v[60:63], a[0:3], a[44:47], v[60:63]
    v_mfma_f32_16x16x32_bf16 v[60:63], a[4:7], a[60:63], v[60:63]
    v_mfma_f32_16x16x32_bf16 v[56:59], a[4:7], a[56:59], v[56:59]
    s_waitcnt vmcnt(12) lgkmcnt(0)
    v_mfma_f32_16x16x32_bf16 v[56:59], a[0:3], a[40:43], v[56:59]
    s_barrier
    v_mfma_f32_16x16x32_bf16 v[72:75], a[8:11], a[40:43], v[72:75]
    ds_read_b64_tr_b16 a[0:1], v13 offset:0
    v_mfma_f32_16x16x32_bf16 v[72:75], a[12:15], a[56:59], v[72:75]
    ds_read_b64_tr_b16 a[2:3], v13 offset:3072
    v_mfma_f32_16x16x32_bf16 v[76:79], a[12:15], a[60:63], v[76:79]
    s_add_u32 m0, s88, 98304
    v_mfma_f32_16x16x32_bf16 v[76:79], a[8:11], a[44:47], v[76:79]
    v_mfma_f32_16x16x32_bf16 v[80:83], a[8:11], a[48:51], v[80:83]
    ds_read_b64_tr_b16 a[4:5], v13 offset:20480
    v_mfma_f32_16x16x32_bf16 v[80:83], a[12:15], a[64:67], v[80:83]
    ds_read_b64_tr_b16 a[6:7], v13 offset:23552
    v_mfma_f32_16x16x32_bf16 v[84:87], a[12:15], a[68:71], v[84:87]
    buffer_load_dwordx4 v18, s[56:59], s75 offen offset:0 lds
    v_mfma_f32_16x16x32_bf16 v[84:87], a[8:11], a[52:55], v[84:87]
    v_mfma_f32_16x16x32_bf16 v[100:103], a[16:19], a[52:55], v[100:103]
    ds_read_b64_tr_b16 a[8:9], v14 offset:32
    v_mfma_f32_16x16x32_bf16 v[100:103], a[20:23], a[68:71], v[100:103]
    ds_read_b64_tr_b16 a[10:11], v14 offset:3104
    v_mfma_f32_16x16x32_bf16 v[96:99], a[20:23], a[64:67], v[96:99]
    buffer_load_dwordx4 v19, s[56:59], s75 offen offset:1024 lds
    v_mfma_f32_16x16x32_bf16 v[96:99], a[16:19], a[48:51], v[96:99]
    v_mfma_f32_16x16x32_bf16 v[92:95], a[16:19], a[44:47], v[92:95]
    ds_read_b64_tr_b16 a[12:13], v14 offset:20512
    v_mfma_f32_16x16x32_bf16 v[92:95], a[20:23], a[60:63], v[92:95]
    ds_read_b64_tr_b16 a[14:15], v14 offset:23584
    v_mfma_f32_16x16x32_bf16 v[88:91], a[20:23], a[56:59], v[88:91]
    v_mfma_f32_16x16x32_bf16 v[88:91], a[16:19], a[40:43], v[88:91]
    s_waitcnt lgkmcnt(8)
    v_mfma_f32_16x16x32_bf16 v[104:107], a[24:27], a[40:43], v[104:107]
    ds_read_b64_tr_b16 a[16:17], v13 offset:64
    v_mfma_f32_16x16x32_bf16 v[104:107], a[28:31], a[56:59], v[104:107]
    ds_read_b64_tr_b16 a[18:19], v13 offset:3136
    v_mfma_f32_16x16x32_bf16 v[108:111], a[28:31], a[60:63], v[108:111]
    buffer_load_dwordx4 v20, s[56:59], s75 offen offset:2048 lds
    v_mfma_f32_16x16x32_bf16 v[108:111], a[24:27], a[44:47], v[108:111]
    v_mfma_f32_16x16x32_bf16 v[112:115], a[24:27], a[48:51], v[112:115]
    ds_read_b64_tr_b16 a[20:21], v13 offset:20544
    v_mfma_f32_16x16x32_bf16 v[112:115], a[28:31], a[64:67], v[112:115]
    ds_read_b64_tr_b16 a[22:23], v13 offset:23616
    v_mfma_f32_16x16x32_bf16 v[116:119], a[28:31], a[68:71], v[116:119]
    buffer_load_dwordx4 v21, s[56:59], s75 offen offset:3072 lds
    v_mfma_f32_16x16x32_bf16 v[116:119], a[24:27], a[52:55], v[116:119]
    v_mfma_f32_16x16x32_bf16 v[132:135], a[32:35], a[52:55], v[132:135]
    ds_read_b64_tr_b16 a[24:25], v14 offset:96
    v_mfma_f32_16x16x32_bf16 v[132:135], a[36:39], a[68:71], v[132:135]
    ds_read_b64_tr_b16 a[26:27], v14 offset:3168
    v_mfma_f32_16x16x32_bf16 v[128:131], a[36:39], a[64:67], v[128:131]
    s_add_u32 s75, s75, 131072
    v_mfma_f32_16x16x32_bf16 v[128:131], a[32:35], a[48:51], v[128:131]
    v_mfma_f32_16x16x32_bf16 v[124:127], a[32:35], a[44:47], v[124:127]
    ds_read_b64_tr_b16 a[28:29], v14 offset:20576
    v_mfma_f32_16x16x32_bf16 v[124:127], a[36:39], a[60:63], v[124:127]
    ds_read_b64_tr_b16 a[30:31], v14 offset:23648
    v_mfma_f32_16x16x32_bf16 v[120:123], a[36:39], a[56:59], v[120:123]
    v_mfma_f32_16x16x32_bf16 v[120:123], a[32:35], a[40:43], v[120:123]
    s_waitcnt vmcnt(8) lgkmcnt(8)
    v_mfma_f32_16x16x32_bf16 a[104:107], a[0:3], a[72:75], a[104:107]
    ds_read_b64_tr_b16 a[32:33], v13 offset:128
    s_add_u32 m0, s88, 114688
    v_mfma_f32_16x16x32_bf16 a[104:107], a[4:7], a[88:91], a[104:107]
    ds_read_b64_tr_b16 a[34:35], v13 offset:3200
    v_mfma_f32_16x16x32_bf16 a[108:111], a[4:7], a[92:95], a[108:111]
    buffer_load_dwordx4 v18, s[56:59], s75 offen offset:0 lds
    v_mfma_f32_16x16x32_bf16 a[108:111], a[0:3], a[76:79], a[108:111]
    s_mov_b32 s44, 0x3fb8aa3b
    v_mfma_f32_16x16x32_bf16 a[112:115], a[0:3], a[80:83], a[112:115]
    ds_read_b64_tr_b16 a[36:37], v13 offset:20608
    s_mov_b32 s45, 0x3fb8aa3b
    v_mfma_f32_16x16x32_bf16 a[112:115], a[4:7], a[96:99], a[112:115]
    ds_read_b64_tr_b16 a[38:39], v13 offset:23680
    v_mfma_f32_16x16x32_bf16 a[116:119], a[4:7], a[100:103], a[116:119]
    buffer_load_dwordx4 v19, s[56:59], s75 offen offset:1024 lds
    v_mfma_f32_16x16x32_bf16 a[116:119], a[0:3], a[84:87], a[116:119]
    s_mov_b32 s46, 0xbfb8aa3b
    v_mfma_f32_16x16x32_bf16 a[132:135], a[8:11], a[84:87], a[132:135]
    ds_read_b64_tr_b16 a[0:1], v14 offset:160
    s_mov_b32 s47, 0xbfb8aa3b
    v_mfma_f32_16x16x32_bf16 a[132:135], a[12:15], a[100:103], a[132:135]
    ds_read_b64_tr_b16 a[2:3], v14 offset:3232
    v_mfma_f32_16x16x32_bf16 a[128:131], a[12:15], a[96:99], a[128:131]
    buffer_load_dwordx4 v20, s[56:59], s75 offen offset:2048 lds
    v_mfma_f32_16x16x32_bf16 a[128:131], a[8:11], a[80:83], a[128:131]
    s_mov_b32 s48, 0x358637bd
    v_mfma_f32_16x16x32_bf16 a[124:127], a[8:11], a[76:79], a[124:127]
    ds_read_b64_tr_b16 a[4:5], v14 offset:20640
    s_mov_b32 s49, 0x358637bd
    v_mfma_f32_16x16x32_bf16 a[124:127], a[12:15], a[92:95], a[124:127]
    ds_read_b64_tr_b16 a[6:7], v14 offset:23712
    v_mfma_f32_16x16x32_bf16 a[120:123], a[12:15], a[88:91], a[120:123]
    buffer_load_dwordx4 v21, s[56:59], s75 offen offset:3072 lds
    v_mfma_f32_16x16x32_bf16 a[120:123], a[8:11], a[72:75], a[120:123]
    s_waitcnt lgkmcnt(8)
    s_add_u32 s75, s75, 131072
    v_mfma_f32_16x16x32_bf16 a[136:139], a[72:75], a[16:19], a[136:139]
    ds_read_b64_tr_b16 a[8:9], v15 offset:6144
    v_mfma_f32_16x16x32_bf16 a[136:139], a[88:91], a[20:23], a[136:139]
    ds_read_b64_tr_b16 a[10:11], v15 offset:9728
    v_mfma_f32_16x16x32_bf16 a[140:143], a[92:95], a[20:23], a[140:143]
    s_lshl_b32 s63, s11, 3
    v_mfma_f32_16x16x32_bf16 a[140:143], a[76:79], a[16:19], a[140:143]
    s_lshl_b32 s52, s3, 1
    v_mfma_f32_16x16x32_bf16 a[144:147], a[80:83], a[16:19], a[144:147]
    ds_read_b64_tr_b16 a[12:13], v15 offset:26624
    s_add_u32 m0, s88, 131072
    v_mfma_f32_16x16x32_bf16 a[144:147], a[96:99], a[20:23], a[144:147]
    ds_read_b64_tr_b16 a[14:15], v15 offset:30208
    v_mfma_f32_16x16x32_bf16 a[148:151], a[100:103], a[20:23], a[148:151]
    buffer_load_dwordx4 v18, s[56:59], s75 offen offset:0 lds
    v_mfma_f32_16x16x32_bf16 a[148:151], a[84:87], a[16:19], a[148:151]
    s_add_u32 s63, s63, s52
    v_mfma_f32_16x16x32_bf16 a[164:167], a[84:87], a[24:27], a[164:167]
    ds_read_b64_tr_b16 a[16:17], v15 offset:6176
    s_mul_i32 s63, s63, 294912
    v_mfma_f32_16x16x32_bf16 a[164:167], a[100:103], a[28:31], a[164:167]
    ds_read_b64_tr_b16 a[18:19], v15 offset:9760
    v_mfma_f32_16x16x32_bf16 a[160:163], a[96:99], a[28:31], a[160:163]
    buffer_load_dwordx4 v19, s[56:59], s75 offen offset:1024 lds
    v_mfma_f32_16x16x32_bf16 a[160:163], a[80:83], a[24:27], a[160:163]
    s_add_u32 s63, s63, 16777216
    v_mfma_f32_16x16x32_bf16 a[156:159], a[76:79], a[24:27], a[156:159]
    ds_read_b64_tr_b16 a[20:21], v15 offset:26656
    s_mul_i32 s52, s10, 7
    v_mfma_f32_16x16x32_bf16 a[156:159], a[92:95], a[28:31], a[156:159]
    ds_read_b64_tr_b16 a[22:23], v15 offset:30240
    v_mfma_f32_16x16x32_bf16 a[152:155], a[88:91], a[28:31], a[152:155]
    buffer_load_dwordx4 v20, s[56:59], s75 offen offset:2048 lds
    v_mfma_f32_16x16x32_bf16 a[152:155], a[72:75], a[24:27], a[152:155]
    s_waitcnt lgkmcnt(8)
    s_lshr_b32 s52, s52, 1
    v_mfma_f32_16x16x32_bf16 a[168:171], a[72:75], a[32:35], a[168:171]
    ds_read_b64_tr_b16 a[24:25], v15 offset:6208
    v_mfma_f32_16x16x32_bf16 a[168:171], a[88:91], a[36:39], a[168:171]
    ds_read_b64_tr_b16 a[26:27], v15 offset:9792
    s_lshl_b32 s52, s52, 11
    v_mfma_f32_16x16x32_bf16 a[172:175], a[92:95], a[36:39], a[172:175]
    buffer_load_dwordx4 v21, s[56:59], s75 offen offset:3072 lds
    v_mfma_f32_16x16x32_bf16 a[172:175], a[76:79], a[32:35], a[172:175]
    s_add_u32 s75, s75, 131072
    v_mfma_f32_16x16x32_bf16 a[176:179], a[80:83], a[32:35], a[176:179]
    ds_read_b64_tr_b16 a[28:29], v15 offset:26688
    v_mfma_f32_16x16x32_bf16 a[176:179], a[96:99], a[36:39], a[176:179]
    ds_read_b64_tr_b16 a[30:31], v15 offset:30272
    v_mfma_f32_16x16x32_bf16 a[180:183], a[100:103], a[36:39], a[180:183]
    s_add_u32 s61, s63, s52
    v_mfma_f32_16x16x32_bf16 a[180:183], a[84:87], a[32:35], a[180:183]
    s_and_b32 s62, s10, 1
    v_mfma_f32_16x16x32_bf16 a[196:199], a[84:87], a[0:3], a[196:199]
    ds_read_b64_tr_b16 a[32:33], v15 offset:6240
    s_add_u32 m0, s88, 0
    v_mfma_f32_16x16x32_bf16 a[196:199], a[100:103], a[4:7], a[196:199]
    ds_read_b64_tr_b16 a[34:35], v15 offset:9824
    v_mfma_f32_16x16x32_bf16 a[192:195], a[96:99], a[4:7], a[192:195]
    buffer_load_dwordx4 v18, s[56:59], s75 offen offset:0 lds
    v_mfma_f32_16x16x32_bf16 a[192:195], a[80:83], a[0:3], a[192:195]
    s_lshr_b32 s52, s20, 1
    v_mfma_f32_16x16x32_bf16 a[188:191], a[76:79], a[0:3], a[188:191]
    ds_read_b64_tr_b16 a[36:37], v15 offset:26720
    v_mfma_f32_16x16x32_bf16 a[188:191], a[92:95], a[4:7], a[188:191]
    ds_read_b64_tr_b16 a[38:39], v15 offset:30304
    v_mfma_f32_16x16x32_bf16 a[184:187], a[88:91], a[4:7], a[184:187]
    s_lshl_b32 s52, s52, 12
    v_mfma_f32_16x16x32_bf16 a[184:187], a[72:75], a[0:3], a[184:187]
    s_waitcnt lgkmcnt(8)
    v_mfma_f32_16x16x32_bf16 v[136:139], a[8:11], a[72:75], v[136:139]
    ds_read_b64_tr_b16 a[0:1], v15 offset:6272
    buffer_load_dwordx4 v19, s[56:59], s75 offen offset:1024 lds
    v_mfma_f32_16x16x32_bf16 v[136:139], a[12:15], a[88:91], v[136:139]
    ds_read_b64_tr_b16 a[2:3], v15 offset:9856
    v_mfma_f32_16x16x32_bf16 v[164:167], a[12:15], a[92:95], v[164:167]
    s_add_u32 s73, s52, 5865472
    v_mfma_f32_16x16x32_bf16 v[164:167], a[8:11], a[76:79], v[164:167]
    s_lshl_b32 s53, s98, 11
    v_mfma_f32_16x16x32_bf16 v[192:195], a[8:11], a[80:83], v[192:195]
    ds_read_b64_tr_b16 a[4:5], v15 offset:26752
    v_mfma_f32_16x16x32_bf16 v[192:195], a[12:15], a[96:99], v[192:195]
    ds_read_b64_tr_b16 a[6:7], v15 offset:30336
    v_mfma_f32_16x16x32_bf16 v[220:223], a[12:15], a[100:103], v[220:223]
    buffer_load_dwordx4 v20, s[56:59], s75 offen offset:2048 lds
    v_mfma_f32_16x16x32_bf16 v[220:223], a[8:11], a[84:87], v[220:223]
    s_add_u32 s71, s52, s53
    v_mfma_f32_16x16x32_bf16 v[224:227], a[16:19], a[84:87], v[224:227]
    ds_read_b64_tr_b16 a[8:9], v15 offset:6304
    v_mfma_f32_16x16x32_bf16 v[224:227], a[20:23], a[100:103], v[224:227]
    ds_read_b64_tr_b16 a[10:11], v15 offset:9888
    v_mfma_f32_16x16x32_bf16 v[196:199], a[20:23], a[96:99], v[196:199]
    s_add_u32 s71, s71, 5832704
    v_mfma_f32_16x16x32_bf16 v[196:199], a[16:19], a[80:83], v[196:199]
    buffer_load_dwordx4 v21, s[56:59], s75 offen offset:3072 lds
    v_mfma_f32_16x16x32_bf16 v[168:171], a[16:19], a[76:79], v[168:171]
    ds_read_b64_tr_b16 a[12:13], v15 offset:26784
    s_add_u32 s75, s75, 131072
    v_mfma_f32_16x16x32_bf16 v[168:171], a[20:23], a[92:95], v[168:171]
    ds_read_b64_tr_b16 a[14:15], v15 offset:30368
    v_mfma_f32_16x16x32_bf16 v[140:143], a[20:23], a[88:91], v[140:143]
    s_lshl_b32 s72, s10, 7
    v_mfma_f32_16x16x32_bf16 v[140:143], a[16:19], a[72:75], v[140:143]
    s_waitcnt lgkmcnt(8)
    v_mfma_f32_16x16x32_bf16 v[144:147], a[24:27], a[72:75], v[144:147]
    ds_read_b64_tr_b16 a[16:17], v15 offset:6336
    v_mfma_f32_16x16x32_bf16 v[144:147], a[28:31], a[88:91], v[144:147]
    ds_read_b64_tr_b16 a[18:19], v15 offset:9920
    v_mfma_f32_16x16x32_bf16 v[172:175], a[28:31], a[92:95], v[172:175]
    s_add_u32 s72, s72, 5799936
    v_mfma_f32_16x16x32_bf16 v[172:175], a[24:27], a[76:79], v[172:175]
    s_add_u32 m0, s88, 16384
    v_mfma_f32_16x16x32_bf16 v[200:203], a[24:27], a[80:83], v[200:203]
    ds_read_b64_tr_b16 a[20:21], v15 offset:26816
    v_mfma_f32_16x16x32_bf16 v[200:203], a[28:31], a[96:99], v[200:203]
    ds_read_b64_tr_b16 a[22:23], v15 offset:30400
    buffer_load_dwordx4 v18, s[56:59], s75 offen offset:0 lds
    v_mfma_f32_16x16x32_bf16 v[228:231], a[28:31], a[100:103], v[228:231]
    s_lshl_b32 s52, s20, 2
    v_mfma_f32_16x16x32_bf16 v[228:231], a[24:27], a[84:87], v[228:231]
    s_add_u32 s52, s52, s3
    v_mfma_f32_16x16x32_bf16 v[232:235], a[32:35], a[84:87], v[232:235]
    ds_read_b64_tr_b16 a[24:25], v15 offset:13312
    v_mfma_f32_16x16x32_bf16 v[232:235], a[36:39], a[100:103], v[232:235]
    ds_read_b64_tr_b16 a[26:27], v15 offset:16896
    v_mfma_f32_16x16x32_bf16 v[204:207], a[36:39], a[96:99], v[204:207]
    buffer_load_dwordx4 v19, s[56:59], s75 offen offset:1024 lds
    v_mfma_f32_16x16x32_bf16 v[204:207], a[32:35], a[80:83], v[204:207]
    s_mul_i32 s52, s52, 294912
    v_mfma_f32_16x16x32_bf16 v[176:179], a[32:35], a[76:79], v[176:179]
    ds_read_b64_tr_b16 a[28:29], v15 offset:33792
    v_mfma_f32_16x16x32_bf16 v[176:179], a[36:39], a[92:95], v[176:179]
    ds_read_b64_tr_b16 a[30:31], v15 offset:37376
    v_mfma_f32_16x16x32_bf16 v[148:151], a[36:39], a[88:91], v[148:151]
    s_add_u32 s52, s52, 16777216
    v_mfma_f32_16x16x32_bf16 v[148:151], a[32:35], a[72:75], v[148:151]
    s_waitcnt lgkmcnt(8)
    v_mfma_f32_16x16x32_bf16 v[152:155], a[0:3], a[72:75], v[152:155]
    ds_read_b64_tr_b16 a[32:33], v15 offset:13344
    buffer_load_dwordx4 v20, s[56:59], s75 offen offset:2048 lds
    v_mfma_f32_16x16x32_bf16 v[152:155], a[4:7], a[88:91], v[152:155]
    ds_read_b64_tr_b16 a[34:35], v15 offset:16928
    v_mfma_f32_16x16x32_bf16 v[180:183], a[4:7], a[92:95], v[180:183]
    s_mul_i32 s64, s98, 114688
    v_mfma_f32_16x16x32_bf16 v[180:183], a[0:3], a[76:79], v[180:183]
    s_add_u32 s32, s22, s52
    s_addc_u32 s33, s23, 0
    v_mfma_f32_16x16x32_bf16 v[208:211], a[0:3], a[80:83], v[208:211]
    ds_read_b64_tr_b16 a[36:37], v15 offset:33824
    v_mfma_f32_16x16x32_bf16 v[208:211], a[4:7], a[96:99], v[208:211]
    ds_read_b64_tr_b16 a[38:39], v15 offset:37408
    v_mfma_f32_16x16x32_bf16 v[236:239], a[4:7], a[100:103], v[236:239]
    buffer_load_dwordx4 v21, s[56:59], s75 offen offset:3072 lds
    v_mfma_f32_16x16x32_bf16 v[236:239], a[0:3], a[84:87], v[236:239]
    s_add_u32 s75, s75, 131072
    v_mfma_f32_16x16x32_bf16 v[240:243], a[8:11], a[84:87], v[240:243]
    ds_read_b64_tr_b16 a[0:1], v15 offset:13376
    v_mfma_f32_16x16x32_bf16 v[240:243], a[12:15], a[100:103], v[240:243]
    ds_read_b64_tr_b16 a[2:3], v15 offset:16960
    v_mfma_f32_16x16x32_bf16 v[212:215], a[12:15], a[96:99], v[212:215]
    s_and_b32 s33, s33, 0xffff
    v_mfma_f32_16x16x32_bf16 v[212:215], a[8:11], a[80:83], v[212:215]
    s_mov_b32 s34, 294912
    v_mfma_f32_16x16x32_bf16 v[184:187], a[8:11], a[76:79], v[184:187]
    ds_read_b64_tr_b16 a[4:5], v15 offset:33856
    buffer_load_dwordx4 a[200:203], v22, s[80:83], s96 offen offset:0
    v_mfma_f32_16x16x32_bf16 v[184:187], a[12:15], a[92:95], v[184:187]
    ds_read_b64_tr_b16 a[6:7], v15 offset:37440
    v_mfma_f32_16x16x32_bf16 v[156:159], a[12:15], a[88:91], v[156:159]
    s_mov_b32 s35, 0x00020000
    v_mfma_f32_16x16x32_bf16 v[156:159], a[8:11], a[72:75], v[156:159]
    s_waitcnt lgkmcnt(8)
    v_mfma_f32_16x16x32_bf16 v[160:163], a[16:19], a[72:75], v[160:163]
    ds_read_b64_tr_b16 a[8:9], v15 offset:13408
    v_mfma_f32_16x16x32_bf16 v[160:163], a[20:23], a[88:91], v[160:163]
    ds_read_b64_tr_b16 a[10:11], v15 offset:16992
    v_mfma_f32_16x16x32_bf16 v[188:191], a[20:23], a[92:95], v[188:191]
    buffer_load_dwordx4 a[204:207], v22, s[80:83], s96 offen offset:64
    v_mfma_f32_16x16x32_bf16 v[188:191], a[16:19], a[76:79], v[188:191]
    buffer_load_dwordx4 a[208:211], v22, s[80:83], s97 offen offset:0
    v_mfma_f32_16x16x32_bf16 v[216:219], a[16:19], a[80:83], v[216:219]
    ds_read_b64_tr_b16 a[12:13], v15 offset:33888
    v_mfma_f32_16x16x32_bf16 v[216:219], a[20:23], a[96:99], v[216:219]
    ds_read_b64_tr_b16 a[14:15], v15 offset:37472
    buffer_load_dwordx4 a[212:215], v22, s[80:83], s97 offen offset:64
    v_mfma_f32_16x16x32_bf16 v[244:247], a[20:23], a[100:103], v[244:247]
    s_lshr_b32 s84, s2, 3
    s_mul_i32 s84, s84, 1152
    v_mfma_f32_16x16x32_bf16 v[244:247], a[16:19], a[84:87], v[244:247]
    v_min_u32 v17, 1024, v17
    v_mfma_f32_16x16x32_bf16 v[36:39], a[24:27], a[84:87], v[36:39]
    ds_read_b64_tr_b16 a[16:17], v15 offset:13440
    v_mfma_f32_16x16x32_bf16 v[36:39], a[28:31], a[100:103], v[36:39]
    ds_read_b64_tr_b16 a[18:19], v15 offset:17024
    v_mfma_f32_16x16x32_bf16 v[32:35], a[28:31], a[96:99], v[32:35]
    v_add_u32 v17, s84, v17
    v_mfma_f32_16x16x32_bf16 v[32:35], a[24:27], a[80:83], v[32:35]
    v_min_u32 v17, L_codeend-L_g1end-128, v17
    v_mfma_f32_16x16x32_bf16 v[28:31], a[24:27], a[76:79], v[28:31]
    ds_read_b64_tr_b16 a[20:21], v15 offset:33920
    v_mfma_f32_16x16x32_bf16 v[28:31], a[28:31], a[92:95], v[28:31]
    ds_read_b64_tr_b16 a[22:23], v15 offset:37504
    v_mfma_f32_16x16x32_bf16 v[24:27], a[28:31], a[88:91], v[24:27]
    global_load_dword v23, v17, s[76:77]
    v_mfma_f32_16x16x32_bf16 v[24:27], a[24:27], a[72:75], v[24:27]
    s_waitcnt lgkmcnt(8)
    v_mfma_f32_16x16x32_bf16 v[40:43], a[32:35], a[72:75], v[40:43]
    ds_read_b64_tr_b16 a[24:25], v15 offset:13472
    v_mfma_f32_16x16x32_bf16 v[40:43], a[36:39], a[88:91], v[40:43]
    ds_read_b64_tr_b16 a[26:27], v15 offset:17056
    s_lshl_b32 s70, s11, 5
    s_add_u32 s70, s70, s10
    s_lshl_b32 s70, s70, 7
    v_mfma_f32_16x16x32_bf16 v[44:47], a[36:39], a[92:95], v[44:47]
    s_add_u32 s84, s70, 5832704
    s_add_u32 s85, s70, 5799936
    s_add_u32 s86, s70, 5865472
    v_mfma_f32_16x16x32_bf16 v[44:47], a[32:35], a[76:79], v[44:47]
    v_mfma_f32_16x16x32_bf16 v[48:51], a[32:35], a[80:83], v[48:51]
    ds_read_b64_tr_b16 a[28:29], v15 offset:33952
    v_mfma_f32_16x16x32_bf16 v[48:51], a[36:39], a[96:99], v[48:51]
    ds_read_b64_tr_b16 a[30:31], v15 offset:37536
    v_mfma_f32_16x16x32_bf16 v[52:55], a[36:39], a[100:103], v[52:55]
    v_mfma_f32_16x16x32_bf16 v[52:55], a[32:35], a[84:87], v[52:55]
    v_mfma_f32_16x16x32_bf16 v[68:71], a[0:3], a[84:87], v[68:71]
    ds_read_b64_tr_b16 a[32:33], v15 offset:13504
    v_mfma_f32_16x16x32_bf16 v[68:71], a[4:7], a[100:103], v[68:71]
    ds_read_b64_tr_b16 a[34:35], v15 offset:17088
    v_mfma_f32_16x16x32_bf16 v[64:67], a[4:7], a[96:99], v[64:67]
    ds_read_b64_tr_b16 a[36:37], v15 offset:33984
    v_mfma_f32_16x16x32_bf16 v[64:67], a[0:3], a[80:83], v[64:67]
    ds_read_b64_tr_b16 a[38:39], v15 offset:37568
    v_mfma_f32_16x16x32_bf16 v[60:63], a[0:3], a[76:79], v[60:63]
    v_mfma_f32_16x16x32_bf16 v[60:63], a[4:7], a[92:95], v[60:63]
    v_mfma_f32_16x16x32_bf16 v[56:59], a[4:7], a[88:91], v[56:59]
    s_waitcnt vmcnt(63) lgkmcnt(0)
    v_mfma_f32_16x16x32_bf16 v[56:59], a[0:3], a[72:75], v[56:59]
    s_barrier
    v_mfma_f32_16x16x32_bf16 v[72:75], a[8:11], a[72:75], v[72:75]
    s_add_u32 m0, s88, 65536
    v_mfma_f32_16x16x32_bf16 v[72:75], a[12:15], a[88:91], v[72:75]
    v_mfma_f32_16x16x32_bf16 v[76:79], a[12:15], a[92:95], v[76:79]
    buffer_load_dwordx4 v18, s[56:59], s75 offen offset:0 lds
    v_mfma_f32_16x16x32_bf16 v[76:79], a[8:11], a[76:79], v[76:79]
    v_mfma_f32_16x16x32_bf16 v[80:83], a[8:11], a[80:83], v[80:83]
    v_mfma_f32_16x16x32_bf16 v[80:83], a[12:15], a[96:99], v[80:83]
    buffer_load_dwordx4 v19, s[56:59], s75 offen offset:1024 lds
    v_mfma_f32_16x16x32_bf16 v[84:87], a[12:15], a[100:103], v[84:87]
    v_mfma_f32_16x16x32_bf16 v[84:87], a[8:11], a[84:87], v[84:87]
    buffer_load_dwordx4 v20, s[56:59], s75 offen offset:2048 lds
    v_mfma_f32_16x16x32_bf16 v[100:103], a[16:19], a[84:87], v[100:103]
    v_mfma_f32_16x16x32_bf16 v[100:103], a[20:23], a[100:103], v[100:103]
    v_mfma_f32_16x16x32_bf16 v[96:99], a[20:23], a[96:99], v[96:99]
    buffer_load_dwordx4 v21, s[56:59], s75 offen offset:3072 lds
    v_mfma_f32_16x16x32_bf16 v[96:99], a[16:19], a[80:83], v[96:99]
    v_mfma_f32_16x16x32_bf16 v[92:95], a[16:19], a[76:79], v[92:95]
    s_add_u32 s75, s75, 131072
    v_mfma_f32_16x16x32_bf16 v[92:95], a[20:23], a[92:95], v[92:95]
    v_mfma_f32_16x16x32_bf16 v[88:91], a[20:23], a[88:91], v[88:91]
    v_mfma_f32_16x16x32_bf16 v[88:91], a[16:19], a[72:75], v[88:91]
    s_add_u32 m0, s88, 32768
    v_mfma_f32_16x16x32_bf16 v[104:107], a[24:27], a[72:75], v[104:107]
    v_mfma_f32_16x16x32_bf16 v[104:107], a[28:31], a[88:91], v[104:107]
    v_mfma_f32_16x16x32_bf16 v[108:111], a[28:31], a[92:95], v[108:111]
    buffer_load_dwordx4 v18, s[56:59], s75 offen offset:0 lds
    v_mfma_f32_16x16x32_bf16 v[108:111], a[24:27], a[76:79], v[108:111]
    v_mfma_f32_16x16x32_bf16 v[112:115], a[24:27], a[80:83], v[112:115]
    buffer_load_dwordx4 v19, s[56:59], s75 offen offset:1024 lds
    v_mfma_f32_16x16x32_bf16 v[112:115], a[28:31], a[96:99], v[112:115]
    v_mfma_f32_16x16x32_bf16 v[116:119], a[28:31], a[100:103], v[116:119]
    v_mfma_f32_16x16x32_bf16 v[116:119], a[24:27], a[84:87], v[116:119]
    buffer_load_dwordx4 v20, s[56:59], s75 offen offset:2048 lds
    v_mfma_f32_16x16x32_bf16 v[132:135], a[32:35], a[84:87], v[132:135]
    v_mfma_f32_16x16x32_bf16 v[132:135], a[36:39], a[100:103], v[132:135]
    buffer_load_dwordx4 v21, s[56:59], s75 offen offset:3072 lds
    v_mfma_f32_16x16x32_bf16 v[128:131], a[36:39], a[96:99], v[128:131]
    v_mfma_f32_16x16x32_bf16 v[128:131], a[32:35], a[80:83], v[128:131]
    v_mfma_f32_16x16x32_bf16 v[124:127], a[32:35], a[76:79], v[124:127]
    s_add_u32 s75, s75, 131072
    v_mfma_f32_16x16x32_bf16 v[124:127], a[36:39], a[92:95], v[124:127]
    v_mfma_f32_16x16x32_bf16 v[120:123], a[36:39], a[88:91], v[120:123]
    v_mfma_f32_16x16x32_bf16 v[120:123], a[32:35], a[72:75], v[120:123]
L_g1end:
    s_nop 7
    v_pk_mul_f32 v[2:3], v[136:137], s[46:47]
    v_pk_mul_f32 v[4:5], v[138:139], s[46:47]
    v_exp_f32 v2, v2
    v_exp_f32 v3, v3
    v_exp_f32 v4, v4
    v_exp_f32 v5, v5
    v_pk_mul_f32 v[136:137], v[136:137], v[24:25]
    v_pk_add_f32 v[2:3], v[2:3], 1.0 op_sel_hi:[1,0]
    v_pk_add_f32 v[4:5], v[4:5], 1.0 op_sel_hi:[1,0]
    v_rcp_f32 v2, v2
    v_rcp_f32 v3, v3
    v_rcp_f32 v4, v4
    v_rcp_f32 v5, v5
    v_pk_mul_f32 v[138:139], v[138:139], v[26:27]
    v_pk_mul_f32 v[136:137], v[136:137], v[2:3]
    v_pk_mul_f32 v[138:139], v[138:139], v[4:5]
    v_cvt_pk_bf16_f32 v136, v136, v137
    v_cvt_pk_bf16_f32 v137, v138, v139
    v_pk_mul_f32 v[2:3], v[140:141], s[46:47]
    v_pk_mul_f32 v[4:5], v[142:143], s[46:47]
    v_exp_f32 v2, v2
    v_exp_f32 v3, v3
    v_exp_f32 v4, v4
    v_exp_f32 v5, v5
    v_pk_mul_f32 v[140:141], v[140:141], v[40:41]
    v_pk_add_f32 v[2:3], v[2:3], 1.0 op_sel_hi:[1,0]
    v_pk_add_f32 v[4:5], v[4:5], 1.0 op_sel_hi:[1,0]
    v_rcp_f32 v2, v2
    v_rcp_f32 v3, v3
    v_rcp_f32 v4, v4
    v_rcp_f32 v5, v5
    v_pk_mul_f32 v[142:143], v[142:143], v[42:43]
    v_pk_mul_f32 v[140:141], v[140:141], v[2:3]
    v_pk_mul_f32 v[142:143], v[142:143], v[4:5]
    v_cvt_pk_bf16_f32 v138, v140, v141
    v_cvt_pk_bf16_f32 v139, v142, v143
    v_pk_mul_f32 v[2:3], v[144:145], s[46:47]
    v_pk_mul_f32 v[4:5], v[146:147], s[46:47]
    v_exp_f32 v2, v2
    v_exp_f32 v3, v3
    v_exp_f32 v4, v4
    v_exp_f32 v5, v5
    v_pk_mul_f32 v[144:145], v[144:145], v[56:57]
    v_pk_add_f32 v[2:3], v[2:3], 1.0 op_sel_hi:[1,0]
    v_pk_add_f32 v[4:5], v[4:5], 1.0 op_sel_hi:[1,0]
    v_rcp_f32 v2, v2
    v_rcp_f32 v3, v3
    v_rcp_f32 v4, v4
    v_rcp_f32 v5, v5
    v_pk_mul_f32 v[146:147], v[146:147], v[58:59]
    v_pk_mul_f32 v[144:145], v[144:145], v[2:3]
    v_pk_mul_f32 v[146:147], v[146:147], v[4:5]
    v_cvt_pk_bf16_f32 v140, v144, v145
    v_cvt_pk_bf16_f32 v141, v146, v147
    v_pk_mul_f32 v[2:3], v[148:149], s[46:47]
    v_pk_mul_f32 v[4:5], v[150:151], s[46:47]
    v_exp_f32 v2, v2
    v_exp_f32 v3, v3
    v_exp_f32 v4, v4
    v_exp_f32 v5, v5
    v_pk_mul_f32 v[148:149], v[148:149], v[72:73]
    v_pk_add_f32 v[2:3], v[2:3], 1.0 op_sel_hi:[1,0]
    v_pk_add_f32 v[4:5], v[4:5], 1.0 op_sel_hi:[1,0]
    v_rcp_f32 v2, v2
    v_rcp_f32 v3, v3
    v_rcp_f32 v4, v4
    v_rcp_f32 v5, v5
    v_pk_mul_f32 v[150:151], v[150:151], v[74:75]
    v_pk_mul_f32 v[148:149], v[148:149], v[2:3]
    v_pk_mul_f32 v[150:151], v[150:151], v[4:5]
    v_cvt_pk_bf16_f32 v142, v148, v149
    v_cvt_pk_bf16_f32 v143, v150, v151
    v_pk_mul_f32 v[2:3], v[152:153], s[46:47]
    v_pk_mul_f32 v[4:5], v[154:155], s[46:47]
    v_exp_f32 v2, v2
    v_exp_f32 v3, v3
    v_exp_f32 v4, v4
    v_exp_f32 v5, v5
    v_pk_mul_f32 v[152:153], v[152:153], v[88:89]
    v_pk_add_f32 v[2:3], v[2:3], 1.0 op_sel_hi:[1,0]
    v_pk_add_f32 v[4:5], v[4:5], 1.0 op_sel_hi:[1,0]
    v_rcp_f32 v2, v2
    v_rcp_f32 v3, v3
    v_rcp_f32 v4, v4
    v_rcp_f32 v5, v5
    v_pk_mul_f32 v[154:155], v[154:155], v[90:91]
    v_pk_mul_f32 v[152:153], v[152:153], v[2:3]
    v_pk_mul_f32 v[154:155], v[154:155], v[4:5]
    v_cvt_pk_bf16_f32 v144, v152, v153
    v_cvt_pk_bf16_f32 v145, v154, v155
    v_pk_mul_f32 v[2:3], v[156:157], s[46:47]
    v_pk_mul_f32 v[4:5], v[158:159], s[46:47]
    v_exp_f32 v2, v2
    v_exp_f32 v3, v3
    v_exp_f32 v4, v4
    v_exp_f32 v5, v5
    v_pk_mul_f32 v[156:157], v[156:157], v[104:105]
    v_pk_add_f32 v[2:3], v[2:3], 1.0 op_sel_hi:[1,0]
    v_pk_add_f32 v[4:5], v[4:5], 1.0 op_sel_hi:[1,0]
    v_rcp_f32 v2, v2
    v_rcp_f32 v3, v3
    v_rcp_f32 v4, v4
    v_rcp_f32 v5, v5
    v_pk_mul_f32 v[158:159], v[158:159], v[106:107]
    v_pk_mul_f32 v[156:157], v[156:157], v[2:3]
    v_pk_mul_f32 v[158:159], v[158:159], v[4:5]
    v_cvt_pk_bf16_f32 v146, v156, v157
    v_cvt_pk_bf16_f32 v147, v158, v159
    v_pk_mul_f32 v[2:3], v[160:161], s[46:47]
    v_pk_mul_f32 v[4:5], v[162:163], s[46:47]
    v_exp_f32 v2, v2
    v_exp_f32 v3, v3
    v_exp_f32 v4, v4
    v_exp_f32 v5, v5
    v_pk_mul_f32 v[160:161], v[160:161], v[120:121]
    v_pk_add_f32 v[2:3], v[2:3], 1.0 op_sel_hi:[1,0]
    v_pk_add_f32 v[4:5], v[4:5], 1.0 op_sel_hi:[1,0]
    v_rcp_f32 v2, v2
    v_rcp_f32 v3, v3
    v_rcp_f32 v4, v4
    v_rcp_f32 v5, v5
    v_pk_mul_f32 v[162:163], v[162:163], v[122:123]
    v_pk_mul_f32 v[160:161], v[160:161], v[2:3]
    v_pk_mul_f32 v[162:163], v[162:163], v[4:5]
    v_cvt_pk_bf16_f32 v148, v160, v161
    v_cvt_pk_bf16_f32 v149, v162, v163
    s_add_u32 s52, s61, 0
    s_add_u32 s53, s61, 4096
    s_cmp_eq_u32 s62, 0
    s_cbranch_scc0 L_odd0
    buffer_store_dwordx4 v[136:139], v16, s[40:43], s52 offen sc1
    buffer_store_dwordx4 v[140:143], v16, s[40:43], s52 offen offset:2048 sc1
    buffer_store_dwordx4 v[144:147], v16, s[40:43], s53 offen sc1
    s_branch L_join0
L_odd0:
    buffer_store_dwordx4 v[138:141], v16, s[40:43], s52 offen offset:2048 sc1
    buffer_store_dwordx4 v[142:145], v16, s[40:43], s53 offen sc1
    buffer_store_dwordx4 v[146:149], v16, s[40:43], s53 offen offset:2048 sc1
L_join0:
    v_pk_mul_f32 v[2:3], v[164:165], s[46:47]
    v_pk_mul_f32 v[4:5], v[166:167], s[46:47]
    v_exp_f32 v2, v2
    v_exp_f32 v3, v3
    v_exp_f32 v4, v4
    v_exp_f32 v5, v5
    v_pk_mul_f32 v[164:165], v[164:165], v[28:29]
    v_pk_add_f32 v[2:3], v[2:3], 1.0 op_sel_hi:[1,0]
    v_pk_add_f32 v[4:5], v[4:5], 1.0 op_sel_hi:[1,0]
    v_rcp_f32 v2, v2
    v_rcp_f32 v3, v3
    v_rcp_f32 v4, v4
    v_rcp_f32 v5, v5
    v_pk_mul_f32 v[166:167], v[166:167], v[30:31]
    v_pk_mul_f32 v[164:165], v[164:165], v[2:3]
    v_pk_mul_f32 v[166:167], v[166:167], v[4:5]
    v_cvt_pk_bf16_f32 v164, v164, v165
    v_cvt_pk_bf16_f32 v165, v166, v167
    v_pk_mul_f32 v[2:3], v[168:169], s[46:47]
    v_pk_mul_f32 v[4:5], v[170:171], s[46:47]
    v_exp_f32 v2, v2
    v_exp_f32 v3, v3
    v_exp_f32 v4, v4
    v_exp_f32 v5, v5
    v_pk_mul_f32 v[168:169], v[168:169], v[44:45]
    v_pk_add_f32 v[2:3], v[2:3], 1.0 op_sel_hi:[1,0]
    v_pk_add_f32 v[4:5], v[4:5], 1.0 op_sel_hi:[1,0]
    v_rcp_f32 v2, v2
    v_rcp_f32 v3, v3
    v_rcp_f32 v4, v4
    v_rcp_f32 v5, v5
    v_pk_mul_f32 v[170:171], v[170:171], v[46:47]
    v_pk_mul_f32 v[168:169], v[168:169], v[2:3]
    v_pk_mul_f32 v[170:171], v[170:171], v[4:5]
    v_cvt_pk_bf16_f32 v166, v168, v169
    v_cvt_pk_bf16_f32 v167, v170, v171
    v_pk_mul_f32 v[2:3], v[172:173], s[46:47]
    v_pk_mul_f32 v[4:5], v[174:175], s[46:47]
    v_exp_f32 v2, v2
    v_exp_f32 v3, v3
    v_exp_f32 v4, v4
    v_exp_f32 v5, v5
    v_pk_mul_f32 v[172:173], v[172:173], v[60:61]
    v_pk_add_f32 v[2:3], v[2:3], 1.0 op_sel_hi:[1,0]
    v_pk_add_f32 v[4:5], v[4:5], 1.0 op_sel_hi:[1,0]
    v_rcp_f32 v2, v2
    v_rcp_f32 v3, v3
    v_rcp_f32 v4, v4
    v_rcp_f32 v5, v5
    v_pk_mul_f32 v[174:175], v[174:175], v[62:63]
    v_pk_mul_f32 v[172:173], v[172:173], v[2:3]
    v_pk_mul_f32 v[174:175], v[174:175], v[4:5]
    v_cvt_pk_bf16_f32 v168, v172, v173
    v_cvt_pk_bf16_f32 v169, v174, v175
    v_pk_mul_f32 v[2:3], v[176:177], s[46:47]
    v_pk_mul_f32 v[4:5], v[178:179], s[46:47]
    v_exp_f32 v2, v2
    v_exp_f32 v3, v3
    v_exp_f32 v4, v4
    v_exp_f32 v5, v5
    v_pk_mul_f32 v[176:177], v[176:177], v[76:77]
    v_pk_add_f32 v[2:3], v[2:3], 1.0 op_sel_hi:[1,0]
    v_pk_add_f32 v[4:5], v[4:5], 1.0 op_sel_hi:[1,0]
    v_rcp_f32 v2, v2
    v_rcp_f32 v3, v3
    v_rcp_f32 v4, v4
    v_rcp_f32 v5, v5
    v_pk_mul_f32 v[178:179], v[178:179], v[78:79]
    v_pk_mul_f32 v[176:177], v[176:177], v[2:3]
    v_pk_mul_f32 v[178:179], v[178:179], v[4:5]
    v_cvt_pk_bf16_f32 v170, v176, v177
    v_cvt_pk_bf16_f32 v171, v178, v179
    v_pk_mul_f32 v[2:3], v[180:181], s[46:47]
    v_pk_mul_f32 v[4:5], v[182:183], s[46:47]
    v_exp_f32 v2, v2
    v_exp_f32 v3, v3
    v_exp_f32 v4, v4
    v_exp_f32 v5, v5
    v_pk_mul_f32 v[180:181], v[180:181], v[92:93]
    v_pk_add_f32 v[2:3], v[2:3], 1.0 op_sel_hi:[1,0]
    v_pk_add_f32 v[4:5], v[4:5], 1.0 op_sel_hi:[1,0]
    v_rcp_f32 v2, v2
    v_rcp_f32 v3, v3
    v_rcp_f32 v4, v4
    v_rcp_f32 v5, v5
    v_pk_mul_f32 v[182:183], v[182:183], v[94:95]
    v_pk_mul_f32 v[180:181], v[180:181], v[2:3]
    v_pk_mul_f32 v[182:183], v[182:183], v[4:5]
    v_cvt_pk_bf16_f32 v172, v180, v181
    v_cvt_pk_bf16_f32 v173, v182, v183
    v_pk_mul_f32 v[2:3], v[184:185], s[46:47]
    v_pk_mul_f32 v[4:5], v[186:187], s[46:47]
    v_exp_f32 v2, v2
    v_exp_f32 v3, v3
    v_exp_f32 v4, v4
    v_exp_f32 v5, v5
    v_pk_mul_f32 v[184:185], v[184:185], v[108:109]
    v_pk_add_f32 v[2:3], v[2:3], 1.0 op_sel_hi:[1,0]
    v_pk_add_f32 v[4:5], v[4:5], 1.0 op_sel_hi:[1,0]
    v_rcp_f32 v2, v2
    v_rcp_f32 v3, v3
    v_rcp_f32 v4, v4
    v_rcp_f32 v5, v5
    v_pk_mul_f32 v[186:187], v[186:187], v[110:111]
    v_pk_mul_f32 v[184:185], v[184:185], v[2:3]
    v_pk_mul_f32 v[186:187], v[186:187], v[4:5]
    v_cvt_pk_bf16_f32 v174, v184, v185
    v_cvt_pk_bf16_f32 v175, v186, v187
    v_pk_mul_f32 v[2:3], v[188:189], s[46:47]
    v_pk_mul_f32 v[4:5], v[190:191], s[46:47]
    v_exp_f32 v2, v2
    v_exp_f32 v3, v3
    v_exp_f32 v4, v4
    v_exp_f32 v5, v5
    v_pk_mul_f32 v[188:189], v[188:189], v[124:125]
    v_pk_add_f32 v[2:3], v[2:3], 1.0 op_sel_hi:[1,0]
    v_pk_add_f32 v[4:5], v[4:5], 1.0 op_sel_hi:[1,0]
    v_rcp_f32 v2, v2
    v_rcp_f32 v3, v3
    v_rcp_f32 v4, v4
    v_rcp_f32 v5, v5
    v_pk_mul_f32 v[190:191], v[190:191], v[126:127]
    v_pk_mul_f32 v[188:189], v[188:189], v[2:3]
    v_pk_mul_f32 v[190:191], v[190:191], v[4:5]
    v_cvt_pk_bf16_f32 v176, v188, v189
    v_cvt_pk_bf16_f32 v177, v190, v191
    s_add_u32 s52, s61, 1024
    s_add_u32 s53, s61, 5120
    s_cmp_eq_u32 s62, 0
    s_cbranch_scc0 L_odd1
    buffer_store_dwordx4 v[164:167], v16, s[40:43], s52 offen sc1
    buffer_store_dwordx4 v[168:171], v16, s[40:43], s52 offen offset:2048 sc1
    buffer_store_dwordx4 v[172:175], v16, s[40:43], s53 offen sc1
    v_mov_b32 v150, v176
    v_mov_b32 v151, v177
    buffer_store_dwordx4 v[148:151], v16, s[40:43], s53 offen offset:1024 sc1
    s_branch L_join1
L_odd1:
    v_mov_b32 v150, v136
    v_mov_b32 v151, v137
    v_mov_b32 v152, v164
    v_mov_b32 v153, v165
    buffer_store_dwordx4 v[150:153], v16, s[40:43], s52 offen sc1
    buffer_store_dwordx4 v[166:169], v16, s[40:43], s52 offen offset:2048 sc1
    buffer_store_dwordx4 v[170:173], v16, s[40:43], s53 offen sc1
    buffer_store_dwordx4 v[174:177], v16, s[40:43], s53 offen offset:2048 sc1
L_join1:
    v_pk_mul_f32 v[2:3], v[192:193], s[46:47]
    v_pk_mul_f32 v[4:5], v[194:195], s[46:47]
    v_exp_f32 v2, v2
    v_exp_f32 v3, v3
    v_exp_f32 v4, v4
    v_exp_f32 v5, v5
    v_pk_mul_f32 v[192:193], v[192:193], v[32:33]
    v_pk_add_f32 v[2:3], v[2:3], 1.0 op_sel_hi:[1,0]
    v_pk_add_f32 v[4:5], v[4:5], 1.0 op_sel_hi:[1,0]
    v_rcp_f32 v2, v2
    v_rcp_f32 v3, v3
    v_rcp_f32 v4, v4
    v_rcp_f32 v5, v5
    v_pk_mul_f32 v[194:195], v[194:195], v[34:35]
    v_pk_mul_f32 v[192:193], v[192:193], v[2:3]
    v_pk_mul_f32 v[194:195], v[194:195], v[4:5]
    v_cvt_pk_bf16_f32 v192, v192, v193
    v_cvt_pk_bf16_f32 v193, v194, v195
    v_pk_mul_f32 v[2:3], v[196:197], s[46:47]
    v_pk_mul_f32 v[4:5], v[198:199], s[46:47]
    v_exp_f32 v2, v2
    v_exp_f32 v3, v3
    v_exp_f32 v4, v4
    v_exp_f32 v5, v5
    v_pk_mul_f32 v[196:197], v[196:197], v[48:49]
    v_pk_add_f32 v[2:3], v[2:3], 1.0 op_sel_hi:[1,0]
    v_pk_add_f32 v[4:5], v[4:5], 1.0 op_sel_hi:[1,0]
    v_rcp_f32 v2, v2
    v_rcp_f32 v3, v3
    v_rcp_f32 v4, v4
    v_rcp_f32 v5, v5
    v_pk_mul_f32 v[198:199], v[198:199], v[50:51]
    v_pk_mul_f32 v[196:197], v[196:197], v[2:3]
    v_pk_mul_f32 v[198:199], v[198:199], v[4:5]
    v_cvt_pk_bf16_f32 v194, v196, v197
    v_cvt_pk_bf16_f32 v195, v198, v199
    v_pk_mul_f32 v[2:3], v[200:201], s[46:47]
    v_pk_mul_f32 v[4:5], v[202:203], s[46:47]
    v_exp_f32 v2, v2
    v_exp_f32 v3, v3
    v_exp_f32 v4, v4
    v_exp_f32 v5, v5
    v_pk_mul_f32 v[200:201], v[200:201], v[64:65]
    v_pk_add_f32 v[2:3], v[2:3], 1.0 op_sel_hi:[1,0]
    v_pk_add_f32 v[4:5], v[4:5], 1.0 op_sel_hi:[1,0]
    v_rcp_f32 v2, v2
    v_rcp_f32 v3, v3
    v_rcp_f32 v4, v4
    v_rcp_f32 v5, v5
    v_pk_mul_f32 v[202:203], v[202:203], v[66:67]
    v_pk_mul_f32 v[200:201], v[200:201], v[2:3]
    v_pk_mul_f32 v[202:203], v[202:203], v[4:5]
    v_cvt_pk_bf16_f32 v196, v200, v201
    v_cvt_pk_bf16_f32 v197, v202, v203
    v_pk_mul_f32 v[2:3], v[204:205], s[46:47]
    v_pk_mul_f32 v[4:5], v[206:207], s[46:47]
    v_exp_f32 v2, v2
    v_exp_f32 v3, v3
    v_exp_f32 v4, v4
    v_exp_f32 v5, v5
    v_pk_mul_f32 v[204:205], v[204:205], v[80:81]
    v_pk_add_f32 v[2:3], v[2:3], 1.0 op_sel_hi:[1,0]
    v_pk_add_f32 v[4:5], v[4:5], 1.0 op_sel_hi:[1,0]
    v_rcp_f32 v2, v2
    v_rcp_f32 v3, v3
    v_rcp_f32 v4, v4
    v_rcp_f32 v5, v5
    v_pk_mul_f32 v[206:207], v[206:207], v[82:83]
    v_pk_mul_f32 v[204:205], v[204:205], v[2:3]
    v_pk_mul_f32 v[206:207], v[206:207], v[4:5]
    v_cvt_pk_bf16_f32 v198, v204, v205
    v_cvt_pk_bf16_f32 v199, v206, v207
    v_pk_mul_f32 v[2:3], v[208:209], s[46:47]
    v_pk_mul_f32 v[4:5], v[210:211], s[46:47]
    v_exp_f32 v2, v2
    v_exp_f32 v3, v3
    v_exp_f32 v4, v4
    v_exp_f32 v5, v5
    v_pk_mul_f32 v[208:209], v[208:209], v[96:97]
    v_pk_add_f32 v[2:3], v[2:3], 1.0 op_sel_hi:[1,0]
    v_pk_add_f32 v[4:5], v[4:5], 1.0 op_sel_hi:[1,0]
    v_rcp_f32 v2, v2
    v_rcp_f32 v3, v3
    v_rcp_f32 v4, v4
    v_rcp_f32 v5, v5
    v_pk_mul_f32 v[210:211], v[210:211], v[98:99]
    v_pk_mul_f32 v[208:209], v[208:209], v[2:3]
    v_pk_mul_f32 v[210:211], v[210:211], v[4:5]
    v_cvt_pk_bf16_f32 v200, v208, v209
    v_cvt_pk_bf16_f32 v201, v210, v211
    v_pk_mul_f32 v[2:3], v[212:213], s[46:47]
    v_pk_mul_f32 v[4:5], v[214:215], s[46:47]
    v_exp_f32 v2, v2
    v_exp_f32 v3, v3
    v_exp_f32 v4, v4
    v_exp_f32 v5, v5
    v_pk_mul_f32 v[212:213], v[212:213], v[112:113]
    v_pk_add_f32 v[2:3], v[2:3], 1.0 op_sel_hi:[1,0]
    v_pk_add_f32 v[4:5], v[4:5], 1.0 op_sel_hi:[1,0]
    v_rcp_f32 v2, v2
    v_rcp_f32 v3, v3
    v_rcp_f32 v4, v4
    v_rcp_f32 v5, v5
    v_pk_mul_f32 v[214:215], v[214:215], v[114:115]
    v_pk_mul_f32 v[212:213], v[212:213], v[2:3]
    v_pk_mul_f32 v[214:215], v[214:215], v[4:5]
    v_cvt_pk_bf16_f32 v202, v212, v213
    v_cvt_pk_bf16_f32 v203, v214, v215
    v_pk_mul_f32 v[2:3], v[216:217], s[46:47]
    v_pk_mul_f32 v[4:5], v[218:219], s[46:47]
    v_exp_f32 v2, v2
    v_exp_f32 v3, v3
    v_exp_f32 v4, v4
    v_exp_f32 v5, v5
    v_pk_mul_f32 v[216:217], v[216:217], v[128:129]
    v_pk_add_f32 v[2:3], v[2:3], 1.0 op_sel_hi:[1,0]
    v_pk_add_f32 v[4:5], v[4:5], 1.0 op_sel_hi:[1,0]
    v_rcp_f32 v2, v2
    v_rcp_f32 v3, v3
    v_rcp_f32 v4, v4
    v_rcp_f32 v5, v5
    v_pk_mul_f32 v[218:219], v[218:219], v[130:131]
    v_pk_mul_f32 v[216:217], v[216:217], v[2:3]
    v_pk_mul_f32 v[218:219], v[218:219], v[4:5]
    v_cvt_pk_bf16_f32 v204, v216, v217
    v_cvt_pk_bf16_f32 v205, v218, v219
    s_add_u32 s52, s61, 294912
    s_add_u32 s53, s61, 299008
    s_cmp_eq_u32 s62, 0
    s_cbranch_scc0 L_odd2
    buffer_store_dwordx4 v[192:195], v16, s[40:43], s52 offen sc1
    buffer_store_dwordx4 v[196:199], v16, s[40:43], s52 offen offset:2048 sc1
    buffer_store_dwordx4 v[200:203], v16, s[40:43], s53 offen sc1
    s_branch L_join2
L_odd2:
    buffer_store_dwordx4 v[194:197], v16, s[40:43], s52 offen offset:2048 sc1
    buffer_store_dwordx4 v[198:201], v16, s[40:43], s53 offen sc1
    buffer_store_dwordx4 v[202:205], v16, s[40:43], s53 offen offset:2048 sc1
L_join2:
    v_pk_mul_f32 v[2:3], v[220:221], s[46:47]
    v_pk_mul_f32 v[4:5], v[222:223], s[46:47]
    v_exp_f32 v2, v2
    v_exp_f32 v3, v3
    v_exp_f32 v4, v4
    v_exp_f32 v5, v5
    v_pk_mul_f32 v[220:221], v[220:221], v[36:37]
    v_pk_add_f32 v[2:3], v[2:3], 1.0 op_sel_hi:[1,0]
    v_pk_add_f32 v[4:5], v[4:5], 1.0 op_sel_hi:[1,0]
    v_rcp_f32 v2, v2
    v_rcp_f32 v3, v3
    v_rcp_f32 v4, v4
    v_rcp_f32 v5, v5
    v_pk_mul_f32 v[222:223], v[222:223], v[38:39]
    v_pk_mul_f32 v[220:221], v[220:221], v[2:3]
    v_pk_mul_f32 v[222:223], v[222:223], v[4:5]
    v_cvt_pk_bf16_f32 v220, v220, v221
    v_cvt_pk_bf16_f32 v221, v222, v223
    v_pk_mul_f32 v[2:3], v[224:225], s[46:47]
    v_pk_mul_f32 v[4:5], v[226:227], s[46:47]
    v_exp_f32 v2, v2
    v_exp_f32 v3, v3
    v_exp_f32 v4, v4
    v_exp_f32 v5, v5
    v_pk_mul_f32 v[224:225], v[224:225], v[52:53]
    v_pk_add_f32 v[2:3], v[2:3], 1.0 op_sel_hi:[1,0]
    v_pk_add_f32 v[4:5], v[4:5], 1.0 op_sel_hi:[1,0]
    v_rcp_f32 v2, v2
    v_rcp_f32 v3, v3
    v_rcp_f32 v4, v4
    v_rcp_f32 v5, v5
    v_pk_mul_f32 v[226:227], v[226:227], v[54:55]
    v_pk_mul_f32 v[224:225], v[224:225], v[2:3]
    v_pk_mul_f32 v[226:227], v[226:227], v[4:5]
    v_cvt_pk_bf16_f32 v222, v224, v225
    v_cvt_pk_bf16_f32 v223, v226, v227
    v_pk_mul_f32 v[2:3], v[228:229], s[46:47]
    v_pk_mul_f32 v[4:5], v[230:231], s[46:47]
    v_exp_f32 v2, v2
    v_exp_f32 v3, v3
    v_exp_f32 v4, v4
    v_exp_f32 v5, v5
    v_pk_mul_f32 v[228:229], v[228:229], v[68:69]
    v_pk_add_f32 v[2:3], v[2:3], 1.0 op_sel_hi:[1,0]
    v_pk_add_f32 v[4:5], v[4:5], 1.0 op_sel_hi:[1,0]
    v_rcp_f32 v2, v2
    v_rcp_f32 v3, v3
    v_rcp_f32 v4, v4
    v_rcp_f32 v5, v5
    v_pk_mul_f32 v[230:231], v[230:231], v[70:71]
    v_pk_mul_f32 v[228:229], v[228:229], v[2:3]
    v_pk_mul_f32 v[230:231], v[230:231], v[4:5]
    v_cvt_pk_bf16_f32 v224, v228, v229
    v_cvt_pk_bf16_f32 v225, v230, v231
    v_pk_mul_f32 v[2:3], v[232:233], s[46:47]
    v_pk_mul_f32 v[4:5], v[234:235], s[46:47]
    v_exp_f32 v2, v2
    v_exp_f32 v3, v3
    v_exp_f32 v4, v4
    v_exp_f32 v5, v5
    v_pk_mul_f32 v[232:233], v[232:233], v[84:85]
    v_pk_add_f32 v[2:3], v[2:3], 1.0 op_sel_hi:[1,0]
    v_pk_add_f32 v[4:5], v[4:5], 1.0 op_sel_hi:[1,0]
    v_rcp_f32 v2, v2
    v_rcp_f32 v3, v3
    v_rcp_f32 v4, v4
    v_rcp_f32 v5, v5
    v_pk_mul_f32 v[234:235], v[234:235], v[86:87]
    v_pk_mul_f32 v[232:233], v[232:233], v[2:3]
    v_pk_mul_f32 v[234:235], v[234:235], v[4:5]
    v_cvt_pk_bf16_f32 v226, v232, v233
    v_cvt_pk_bf16_f32 v227, v234, v235
    v_pk_mul_f32 v[2:3], v[236:237], s[46:47]
    v_pk_mul_f32 v[4:5], v[238:239], s[46:47]
    v_exp_f32 v2, v2
    v_exp_f32 v3, v3
    v_exp_f32 v4, v4
    v_exp_f32 v5, v5
    v_pk_mul_f32 v[236:237], v[236:237], v[100:101]
    v_pk_add_f32 v[2:3], v[2:3], 1.0 op_sel_hi:[1,0]
    v_pk_add_f32 v[4:5], v[4:5], 1.0 op_sel_hi:[1,0]
    v_rcp_f32 v2, v2
    v_rcp_f32 v3, v3
    v_rcp_f32 v4, v4
    v_rcp_f32 v5, v5
    v_pk_mul_f32 v[238:239], v[238:239], v[102:103]
    v_pk_mul_f32 v[236:237], v[236:237], v[2:3]
    v_pk_mul_f32 v[238:239], v[238:239], v[4:5]
    v_cvt_pk_bf16_f32 v228, v236, v237
    v_cvt_pk_bf16_f32 v229, v238, v239
    v_pk_mul_f32 v[2:3], v[240:241], s[46:47]
    v_pk_mul_f32 v[4:5], v[242:243], s[46:47]
    v_exp_f32 v2, v2
    v_exp_f32 v3, v3
    v_exp_f32 v4, v4
    v_exp_f32 v5, v5
    v_pk_mul_f32 v[240:241], v[240:241], v[116:117]
    v_pk_add_f32 v[2:3], v[2:3], 1.0 op_sel_hi:[1,0]
    v_pk_add_f32 v[4:5], v[4:5], 1.0 op_sel_hi:[1,0]
    v_rcp_f32 v2, v2
    v_rcp_f32 v3, v3
    v_rcp_f32 v4, v4
    v_rcp_f32 v5, v5
    v_pk_mul_f32 v[242:243], v[242:243], v[118:119]
    v_pk_mul_f32 v[240:241], v[240:241], v[2:3]
    v_pk_mul_f32 v[242:243], v[242:243], v[4:5]
    v_cvt_pk_bf16_f32 v230, v240, v241
    v_cvt_pk_bf16_f32 v231, v242, v243
    v_pk_mul_f32 v[2:3], v[244:245], s[46:47]
    v_pk_mul_f32 v[4:5], v[246:247], s[46:47]
    v_exp_f32 v2, v2
    v_exp_f32 v3, v3
    v_exp_f32 v4, v4
    v_exp_f32 v5, v5
    v_pk_mul_f32 v[244:245], v[244:245], v[132:133]
    v_pk_add_f32 v[2:3], v[2:3], 1.0 op_sel_hi:[1,0]
    v_pk_add_f32 v[4:5], v[4:5], 1.0 op_sel_hi:[1,0]
    v_rcp_f32 v2, v2
    v_rcp_f32 v3, v3
    v_rcp_f32 v4, v4
    v_rcp_f32 v5, v5
    v_pk_mul_f32 v[246:247], v[246:247], v[134:135]
    v_pk_mul_f32 v[244:245], v[244:245], v[2:3]
    v_pk_mul_f32 v[246:247], v[246:247], v[4:5]
    v_cvt_pk_bf16_f32 v232, v244, v245
    v_cvt_pk_bf16_f32 v233, v246, v247
    s_add_u32 s52, s61, 295936
    s_add_u32 s53, s61, 300032
    s_cmp_eq_u32 s62, 0
    s_cbranch_scc0 L_odd3
    buffer_store_dwordx4 v[220:223], v16, s[40:43], s52 offen sc1
    buffer_store_dwordx4 v[224:227], v16, s[40:43], s52 offen offset:2048 sc1
    buffer_store_dwordx4 v[228:231], v16, s[40:43], s53 offen sc1
    v_mov_b32 v206, v232
    v_mov_b32 v207, v233
    buffer_store_dwordx4 v[204:207], v16, s[40:43], s53 offen offset:1024 sc1
    s_branch L_join3
L_odd3:
    v_mov_b32 v206, v192
    v_mov_b32 v207, v193
    v_mov_b32 v208, v220
    v_mov_b32 v209, v221
    buffer_store_dwordx4 v[206:209], v16, s[40:43], s52 offen sc1
    buffer_store_dwordx4 v[222:225], v16, s[40:43], s52 offen offset:2048 sc1
    buffer_store_dwordx4 v[226:229], v16, s[40:43], s53 offen sc1
    buffer_store_dwordx4 v[230:233], v16, s[40:43], s53 offen offset:2048 sc1
L_join3:
    v_mov_b32 v10, v18
    v_mov_b32 v11, v19
    v_mov_b32 v12, v20
    v_mov_b32 v13, v21
    v_mov_b32 v15, v22
    v_accvgpr_read_b32 v24, a104
    v_accvgpr_read_b32 v25, a105
    v_accvgpr_read_b32 v26, a106
    v_accvgpr_read_b32 v27, a107
    v_accvgpr_read_b32 v28, a108
    v_accvgpr_read_b32 v29, a109
    v_accvgpr_read_b32 v30, a110
    v_accvgpr_read_b32 v31, a111
    v_accvgpr_read_b32 v32, a112
    v_accvgpr_read_b32 v33, a113
    v_accvgpr_read_b32 v34, a114
    v_accvgpr_read_b32 v35, a115
    v_accvgpr_read_b32 v36, a116
    v_accvgpr_read_b32 v37, a117
    v_accvgpr_read_b32 v38, a118
    v_accvgpr_read_b32 v39, a119
    v_accvgpr_read_b32 v40, a120
    v_accvgpr_read_b32 v41, a121
    v_accvgpr_read_b32 v42, a122
    v_accvgpr_read_b32 v43, a123
    v_accvgpr_read_b32 v44, a124
    v_accvgpr_read_b32 v45, a125
    v_accvgpr_read_b32 v46, a126
    v_accvgpr_read_b32 v47, a127
    v_accvgpr_read_b32 v48, a128
    v_accvgpr_read_b32 v49, a129
    v_accvgpr_read_b32 v50, a130
    v_accvgpr_read_b32 v51, a131
    v_accvgpr_read_b32 v52, a132
    v_accvgpr_read_b32 v53, a133
    v_accvgpr_read_b32 v54, a134
    v_accvgpr_read_b32 v55, a135
    v_accvgpr_read_b32 v56, a136
    v_accvgpr_read_b32 v57, a137
    v_accvgpr_read_b32 v58, a138
    v_accvgpr_read_b32 v59, a139
    v_accvgpr_read_b32 v60, a140
    v_accvgpr_read_b32 v61, a141
    v_accvgpr_read_b32 v62, a142
    v_accvgpr_read_b32 v63, a143
    v_accvgpr_read_b32 v64, a144
    v_accvgpr_read_b32 v65, a145
    v_accvgpr_read_b32 v66, a146
    v_accvgpr_read_b32 v67, a147
    v_accvgpr_read_b32 v68, a148
    v_accvgpr_read_b32 v69, a149
    v_accvgpr_read_b32 v70, a150
    v_accvgpr_read_b32 v71, a151
    v_accvgpr_read_b32 v72, a152
    v_accvgpr_read_b32 v73, a153
    v_accvgpr_read_b32 v74, a154
    v_accvgpr_read_b32 v75, a155
    v_accvgpr_read_b32 v76, a156
    v_accvgpr_read_b32 v77, a157
    v_accvgpr_read_b32 v78, a158
    v_accvgpr_read_b32 v79, a159
    v_accvgpr_read_b32 v80, a160
    v_accvgpr_read_b32 v81, a161
    v_accvgpr_read_b32 v82, a162
    v_accvgpr_read_b32 v83, a163
    v_accvgpr_read_b32 v84, a164
    v_accvgpr_read_b32 v85, a165
    v_accvgpr_read_b32 v86, a166
    v_accvgpr_read_b32 v87, a167
    v_accvgpr_read_b32 v88, a168
    v_accvgpr_read_b32 v89, a169
    v_accvgpr_read_b32 v90, a170
    v_accvgpr_read_b32 v91, a171
    v_accvgpr_read_b32 v92, a172
    v_accvgpr_read_b32 v93, a173
    v_accvgpr_read_b32 v94, a174
    v_accvgpr_read_b32 v95, a175
    v_accvgpr_read_b32 v96, a176
    v_accvgpr_read_b32 v97, a177
    v_accvgpr_read_b32 v98, a178
    v_accvgpr_read_b32 v99, a179
    v_accvgpr_read_b32 v100, a180
    v_accvgpr_read_b32 v101, a181
    v_accvgpr_read_b32 v102, a182
    v_accvgpr_read_b32 v103, a183
    v_accvgpr_read_b32 v104, a184
    v_accvgpr_read_b32 v105, a185
    v_accvgpr_read_b32 v106, a186
    v_accvgpr_read_b32 v107, a187
    v_accvgpr_read_b32 v108, a188
    v_accvgpr_read_b32 v109, a189
    v_accvgpr_read_b32 v110, a190
    v_accvgpr_read_b32 v111, a191
    v_accvgpr_read_b32 v112, a192
    v_accvgpr_read_b32 v113, a193
    v_accvgpr_read_b32 v114, a194
    v_accvgpr_read_b32 v115, a195
    v_accvgpr_read_b32 v116, a196
    v_accvgpr_read_b32 v117, a197
    v_accvgpr_read_b32 v118, a198
    v_accvgpr_read_b32 v119, a199
    v_mov_b32 v2, 0x3f803f80
    v_mov_b32 v3, 0x3f803f80
    v_mov_b32 v4, 0x3f803f80
    v_mov_b32 v5, 0x3f803f80
    v_pk_mul_f32 v[18:19], v[56:57], s[44:45]
    v_pk_mul_f32 v[20:21], v[58:59], s[44:45]
    v_exp_f32_e64 v18, v18 clamp
    v_exp_f32_e64 v19, v19 clamp
    v_exp_f32_e64 v20, v20 clamp
    v_exp_f32_e64 v21, v21 clamp
    v_max_f32 v56, 0, v56
    v_max_f32 v57, 0, v57
    v_max_f32 v58, 0, v58
    v_max_f32 v59, 0, v59
    v_pk_add_f32 v[56:57], v[56:57], v[18:19]
    v_pk_add_f32 v[58:59], v[58:59], v[20:21]
    v_pk_add_f32 v[56:57], v[56:57], s[48:49]
    v_pk_add_f32 v[58:59], v[58:59], s[48:49]
    v_pk_mul_f32 v[18:19], v[60:61], s[44:45]
    v_pk_mul_f32 v[20:21], v[62:63], s[44:45]
    v_exp_f32_e64 v18, v18 clamp
    v_exp_f32_e64 v19, v19 clamp
    v_exp_f32_e64 v20, v20 clamp
    v_exp_f32_e64 v21, v21 clamp
    v_max_f32 v60, 0, v60
    v_max_f32 v61, 0, v61
    v_max_f32 v62, 0, v62
    v_max_f32 v63, 0, v63
    v_pk_add_f32 v[60:61], v[60:61], v[18:19]
    v_pk_add_f32 v[62:63], v[62:63], v[20:21]
    v_pk_add_f32 v[60:61], v[60:61], s[48:49]
    v_pk_add_f32 v[62:63], v[62:63], s[48:49]
    v_pk_mul_f32 v[18:19], v[64:65], s[44:45]
    v_pk_mul_f32 v[20:21], v[66:67], s[44:45]
    v_exp_f32_e64 v18, v18 clamp
    v_exp_f32_e64 v19, v19 clamp
    v_exp_f32_e64 v20, v20 clamp
    v_exp_f32_e64 v21, v21 clamp
    v_max_f32 v64, 0, v64
    v_max_f32 v65, 0, v65
    v_max_f32 v66, 0, v66
    v_max_f32 v67, 0, v67
    v_pk_add_f32 v[64:65], v[64:65], v[18:19]
    v_pk_add_f32 v[66:67], v[66:67], v[20:21]
    v_pk_add_f32 v[64:65], v[64:65], s[48:49]
    v_pk_add_f32 v[66:67], v[66:67], s[48:49]
    v_pk_mul_f32 v[18:19], v[68:69], s[44:45]
    v_pk_mul_f32 v[20:21], v[70:71], s[44:45]
    v_exp_f32_e64 v18, v18 clamp
    v_exp_f32_e64 v19, v19 clamp
    v_exp_f32_e64 v20, v20 clamp
    v_exp_f32_e64 v21, v21 clamp
    v_max_f32 v68, 0, v68
    v_max_f32 v69, 0, v69
    v_max_f32 v70, 0, v70
    v_max_f32 v71, 0, v71
    v_pk_add_f32 v[68:69], v[68:69], v[18:19]
    v_pk_add_f32 v[70:71], v[70:71], v[20:21]
    v_pk_add_f32 v[68:69], v[68:69], s[48:49]
    v_pk_add_f32 v[70:71], v[70:71], s[48:49]
    s_waitcnt vmcnt(0)
    s_barrier
    s_cmp_eq_u32 s3, 0
    s_cbranch_scc0 L_sig1
    v_mov_b32 v18, s92
    v_mov_b32 v19, s93
    v_mov_b32 v20, s92
    v_mov_b32 v21, s93
    s_mov_b64 exec, 0xff
    buffer_store_dwordx4 v[18:21], v16, s[40:43], s84 offen sc0 sc1
    s_mov_b64 exec, -1
    s_nop 0
L_sig1:
    s_mov_b32 s51, 0
    v_pk_mul_f32 v[18:19], v[72:73], s[44:45]
    v_pk_mul_f32 v[20:21], v[74:75], s[44:45]
    v_exp_f32_e64 v18, v18 clamp
    v_exp_f32_e64 v19, v19 clamp
    v_exp_f32_e64 v20, v20 clamp
    v_exp_f32_e64 v21, v21 clamp
    v_max_f32 v72, 0, v72
    v_max_f32 v73, 0, v73
    v_max_f32 v74, 0, v74
    v_max_f32 v75, 0, v75
    v_pk_add_f32 v[72:73], v[72:73], v[18:19]
    v_pk_add_f32 v[74:75], v[74:75], v[20:21]
    v_pk_add_f32 v[72:73], v[72:73], s[48:49]
    v_pk_add_f32 v[74:75], v[74:75], s[48:49]
    v_pk_mul_f32 v[18:19], v[76:77], s[44:45]
    v_pk_mul_f32 v[20:21], v[78:79], s[44:45]
    v_exp_f32_e64 v18, v18 clamp
    v_exp_f32_e64 v19, v19 clamp
    v_exp_f32_e64 v20, v20 clamp
    v_exp_f32_e64 v21, v21 clamp
    v_max_f32 v76, 0, v76
    v_max_f32 v77, 0, v77
    v_max_f32 v78, 0, v78
    v_max_f32 v79, 0, v79
    v_pk_add_f32 v[76:77], v[76:77], v[18:19]
    v_pk_add_f32 v[78:79], v[78:79], v[20:21]
    v_pk_add_f32 v[76:77], v[76:77], s[48:49]
    v_pk_add_f32 v[78:79], v[78:79], s[48:49]
    v_pk_mul_f32 v[18:19], v[80:81], s[44:45]
    v_pk_mul_f32 v[20:21], v[82:83], s[44:45]
    v_exp_f32_e64 v18, v18 clamp
    v_exp_f32_e64 v19, v19 clamp
    v_exp_f32_e64 v20, v20 clamp
    v_exp_f32_e64 v21, v21 clamp
    v_max_f32 v80, 0, v80
    v_max_f32 v81, 0, v81
    v_max_f32 v82, 0, v82
    v_max_f32 v83, 0, v83
    v_pk_add_f32 v[80:81], v[80:81], v[18:19]
    v_pk_add_f32 v[82:83], v[82:83], v[20:21]
    v_pk_add_f32 v[80:81], v[80:81], s[48:49]
    v_pk_add_f32 v[82:83], v[82:83], s[48:49]
    v_pk_mul_f32 v[18:19], v[84:85], s[44:45]
    v_pk_mul_f32 v[20:21], v[86:87], s[44:45]
    v_exp_f32_e64 v18, v18 clamp
    v_exp_f32_e64 v19, v19 clamp
    v_exp_f32_e64 v20, v20 clamp
    v_exp_f32_e64 v21, v21 clamp
    v_max_f32 v84, 0, v84
    v_max_f32 v85, 0, v85
    v_max_f32 v86, 0, v86
    v_max_f32 v87, 0, v87
    v_pk_add_f32 v[84:85], v[84:85], v[18:19]
    v_pk_add_f32 v[86:87], v[86:87], v[20:21]
    v_pk_add_f32 v[84:85], v[84:85], s[48:49]
    v_pk_add_f32 v[86:87], v[86:87], s[48:49]
    v_cvt_pk_bf16_f32 v56, v56, v57
    v_cvt_pk_bf16_f32 v57, v58, v59
    v_cvt_pk_bf16_f32 v58, v60, v61
    v_cvt_pk_bf16_f32 v59, v62, v63
    v_cvt_pk_bf16_f32 v64, v64, v65
    v_cvt_pk_bf16_f32 v65, v66, v67
    v_cvt_pk_bf16_f32 v66, v68, v69
    v_cvt_pk_bf16_f32 v67, v70, v71
    v_cvt_pk_bf16_f32 v72, v72, v73
    v_cvt_pk_bf16_f32 v73, v74, v75
    v_cvt_pk_bf16_f32 v74, v76, v77
    v_cvt_pk_bf16_f32 v75, v78, v79
    v_cvt_pk_bf16_f32 v80, v80, v81
    v_cvt_pk_bf16_f32 v81, v82, v83
    v_cvt_pk_bf16_f32 v82, v84, v85
    v_cvt_pk_bf16_f32 v83, v86, v87
    v_cvt_pk_bf16_f32 v88, v88, v89
    v_cvt_pk_bf16_f32 v89, v90, v91
    v_cvt_pk_bf16_f32 v90, v92, v93
    v_cvt_pk_bf16_f32 v91, v94, v95
    v_cvt_pk_bf16_f32 v96, v96, v97
    v_cvt_pk_bf16_f32 v97, v98, v99
    v_cvt_pk_bf16_f32 v98, v100, v101
    v_cvt_pk_bf16_f32 v99, v102, v103
    v_cvt_pk_bf16_f32 v104, v104, v105
    v_cvt_pk_bf16_f32 v105, v106, v107
    v_cvt_pk_bf16_f32 v106, v108, v109
    v_cvt_pk_bf16_f32 v107, v110, v111
    v_cvt_pk_bf16_f32 v112, v112, v113
    v_cvt_pk_bf16_f32 v113, v114, v115
    v_cvt_pk_bf16_f32 v114, v116, v117
    v_cvt_pk_bf16_f32 v115, v118, v119
    s_nop 1
    v_mfma_f32_16x16x32_bf16 v[60:63], v[56:59], v[88:91], 0
    v_mfma_f32_16x16x32_bf16 v[68:71], v[56:59], v[104:107], 0
    v_mfma_f32_16x16x32_bf16 v[92:95], v[56:59], v[2:5], 0
    v_mfma_f32_16x16x32_bf16 v[76:79], v[72:75], v[88:91], 0
    v_mfma_f32_16x16x32_bf16 v[84:87], v[72:75], v[104:107], 0
    v_mfma_f32_16x16x32_bf16 v[100:103], v[72:75], v[2:5], 0
    v_mfma_f32_16x16x32_bf16 v[60:63], v[64:67], v[96:99], v[60:63]
    v_mfma_f32_16x16x32_bf16 v[68:71], v[64:67], v[112:115], v[68:71]
    v_mfma_f32_16x16x32_bf16 v[92:95], v[64:67], v[2:5], v[92:95]
    v_mfma_f32_16x16x32_bf16 v[76:79], v[80:83], v[96:99], v[76:79]
    v_mfma_f32_16x16x32_bf16 v[84:87], v[80:83], v[112:115], v[84:87]
    v_mfma_f32_16x16x32_bf16 v[100:103], v[80:83], v[2:5], v[100:103]
    v_add_u32 v17, s88, v16
    v_and_b32 v22, 48, v1
    s_lshl_b32 s52, s3, 7
    s_add_u32 s52, s52, 155648
    v_add_u32 v14, s52, v22
    s_nop 4
    ds_write_b128 v17, v[60:63] offset:49152
    ds_write_b128 v17, v[68:71] offset:50176
    ds_write_b128 v17, v[76:79] offset:51200
    ds_write_b128 v17, v[84:87] offset:52224
    ds_write_b128 v14, v[92:95] offset:0
    ds_write_b128 v14, v[100:103] offset:64
    v_and_b32 v14, 15, v1
    v_lshlrev_b32 v14, 7, v14
    buffer_load_dwordx2 v[2:3], v14, s[40:43], s71 offen sc0 sc1
    s_waitcnt lgkmcnt(0)
    s_barrier
    s_lshl_b32 s52, s3, 10
    v_add_u32 v17, s52, v16
    v_bfe_u32 v18, v1, 3, 1
    v_lshl_add_u32 v18, v18, 6, v22
    v_add_u32 v19, 155648, v18
    ds_read_b128 v[56:59], v17 offset:49152
    ds_read_b128 v[60:63], v17 offset:53248
    ds_read_b128 v[64:67], v17 offset:57344
    ds_read_b128 v[68:71], v17 offset:61440
    ds_read_b128 v[72:75], v19 offset:0
    ds_read_b128 v[76:79], v19 offset:128
    ds_read_b128 v[80:83], v19 offset:256
    ds_read_b128 v[84:87], v19 offset:384
    s_lshl_b32 s60, s10, 15
    s_add_u32 s60, s60, s52
    s_add_u32 s60, s60, 4194304
    s_lshl_b32 s87, s10, 10
    s_add_u32 s87, s87, 5242880
    s_lshl_b32 s52, s11, 12
    s_add_u32 s52, s52, s60
    s_lshl_b32 s53, s11, 7
    s_add_u32 s53, s53, s87
    s_waitcnt lgkmcnt(0)
    v_pk_add_f32 v[56:57], v[56:57], v[60:61]
    v_pk_add_f32 v[58:59], v[58:59], v[62:63]
    v_pk_add_f32 v[64:65], v[64:65], v[68:69]
    v_pk_add_f32 v[66:67], v[66:67], v[70:71]
    v_pk_add_f32 v[56:57], v[56:57], v[64:65]
    v_pk_add_f32 v[58:59], v[58:59], v[66:67]
    v_pk_add_f32 v[72:73], v[72:73], v[76:77]
    v_pk_add_f32 v[74:75], v[74:75], v[78:79]
    v_pk_add_f32 v[80:81], v[80:81], v[84:85]
    v_pk_add_f32 v[82:83], v[82:83], v[86:87]
    v_pk_add_f32 v[72:73], v[72:73], v[80:81]
    v_pk_add_f32 v[74:75], v[74:75], v[82:83]
    buffer_store_dwordx4 v[56:59], v16, s[40:43], s52 offen sc1
    s_cmp_eq_u32 s3, 1
    s_cbranch_scc0 L_nz
    buffer_store_dwordx4 v[72:75], v18, s[40:43], s53 offen sc1
L_nz:
    v_lshrrev_b32 v18, 2, v1
    v_and_b32 v19, 3, v1
    v_lshlrev_b32 v19, 3, v19
    v_lshl_add_u32 v20, v18, 8, v19
    v_and_b32 v21, 7, v18
    v_xor_b32 v4, 0, v21
    v_lshl_add_u32 v88, v4, 5, v20
    v_add_u32 v96, 0x10000, v88
    v_add_u32 v104, 0x20000, v88
    v_xor_b32 v4, 1, v21
    v_lshl_add_u32 v89, v4, 5, v20
    v_add_u32 v97, 0x10000, v89
    v_add_u32 v105, 0x20000, v89
    v_xor_b32 v4, 2, v21
    v_lshl_add_u32 v90, v4, 5, v20
    v_add_u32 v98, 0x10000, v90
    v_add_u32 v106, 0x20000, v90
    v_xor_b32 v4, 3, v21
    v_lshl_add_u32 v91, v4, 5, v20
    v_add_u32 v99, 0x10000, v91
    v_add_u32 v107, 0x20000, v91
    v_xor_b32 v4, 4, v21
    v_lshl_add_u32 v92, v4, 5, v20
    v_add_u32 v100, 0x10000, v92
    v_add_u32 v108, 0x20000, v92
    v_xor_b32 v4, 5, v21
    v_lshl_add_u32 v93, v4, 5, v20
    v_add_u32 v101, 0x10000, v93
    v_add_u32 v109, 0x20000, v93
    v_xor_b32 v4, 6, v21
    v_lshl_add_u32 v94, v4, 5, v20
    v_add_u32 v102, 0x10000, v94
    v_add_u32 v110, 0x20000, v94
    v_xor_b32 v4, 7, v21
    v_lshl_add_u32 v95, v4, 5, v20
    v_add_u32 v103, 0x10000, v95
    v_add_u32 v111, 0x20000, v95
    v_and_b32 v17, 15, v1
    s_lshr_b32 s52, s2, 3
    s_lshl_b32 s52, s52, 4
    v_add_u32 v17, s52, v17
    v_lshlrev_b32 v17, 11, v17
    s_lshr_b32 s52, s21, 2
    s_lshl_b32 s52, s52, 10
    s_add_u32 s52, s52, 384
    v_add_u32 v17, s52, v17
    s_mul_i32 s70, s98, 3670016
    s_add_u32 s52, s3, s51
    s_cmp_eq_u32 s52, 0
    s_cbranch_scc0 L_p1s
    s_waitcnt vmcnt(1)
    s_mov_b32 s99, 0
L_p1:
    v_xor_b32 v2, s92, v2
    v_xor_b32 v3, s93, v3
    v_or_b32 v2, v2, v3
    v_cmp_ne_u32 vcc, 0, v2
    s_cbranch_vccz L_p1_ok
    buffer_load_dwordx2 v[2:3], v14, s[40:43], s71 offen sc0 sc1
    s_add_u32 s99, s99, 1
    s_cmp_lt_u32 s99, 0x200000
    s_waitcnt vmcnt(0)
    s_cbranch_scc1 L_p1
L_p1_ok:
L_p1s:
    s_barrier
    ds_read_b64_tr_b16 a[112:113], v96 offset:16384
    ds_read_b64_tr_b16 a[114:115], v96 offset:20480
    ds_read_b64_tr_b16 a[116:117], v96 offset:24576
    ds_read_b64_tr_b16 a[118:119], v96 offset:28672
    ds_read_b64_tr_b16 a[120:121], v97 offset:16384
    ds_read_b64_tr_b16 a[122:123], v97 offset:20480
    ds_read_b64_tr_b16 a[124:125], v97 offset:24576
    ds_read_b64_tr_b16 a[126:127], v97 offset:28672
    ds_read_b64_tr_b16 a[128:129], v98 offset:16384
    ds_read_b64_tr_b16 a[130:131], v98 offset:20480
    ds_read_b64_tr_b16 a[132:133], v98 offset:24576
    ds_read_b64_tr_b16 a[134:135], v98 offset:28672
    ds_read_b64_tr_b16 a[136:137], v99 offset:16384
    ds_read_b64_tr_b16 a[138:139], v99 offset:20480
    ds_read_b64_tr_b16 a[140:141], v99 offset:24576
    ds_read_b64_tr_b16 a[142:143], v99 offset:28672
    s_cmp_eq_u32 s51, 0
    s_cbranch_scc0 L_hl
    buffer_load_dwordx4 a[0:3], v16, s[32:35], s64 offen offset:0 sc1
    buffer_load_dwordx4 a[4:7], v16, s[32:35], s64 offen offset:1024 sc1
    buffer_load_dwordx4 a[8:11], v16, s[32:35], s64 offen offset:2048 sc1
    buffer_load_dwordx4 a[12:15], v16, s[32:35], s64 offen offset:3072 sc1
    s_add_u32 s64, s64, 4096
    buffer_load_dwordx4 a[16:19], v16, s[32:35], s64 offen offset:0 sc1
    buffer_load_dwordx4 a[20:23], v16, s[32:35], s64 offen offset:1024 sc1
    buffer_load_dwordx4 a[24:27], v16, s[32:35], s64 offen offset:2048 sc1
    buffer_load_dwordx4 a[28:31], v16, s[32:35], s64 offen offset:3072 sc1
    s_add_u32 s64, s64, 4096
    buffer_load_dwordx4 a[32:35], v16, s[32:35], s64 offen offset:0 sc1
    buffer_load_dwordx4 a[36:39], v16, s[32:35], s64 offen offset:1024 sc1
L_hl:
    s_waitcnt vmcnt(6)
    s_waitcnt lgkmcnt(8)
    v_mfma_f32_16x16x32_bf16 v[128:131], a[112:115], a[0:3], 0
    ds_read_b64_tr_b16 a[144:145], v100 offset:16384
    buffer_load_dwordx4 a[40:43], v16, s[32:35], s64 offen offset:2048 sc1
    v_mfma_f32_16x16x32_bf16 v[128:131], a[116:119], a[8:11], v[128:131]
    ds_read_b64_tr_b16 a[146:147], v100 offset:20480
    buffer_load_dwordx4 a[44:47], v16, s[32:35], s64 offen offset:3072 sc1
    s_cmp_eq_u32 s3, 1
    s_cbranch_scc0 L_l24
    s_add_u32 s76, s70, 1048576
    buffer_load_dword v23, v17, s[56:59], s76 offen
L_l24:
    v_mfma_f32_16x16x32_bf16 v[132:135], a[116:119], a[12:15], 0
    ds_read_b64_tr_b16 a[148:149], v100 offset:24576
    s_add_u32 s64, s64, 4096
    v_mfma_f32_16x16x32_bf16 v[132:135], a[112:115], a[4:7], v[132:135]
    ds_read_b64_tr_b16 a[150:151], v100 offset:28672
    v_mfma_f32_16x16x32_bf16 v[140:143], a[120:123], a[4:7], 0
    ds_read_b64_tr_b16 a[152:153], v101 offset:16384
    buffer_load_dwordx4 a[48:51], v16, s[32:35], s64 offen offset:0 sc1
    v_mfma_f32_16x16x32_bf16 v[140:143], a[124:127], a[12:15], v[140:143]
    ds_read_b64_tr_b16 a[154:155], v101 offset:20480
    buffer_load_dwordx4 a[52:55], v16, s[32:35], s64 offen offset:1024 sc1
    v_mfma_f32_16x16x32_bf16 v[136:139], a[124:127], a[8:11], 0
    ds_read_b64_tr_b16 a[156:157], v101 offset:24576
    s_lshl_b32 s65, s10, 11
    v_mfma_f32_16x16x32_bf16 v[136:139], a[120:123], a[0:3], v[136:139]
    ds_read_b64_tr_b16 a[158:159], v101 offset:28672
    s_add_u32 s65, s65, s63
    s_waitcnt lgkmcnt(8)
    v_mfma_f32_16x16x32_bf16 v[144:147], a[128:131], a[0:3], 0
    ds_read_b64_tr_b16 a[160:161], v102 offset:16384
    s_add_u32 s65, s65, 229376
    v_mfma_f32_16x16x32_bf16 v[144:147], a[132:135], a[8:11], v[144:147]
    ds_read_b64_tr_b16 a[162:163], v102 offset:20480
    s_add_u32 s66, s65, 294912
    v_mfma_f32_16x16x32_bf16 v[148:151], a[132:135], a[12:15], 0
    ds_read_b64_tr_b16 a[164:165], v102 offset:24576
    v_mul_f32 v80, s44, v24
    v_mfma_f32_16x16x32_bf16 v[148:151], a[128:131], a[4:7], v[148:151]
    ds_read_b64_tr_b16 a[166:167], v102 offset:28672
    v_mul_f32 v81, s44, v25
    v_mfma_f32_16x16x32_bf16 v[156:159], a[136:139], a[4:7], 0
    ds_read_b64_tr_b16 a[168:169], v103 offset:16384
    v_mul_f32 v82, s44, v26
    v_mfma_f32_16x16x32_bf16 v[156:159], a[140:143], a[12:15], v[156:159]
    ds_read_b64_tr_b16 a[170:171], v103 offset:20480
    v_mul_f32 v83, s44, v27
    v_mfma_f32_16x16x32_bf16 v[152:155], a[140:143], a[8:11], 0
    ds_read_b64_tr_b16 a[172:173], v103 offset:24576
    v_exp_f32_e64 v80, v80 clamp
    v_mfma_f32_16x16x32_bf16 v[152:155], a[136:139], a[0:3], v[152:155]
    ds_read_b64_tr_b16 a[174:175], v103 offset:28672
    v_exp_f32_e64 v81, v81 clamp
    s_waitcnt vmcnt(6) lgkmcnt(8)
    s_barrier
    v_mfma_f32_16x16x32_bf16 v[160:163], a[144:147], a[0:3], 0
    ds_read_b64_tr_b16 a[112:113], v96 offset:32768
    buffer_load_dwordx4 a[56:59], v16, s[32:35], s64 offen offset:2048 sc1
    v_mfma_f32_16x16x32_bf16 v[160:163], a[148:151], a[8:11], v[160:163]
    ds_read_b64_tr_b16 a[114:115], v96 offset:36864
    v_exp_f32_e64 v82, v82 clamp
    v_mfma_f32_16x16x32_bf16 v[164:167], a[148:151], a[12:15], 0
    ds_read_b64_tr_b16 a[116:117], v96 offset:40960
    v_exp_f32_e64 v83, v83 clamp
    v_mfma_f32_16x16x32_bf16 v[164:167], a[144:147], a[4:7], v[164:167]
    ds_read_b64_tr_b16 a[118:119], v96 offset:45056
    v_max_f32 v24, 0, v24
    v_mfma_f32_16x16x32_bf16 v[172:175], a[152:155], a[4:7], 0
    ds_read_b64_tr_b16 a[120:121], v97 offset:32768
    s_add_u32 m0, s88, 49152
    v_max_f32 v25, 0, v25
    v_mfma_f32_16x16x32_bf16 v[172:175], a[156:159], a[12:15], v[172:175]
    ds_read_b64_tr_b16 a[122:123], v97 offset:36864
    buffer_load_dwordx4 v10, s[56:59], s75 offen offset:0  lds
    v_mfma_f32_16x16x32_bf16 v[168:171], a[156:159], a[8:11], 0
    ds_read_b64_tr_b16 a[124:125], v97 offset:40960
    v_max_f32 v26, 0, v26
    v_mfma_f32_16x16x32_bf16 v[168:171], a[152:155], a[0:3], v[168:171]
    ds_read_b64_tr_b16 a[126:127], v97 offset:45056
    v_max_f32 v27, 0, v27
    s_waitcnt lgkmcnt(8)
    v_mfma_f32_16x16x32_bf16 v[176:179], a[160:163], a[0:3], 0
    ds_read_b64_tr_b16 a[128:129], v98 offset:32768
    buffer_load_dwordx4 a[60:63], v16, s[32:35], s64 offen offset:3072 sc1
    v_accvgpr_read_b32 v124, a26
    v_mfma_f32_16x16x32_bf16 v[176:179], a[164:167], a[8:11], v[176:179]
    ds_read_b64_tr_b16 a[130:131], v98 offset:36864
    v_accvgpr_read_b32 v125, a27
    v_add_f32 v24, v24, v80
    v_mfma_f32_16x16x32_bf16 v[180:183], a[164:167], a[12:15], 0
    ds_read_b64_tr_b16 a[132:133], v98 offset:40960
    s_add_u32 s64, s64, 4096
    v_accvgpr_mov_b32 a26, a28
    v_mfma_f32_16x16x32_bf16 v[180:183], a[160:163], a[4:7], v[180:183]
    ds_read_b64_tr_b16 a[134:135], v98 offset:45056
    v_accvgpr_mov_b32 a27, a29
    v_add_f32 v25, v25, v81
    v_mfma_f32_16x16x32_bf16 v[188:191], a[168:171], a[4:7], 0
    ds_read_b64_tr_b16 a[136:137], v99 offset:32768
    v_accvgpr_write_b32 a28, v124
    v_add_f32 v26, v26, v82
    v_mfma_f32_16x16x32_bf16 v[188:191], a[172:175], a[12:15], v[188:191]
    ds_read_b64_tr_b16 a[138:139], v99 offset:36864
    buffer_load_dwordx4 v11, s[56:59], s75 offen offset:1024  lds
    v_accvgpr_write_b32 a29, v125
    v_mfma_f32_16x16x32_bf16 v[184:187], a[172:175], a[8:11], 0
    ds_read_b64_tr_b16 a[140:141], v99 offset:40960
    v_add_f32 v27, v27, v83
    v_mfma_f32_16x16x32_bf16 v[184:187], a[168:171], a[0:3], v[184:187]
    ds_read_b64_tr_b16 a[142:143], v99 offset:45056
    v_add_f32 v24, s48, v24
    s_waitcnt lgkmcnt(8)
    v_mfma_f32_16x16x32_bf16 v[128:131], a[112:115], a[16:19], v[128:131]
    ds_read_b64_tr_b16 a[144:145], v100 offset:32768
    buffer_load_dwordx4 a[64:67], v16, s[32:35], s64 offen offset:0 sc1
    v_mfma_f32_16x16x32_bf16 v[128:131], a[116:119], a[24:27], v[128:131]
    ds_read_b64_tr_b16 a[146:147], v100 offset:36864
    v_add_f32 v25, s48, v25
    v_mfma_f32_16x16x32_bf16 v[132:135], a[116:119], a[28:31], v[132:135]
    ds_read_b64_tr_b16 a[148:149], v100 offset:40960
    v_add_f32 v26, s48, v26
    v_mfma_f32_16x16x32_bf16 v[132:135], a[112:115], a[20:23], v[132:135]
    ds_read_b64_tr_b16 a[150:151], v100 offset:45056
    v_add_f32 v27, s48, v27
    v_mfma_f32_16x16x32_bf16 v[140:143], a[120:123], a[20:23], v[140:143]
    ds_read_b64_tr_b16 a[152:153], v101 offset:32768
    v_mul_f32 v80, s44, v40
    v_mfma_f32_16x16x32_bf16 v[140:143], a[124:127], a[28:31], v[140:143]
    ds_read_b64_tr_b16 a[154:155], v101 offset:36864
    buffer_load_dwordx4 v12, s[56:59], s75 offen offset:2048  lds
    v_mfma_f32_16x16x32_bf16 v[136:139], a[124:127], a[24:27], v[136:139]
    ds_read_b64_tr_b16 a[156:157], v101 offset:40960
    v_mul_f32 v81, s44, v41
    v_mfma_f32_16x16x32_bf16 v[136:139], a[120:123], a[16:19], v[136:139]
    ds_read_b64_tr_b16 a[158:159], v101 offset:45056
    v_mul_f32 v82, s44, v42
    s_waitcnt vmcnt(10)
    s_waitcnt lgkmcnt(8)
    v_mfma_f32_16x16x32_bf16 v[144:147], a[128:131], a[16:19], v[144:147]
    ds_read_b64_tr_b16 a[160:161], v102 offset:32768
    buffer_load_dwordx4 a[68:71], v16, s[32:35], s64 offen offset:1024 sc1
    v_mfma_f32_16x16x32_bf16 v[144:147], a[132:135], a[24:27], v[144:147]
    ds_read_b64_tr_b16 a[162:163], v102 offset:36864
    v_mul_f32 v83, s44, v43
    v_mfma_f32_16x16x32_bf16 v[148:151], a[132:135], a[28:31], v[148:151]
    ds_read_b64_tr_b16 a[164:165], v102 offset:40960
    v_exp_f32_e64 v80, v80 clamp
    v_mfma_f32_16x16x32_bf16 v[148:151], a[128:131], a[20:23], v[148:151]
    ds_read_b64_tr_b16 a[166:167], v102 offset:45056
    v_exp_f32_e64 v81, v81 clamp
    v_mfma_f32_16x16x32_bf16 v[156:159], a[136:139], a[20:23], v[156:159]
    ds_read_b64_tr_b16 a[168:169], v103 offset:32768
    v_exp_f32_e64 v82, v82 clamp
    v_mfma_f32_16x16x32_bf16 v[156:159], a[140:143], a[28:31], v[156:159]
    ds_read_b64_tr_b16 a[170:171], v103 offset:36864
    buffer_load_dwordx4 v13, s[56:59], s75 offen offset:3072  lds
    v_mfma_f32_16x16x32_bf16 v[152:155], a[140:143], a[24:27], v[152:155]
    ds_read_b64_tr_b16 a[172:173], v103 offset:40960
    s_add_u32 s75, s75, 131072
    v_exp_f32_e64 v83, v83 clamp
    v_mfma_f32_16x16x32_bf16 v[152:155], a[136:139], a[16:19], v[152:155]
    ds_read_b64_tr_b16 a[174:175], v103 offset:45056
    v_max_f32 v40, 0, v40
    s_waitcnt vmcnt(10) lgkmcnt(8)
    s_barrier
    v_mfma_f32_16x16x32_bf16 v[160:163], a[144:147], a[16:19], v[160:163]
    ds_read_b64_tr_b16 a[112:113], v96 offset:49152
    buffer_load_dwordx4 a[72:75], v16, s[32:35], s64 offen offset:2048 sc1
    v_mfma_f32_16x16x32_bf16 v[160:163], a[148:151], a[24:27], v[160:163]
    ds_read_b64_tr_b16 a[114:115], v96 offset:53248
    v_max_f32 v41, 0, v41
    v_mfma_f32_16x16x32_bf16 v[164:167], a[148:151], a[28:31], v[164:167]
    ds_read_b64_tr_b16 a[116:117], v96 offset:57344
    v_max_f32 v42, 0, v42
    v_mfma_f32_16x16x32_bf16 v[164:167], a[144:147], a[20:23], v[164:167]
    ds_read_b64_tr_b16 a[118:119], v96 offset:61440
    v_max_f32 v43, 0, v43
    v_mfma_f32_16x16x32_bf16 v[172:175], a[152:155], a[20:23], v[172:175]
    ds_read_b64_tr_b16 a[120:121], v97 offset:49152
    s_add_u32 m0, s88, 81920
    v_add_f32 v40, v40, v80
    v_mfma_f32_16x16x32_bf16 v[172:175], a[156:159], a[28:31], v[172:175]
    ds_read_b64_tr_b16 a[122:123], v97 offset:53248
    buffer_load_dwordx4 v10, s[56:59], s75 offen offset:0  lds
    v_mfma_f32_16x16x32_bf16 v[168:171], a[156:159], a[24:27], v[168:171]
    ds_read_b64_tr_b16 a[124:125], v97 offset:57344
    v_add_f32 v41, v41, v81
    v_mfma_f32_16x16x32_bf16 v[168:171], a[152:155], a[16:19], v[168:171]
    ds_read_b64_tr_b16 a[126:127], v97 offset:61440
    v_add_f32 v42, v42, v82
    s_cmp_eq_u32 s3, 0
    s_cbranch_scc0 L_sig2
    v_mov_b32 v76, s92
    v_mov_b32 v77, s93
    v_mov_b32 v78, s92
    v_mov_b32 v79, s93
    s_mov_b64 exec, 0xff
    buffer_store_dwordx4 v[76:79], v16, s[40:43], s85 offen sc0 sc1
    s_mov_b64 exec, -1
    s_nop 0
L_sig2:
    s_waitcnt lgkmcnt(8)
    v_mfma_f32_16x16x32_bf16 v[176:179], a[160:163], a[16:19], v[176:179]
    ds_read_b64_tr_b16 a[128:129], v98 offset:49152
    buffer_load_dwordx4 a[76:79], v16, s[32:35], s64 offen offset:3072 sc1
    v_mfma_f32_16x16x32_bf16 v[176:179], a[164:167], a[24:27], v[176:179]
    ds_read_b64_tr_b16 a[130:131], v98 offset:53248
    v_add_f32 v43, v43, v83
    v_mfma_f32_16x16x32_bf16 v[180:183], a[164:167], a[28:31], v[180:183]
    ds_read_b64_tr_b16 a[132:133], v98 offset:57344
    s_add_u32 s64, s64, 4096
    v_add_f32 v40, s48, v40
    v_mfma_f32_16x16x32_bf16 v[180:183], a[160:163], a[20:23], v[180:183]
    ds_read_b64_tr_b16 a[134:135], v98 offset:61440
    v_add_f32 v41, s48, v41
    v_mfma_f32_16x16x32_bf16 v[188:191], a[168:171], a[20:23], v[188:191]
    ds_read_b64_tr_b16 a[136:137], v99 offset:49152
    v_add_f32 v42, s48, v42
    v_mfma_f32_16x16x32_bf16 v[188:191], a[172:175], a[28:31], v[188:191]
    ds_read_b64_tr_b16 a[138:139], v99 offset:53248
    buffer_load_dwordx4 v11, s[56:59], s75 offen offset:1024  lds
    v_mfma_f32_16x16x32_bf16 v[184:187], a[172:175], a[24:27], v[184:187]
    ds_read_b64_tr_b16 a[140:141], v99 offset:57344
    v_add_f32 v43, s48, v43
    v_mfma_f32_16x16x32_bf16 v[184:187], a[168:171], a[16:19], v[184:187]
    ds_read_b64_tr_b16 a[142:143], v99 offset:61440
    v_cvt_pk_bf16_f32 v24, v24, v25
    s_waitcnt lgkmcnt(8)
    v_mfma_f32_16x16x32_bf16 v[128:131], a[112:115], a[32:35], v[128:131]
    ds_read_b64_tr_b16 a[144:145], v100 offset:49152
    buffer_load_dwordx4 a[80:83], v16, s[32:35], s64 offen offset:0 sc1
    v_mfma_f32_16x16x32_bf16 v[128:131], a[116:119], a[40:43], v[128:131]
    ds_read_b64_tr_b16 a[146:147], v100 offset:53248
    v_cvt_pk_bf16_f32 v25, v26, v27
    v_mfma_f32_16x16x32_bf16 v[132:135], a[116:119], a[44:47], v[132:135]
    ds_read_b64_tr_b16 a[148:149], v100 offset:57344
    v_cvt_pk_bf16_f32 v26, v40, v41
    v_mfma_f32_16x16x32_bf16 v[132:135], a[112:115], a[36:39], v[132:135]
    ds_read_b64_tr_b16 a[150:151], v100 offset:61440
    v_cvt_pk_bf16_f32 v27, v42, v43
    v_mfma_f32_16x16x32_bf16 v[140:143], a[120:123], a[36:39], v[140:143]
    ds_read_b64_tr_b16 a[152:153], v101 offset:49152
    v_mul_f32 v80, s44, v28
    v_mfma_f32_16x16x32_bf16 v[140:143], a[124:127], a[44:47], v[140:143]
    ds_read_b64_tr_b16 a[154:155], v101 offset:53248
    buffer_load_dwordx4 v12, s[56:59], s75 offen offset:2048  lds
    v_mfma_f32_16x16x32_bf16 v[136:139], a[124:127], a[40:43], v[136:139]
    ds_read_b64_tr_b16 a[156:157], v101 offset:57344
    v_mul_f32 v81, s44, v29
    v_mfma_f32_16x16x32_bf16 v[136:139], a[120:123], a[32:35], v[136:139]
    ds_read_b64_tr_b16 a[158:159], v101 offset:61440
    v_mul_f32 v82, s44, v30
    s_waitcnt lgkmcnt(8)
    v_mfma_f32_16x16x32_bf16 v[144:147], a[128:131], a[32:35], v[144:147]
    ds_read_b64_tr_b16 a[160:161], v102 offset:49152
    buffer_load_dwordx4 a[84:87], v16, s[32:35], s64 offen offset:1024 sc1
    v_mfma_f32_16x16x32_bf16 v[144:147], a[132:135], a[40:43], v[144:147]
    ds_read_b64_tr_b16 a[162:163], v102 offset:53248
    v_mul_f32 v83, s44, v31
    v_mfma_f32_16x16x32_bf16 v[148:151], a[132:135], a[44:47], v[148:151]
    ds_read_b64_tr_b16 a[164:165], v102 offset:57344
    v_exp_f32_e64 v80, v80 clamp
    v_mfma_f32_16x16x32_bf16 v[148:151], a[128:131], a[36:39], v[148:151]
    ds_read_b64_tr_b16 a[166:167], v102 offset:61440
    v_exp_f32_e64 v81, v81 clamp
    v_mfma_f32_16x16x32_bf16 v[156:159], a[136:139], a[36:39], v[156:159]
    ds_read_b64_tr_b16 a[168:169], v103 offset:49152
    v_exp_f32_e64 v82, v82 clamp
    v_mfma_f32_16x16x32_bf16 v[156:159], a[140:143], a[44:47], v[156:159]
    ds_read_b64_tr_b16 a[170:171], v103 offset:53248
    buffer_load_dwordx4 v13, s[56:59], s75 offen offset:3072  lds
    v_mfma_f32_16x16x32_bf16 v[152:155], a[140:143], a[40:43], v[152:155]
    ds_read_b64_tr_b16 a[172:173], v103 offset:57344
    s_add_u32 s75, s75, 131072
    v_exp_f32_e64 v83, v83 clamp
    v_mfma_f32_16x16x32_bf16 v[152:155], a[136:139], a[32:35], v[152:155]
    ds_read_b64_tr_b16 a[174:175], v103 offset:61440
    v_max_f32 v28, 0, v28
    s_waitcnt vmcnt(13) lgkmcnt(8)
    s_barrier
    v_mfma_f32_16x16x32_bf16 v[160:163], a[144:147], a[32:35], v[160:163]
    ds_read_b64_tr_b16 a[112:113], v104 offset:0
    buffer_load_dwordx4 a[88:91], v16, s[32:35], s64 offen offset:2048 sc1
    v_mfma_f32_16x16x32_bf16 v[160:163], a[148:151], a[40:43], v[160:163]
    ds_read_b64_tr_b16 a[114:115], v104 offset:4096
    v_max_f32 v29, 0, v29
    v_mfma_f32_16x16x32_bf16 v[164:167], a[148:151], a[44:47], v[164:167]
    ds_read_b64_tr_b16 a[116:117], v104 offset:8192
    v_max_f32 v30, 0, v30
    v_mfma_f32_16x16x32_bf16 v[164:167], a[144:147], a[36:39], v[164:167]
    ds_read_b64_tr_b16 a[118:119], v104 offset:12288
    v_max_f32 v31, 0, v31
    v_mfma_f32_16x16x32_bf16 v[172:175], a[152:155], a[36:39], v[172:175]
    ds_read_b64_tr_b16 a[120:121], v105 offset:0
    s_add_u32 m0, s88, 98304
    v_add_f32 v28, v28, v80
    v_mfma_f32_16x16x32_bf16 v[172:175], a[156:159], a[44:47], v[172:175]
    ds_read_b64_tr_b16 a[122:123], v105 offset:4096
    buffer_load_dwordx4 v10, s[56:59], s75 offen offset:0  lds
    v_mfma_f32_16x16x32_bf16 v[168:171], a[156:159], a[40:43], v[168:171]
    ds_read_b64_tr_b16 a[124:125], v105 offset:8192
    v_add_f32 v29, v29, v81
    v_mfma_f32_16x16x32_bf16 v[168:171], a[152:155], a[32:35], v[168:171]
    ds_read_b64_tr_b16 a[126:127], v105 offset:12288
    v_add_f32 v30, v30, v82
    s_waitcnt lgkmcnt(8)
    v_mfma_f32_16x16x32_bf16 v[176:179], a[160:163], a[32:35], v[176:179]
    ds_read_b64_tr_b16 a[128:129], v106 offset:0
    buffer_load_dwordx4 a[92:95], v16, s[32:35], s64 offen offset:3072 sc1
    v_mfma_f32_16x16x32_bf16 v[176:179], a[164:167], a[40:43], v[176:179]
    ds_read_b64_tr_b16 a[130:131], v106 offset:4096
    v_add_f32 v31, v31, v83
    v_mfma_f32_16x16x32_bf16 v[180:183], a[164:167], a[44:47], v[180:183]
    ds_read_b64_tr_b16 a[132:133], v106 offset:8192
    s_add_u32 s64, s64, 4096
    v_add_f32 v28, s48, v28
    v_mfma_f32_16x16x32_bf16 v[180:183], a[160:163], a[36:39], v[180:183]
    ds_read_b64_tr_b16 a[134:135], v106 offset:12288
    v_add_f32 v29, s48, v29
    v_mfma_f32_16x16x32_bf16 v[188:191], a[168:171], a[36:39], v[188:191]
    ds_read_b64_tr_b16 a[136:137], v107 offset:0
    v_add_f32 v30, s48, v30
    v_mfma_f32_16x16x32_bf16 v[188:191], a[172:175], a[44:47], v[188:191]
    ds_read_b64_tr_b16 a[138:139], v107 offset:4096
    buffer_load_dwordx4 v11, s[56:59], s75 offen offset:1024  lds
    v_mfma_f32_16x16x32_bf16 v[184:187], a[172:175], a[40:43], v[184:187]
    ds_read_b64_tr_b16 a[140:141], v107 offset:8192
    v_add_f32 v31, s48, v31
    v_mfma_f32_16x16x32_bf16 v[184:187], a[168:171], a[32:35], v[184:187]
    ds_read_b64_tr_b16 a[142:143], v107 offset:12288
    v_mul_f32 v80, s44, v44
    s_waitcnt lgkmcnt(8)
    v_mfma_f32_16x16x32_bf16 v[128:131], a[112:115], a[48:51], v[128:131]
    ds_read_b64_tr_b16 a[144:145], v108 offset:0
    buffer_load_dwordx4 a[96:99], v16, s[32:35], s64 offen offset:0 sc1
    v_mfma_f32_16x16x32_bf16 v[128:131], a[116:119], a[56:59], v[128:131]
    ds_read_b64_tr_b16 a[146:147], v108 offset:4096
    v_mul_f32 v81, s44, v45
    v_mfma_f32_16x16x32_bf16 v[132:135], a[116:119], a[60:63], v[132:135]
    ds_read_b64_tr_b16 a[148:149], v108 offset:8192
    v_mul_f32 v82, s44, v46
    v_mfma_f32_16x16x32_bf16 v[132:135], a[112:115], a[52:55], v[132:135]
    ds_read_b64_tr_b16 a[150:151], v108 offset:12288
    v_mul_f32 v83, s44, v47
    v_mfma_f32_16x16x32_bf16 v[140:143], a[120:123], a[52:55], v[140:143]
    ds_read_b64_tr_b16 a[152:153], v109 offset:0
    v_exp_f32_e64 v80, v80 clamp
    v_mfma_f32_16x16x32_bf16 v[140:143], a[124:127], a[60:63], v[140:143]
    ds_read_b64_tr_b16 a[154:155], v109 offset:4096
    buffer_load_dwordx4 v12, s[56:59], s75 offen offset:2048  lds
    v_mfma_f32_16x16x32_bf16 v[136:139], a[124:127], a[56:59], v[136:139]
    ds_read_b64_tr_b16 a[156:157], v109 offset:8192
    v_exp_f32_e64 v81, v81 clamp
    v_mfma_f32_16x16x32_bf16 v[136:139], a[120:123], a[48:51], v[136:139]
    ds_read_b64_tr_b16 a[158:159], v109 offset:12288
    v_exp_f32_e64 v82, v82 clamp
    s_waitcnt lgkmcnt(8)
    v_mfma_f32_16x16x32_bf16 v[144:147], a[128:131], a[48:51], v[144:147]
    ds_read_b64_tr_b16 a[160:161], v110 offset:0
    buffer_load_dwordx4 a[100:103], v16, s[32:35], s64 offen offset:1024 sc1
    v_mfma_f32_16x16x32_bf16 v[144:147], a[132:135], a[56:59], v[144:147]
    ds_read_b64_tr_b16 a[162:163], v110 offset:4096
    v_exp_f32_e64 v83, v83 clamp
    v_mfma_f32_16x16x32_bf16 v[148:151], a[132:135], a[60:63], v[148:151]
    ds_read_b64_tr_b16 a[164:165], v110 offset:8192
    v_max_f32 v44, 0, v44
    v_mfma_f32_16x16x32_bf16 v[148:151], a[128:131], a[52:55], v[148:151]
    ds_read_b64_tr_b16 a[166:167], v110 offset:12288
    v_max_f32 v45, 0, v45
    v_mfma_f32_16x16x32_bf16 v[156:159], a[136:139], a[52:55], v[156:159]
    ds_read_b64_tr_b16 a[168:169], v111 offset:0
    v_max_f32 v46, 0, v46
    v_mfma_f32_16x16x32_bf16 v[156:159], a[140:143], a[60:63], v[156:159]
    ds_read_b64_tr_b16 a[170:171], v111 offset:4096
    buffer_load_dwordx4 v13, s[56:59], s75 offen offset:3072  lds
    v_mfma_f32_16x16x32_bf16 v[152:155], a[140:143], a[56:59], v[152:155]
    ds_read_b64_tr_b16 a[172:173], v111 offset:8192
    s_add_u32 s75, s75, 131072
    v_max_f32 v47, 0, v47
    v_mfma_f32_16x16x32_bf16 v[152:155], a[136:139], a[48:51], v[152:155]
    ds_read_b64_tr_b16 a[174:175], v111 offset:12288
    v_add_f32 v44, v44, v80
    s_waitcnt vmcnt(13) lgkmcnt(8)
    s_barrier
    v_mfma_f32_16x16x32_bf16 v[160:163], a[144:147], a[48:51], v[160:163]
    ds_read_b64_tr_b16 a[112:113], v88 offset:0
    buffer_load_dwordx4 a[104:107], v16, s[32:35], s64 offen offset:2048 sc1
    v_mfma_f32_16x16x32_bf16 v[160:163], a[148:151], a[56:59], v[160:163]
    ds_read_b64_tr_b16 a[114:115], v88 offset:4096
    v_add_f32 v45, v45, v81
    v_mfma_f32_16x16x32_bf16 v[164:167], a[148:151], a[60:63], v[164:167]
    ds_read_b64_tr_b16 a[116:117], v88 offset:8192
    v_add_f32 v46, v46, v82
    v_mfma_f32_16x16x32_bf16 v[164:167], a[144:147], a[52:55], v[164:167]
    ds_read_b64_tr_b16 a[118:119], v88 offset:12288
    v_add_f32 v47, v47, v83
    v_mfma_f32_16x16x32_bf16 v[172:175], a[152:155], a[52:55], v[172:175]
    ds_read_b64_tr_b16 a[120:121], v89 offset:0
    s_add_u32 m0, s88, 114688
    v_add_f32 v44, s48, v44
    v_mfma_f32_16x16x32_bf16 v[172:175], a[156:159], a[60:63], v[172:175]
    ds_read_b64_tr_b16 a[122:123], v89 offset:4096
    buffer_load_dwordx4 v10, s[56:59], s75 offen offset:0  lds
    v_mfma_f32_16x16x32_bf16 v[168:171], a[156:159], a[56:59], v[168:171]
    ds_read_b64_tr_b16 a[124:125], v89 offset:8192
    v_add_f32 v45, s48, v45
    v_mfma_f32_16x16x32_bf16 v[168:171], a[152:155], a[48:51], v[168:171]
    ds_read_b64_tr_b16 a[126:127], v89 offset:12288
    v_add_f32 v46, s48, v46
    s_waitcnt lgkmcnt(8)
    v_mfma_f32_16x16x32_bf16 v[176:179], a[160:163], a[48:51], v[176:179]
    ds_read_b64_tr_b16 a[128:129], v90 offset:0
    buffer_load_dwordx4 a[108:111], v16, s[32:35], s64 offen offset:3072 sc1
    v_mfma_f32_16x16x32_bf16 v[176:179], a[164:167], a[56:59], v[176:179]
    ds_read_b64_tr_b16 a[130:131], v90 offset:4096
    v_add_f32 v47, s48, v47
    v_mfma_f32_16x16x32_bf16 v[180:183], a[164:167], a[60:63], v[180:183]
    ds_read_b64_tr_b16 a[132:133], v90 offset:8192
    s_add_u32 s64, s64, 4096
    v_cvt_pk_bf16_f32 v28, v28, v29
    v_mfma_f32_16x16x32_bf16 v[180:183], a[160:163], a[52:55], v[180:183]
    ds_read_b64_tr_b16 a[134:135], v90 offset:12288
    v_cvt_pk_bf16_f32 v29, v30, v31
    v_mfma_f32_16x16x32_bf16 v[188:191], a[168:171], a[52:55], v[188:191]
    ds_read_b64_tr_b16 a[136:137], v91 offset:0
    v_cvt_pk_bf16_f32 v30, v44, v45
    v_mfma_f32_16x16x32_bf16 v[188:191], a[172:175], a[60:63], v[188:191]
    ds_read_b64_tr_b16 a[138:139], v91 offset:4096
    buffer_load_dwordx4 v11, s[56:59], s75 offen offset:1024  lds
    v_mfma_f32_16x16x32_bf16 v[184:187], a[172:175], a[56:59], v[184:187]
    ds_read_b64_tr_b16 a[140:141], v91 offset:8192
    v_cvt_pk_bf16_f32 v31, v46, v47
    v_mfma_f32_16x16x32_bf16 v[184:187], a[168:171], a[48:51], v[184:187]
    ds_read_b64_tr_b16 a[142:143], v91 offset:12288
    v_mul_f32 v80, s44, v32
    s_waitcnt lgkmcnt(8)
    v_mfma_f32_16x16x32_bf16 v[128:131], a[112:115], a[64:67], v[128:131]
    ds_read_b64_tr_b16 a[144:145], v92 offset:0
    buffer_load_dwordx4 a[0:3], v16, s[32:35], s64 offen offset:0 sc1
    v_mfma_f32_16x16x32_bf16 v[128:131], a[116:119], a[72:75], v[128:131]
    ds_read_b64_tr_b16 a[146:147], v92 offset:4096
    v_mul_f32 v81, s44, v33
    v_mfma_f32_16x16x32_bf16 v[132:135], a[116:119], a[76:79], v[132:135]
    ds_read_b64_tr_b16 a[148:149], v92 offset:8192
    v_mul_f32 v82, s44, v34
    v_mfma_f32_16x16x32_bf16 v[132:135], a[112:115], a[68:71], v[132:135]
    ds_read_b64_tr_b16 a[150:151], v92 offset:12288
    v_mul_f32 v83, s44, v35
    v_mfma_f32_16x16x32_bf16 v[140:143], a[120:123], a[68:71], v[140:143]
    ds_read_b64_tr_b16 a[152:153], v93 offset:0
    v_exp_f32_e64 v80, v80 clamp
    v_mfma_f32_16x16x32_bf16 v[140:143], a[124:127], a[76:79], v[140:143]
    ds_read_b64_tr_b16 a[154:155], v93 offset:4096
    buffer_load_dwordx4 v12, s[56:59], s75 offen offset:2048  lds
    v_mfma_f32_16x16x32_bf16 v[136:139], a[124:127], a[72:75], v[136:139]
    ds_read_b64_tr_b16 a[156:157], v93 offset:8192
    v_exp_f32_e64 v81, v81 clamp
    v_mfma_f32_16x16x32_bf16 v[136:139], a[120:123], a[64:67], v[136:139]
    ds_read_b64_tr_b16 a[158:159], v93 offset:12288
    v_exp_f32_e64 v82, v82 clamp
    v_and_b32 v14, 7, v1
    v_lshlrev_b32 v14, 12, v14
    buffer_load_dwordx2 v[2:3], v14, s[40:43], s72 offen sc0 sc1
    v_and_b32 v18, 15, v1
    v_and_b32 v19, 7, v1
    v_lshrrev_b32 v18, 3, v18
    v_lshl_add_u32 v19, v19, 7, v22
    v_lshl_add_u32 v19, v18, 6, v19
    s_waitcnt lgkmcnt(8)
    v_mfma_f32_16x16x32_bf16 v[144:147], a[128:131], a[64:67], v[144:147]
    ds_read_b64_tr_b16 a[160:161], v94 offset:0
    buffer_load_dwordx4 a[4:7], v16, s[32:35], s64 offen offset:1024 sc1
    v_mfma_f32_16x16x32_bf16 v[144:147], a[132:135], a[72:75], v[144:147]
    ds_read_b64_tr_b16 a[162:163], v94 offset:4096
    v_exp_f32_e64 v83, v83 clamp
    v_mfma_f32_16x16x32_bf16 v[148:151], a[132:135], a[76:79], v[148:151]
    ds_read_b64_tr_b16 a[164:165], v94 offset:8192
    v_max_f32 v32, 0, v32
    v_mfma_f32_16x16x32_bf16 v[148:151], a[128:131], a[68:71], v[148:151]
    ds_read_b64_tr_b16 a[166:167], v94 offset:12288
    v_max_f32 v33, 0, v33
    v_mfma_f32_16x16x32_bf16 v[156:159], a[136:139], a[68:71], v[156:159]
    ds_read_b64_tr_b16 a[168:169], v95 offset:0
    v_max_f32 v34, 0, v34
    v_mfma_f32_16x16x32_bf16 v[156:159], a[140:143], a[76:79], v[156:159]
    ds_read_b64_tr_b16 a[170:171], v95 offset:4096
    buffer_load_dwordx4 v13, s[56:59], s75 offen offset:3072  lds
    v_mfma_f32_16x16x32_bf16 v[152:155], a[140:143], a[72:75], v[152:155]
    ds_read_b64_tr_b16 a[172:173], v95 offset:8192
    s_add_u32 s75, s75, 131072
    v_max_f32 v35, 0, v35
    v_mfma_f32_16x16x32_bf16 v[152:155], a[136:139], a[64:67], v[152:155]
    ds_read_b64_tr_b16 a[174:175], v95 offset:12288
    v_add_f32 v32, v32, v80
    s_waitcnt vmcnt(14) lgkmcnt(8)
    s_barrier
    v_mfma_f32_16x16x32_bf16 v[160:163], a[144:147], a[64:67], v[160:163]
    ds_read_b64_tr_b16 a[112:113], v88 offset:16384
    buffer_load_dwordx4 a[8:11], v16, s[32:35], s64 offen offset:2048 sc1
    v_mfma_f32_16x16x32_bf16 v[160:163], a[148:151], a[72:75], v[160:163]
    ds_read_b64_tr_b16 a[114:115], v88 offset:20480
    v_add_f32 v33, v33, v81
    v_mfma_f32_16x16x32_bf16 v[164:167], a[148:151], a[76:79], v[164:167]
    ds_read_b64_tr_b16 a[116:117], v88 offset:24576
    v_add_f32 v34, v34, v82
    v_mfma_f32_16x16x32_bf16 v[164:167], a[144:147], a[68:71], v[164:167]
    ds_read_b64_tr_b16 a[118:119], v88 offset:28672
    s_cmp_eq_u32 s3, 2
    s_cbranch_scc0 L_l28
    s_add_u32 s76, s70, 2097152
    buffer_load_dword v23, v17, s[56:59], s76 offen
L_l28:
    v_add_f32 v35, v35, v83
    v_mfma_f32_16x16x32_bf16 v[172:175], a[152:155], a[68:71], v[172:175]
    ds_read_b64_tr_b16 a[120:121], v89 offset:16384
    s_add_u32 m0, s88, 131072
    v_add_f32 v32, s48, v32
    v_mfma_f32_16x16x32_bf16 v[172:175], a[156:159], a[76:79], v[172:175]
    ds_read_b64_tr_b16 a[122:123], v89 offset:20480
    buffer_load_dwordx4 v10, s[56:59], s75 offen offset:0  lds
    v_mfma_f32_16x16x32_bf16 v[168:171], a[156:159], a[72:75], v[168:171]
    ds_read_b64_tr_b16 a[124:125], v89 offset:24576
    v_add_f32 v33, s48, v33
    v_mfma_f32_16x16x32_bf16 v[168:171], a[152:155], a[64:67], v[168:171]
    ds_read_b64_tr_b16 a[126:127], v89 offset:28672
    v_add_f32 v34, s48, v34
    s_waitcnt lgkmcnt(8)
    v_mfma_f32_16x16x32_bf16 v[176:179], a[160:163], a[64:67], v[176:179]
    ds_read_b64_tr_b16 a[128:129], v90 offset:16384
    buffer_load_dwordx4 a[12:15], v16, s[32:35], s64 offen offset:3072 sc1
    v_accvgpr_read_b32 v124, a82
    v_mfma_f32_16x16x32_bf16 v[176:179], a[164:167], a[72:75], v[176:179]
    ds_read_b64_tr_b16 a[130:131], v90 offset:20480
    v_accvgpr_read_b32 v125, a83
    v_add_f32 v35, s48, v35
    v_mfma_f32_16x16x32_bf16 v[180:183], a[164:167], a[76:79], v[180:183]
    ds_read_b64_tr_b16 a[132:133], v90 offset:24576
    s_add_u32 s64, s64, 4096
    v_accvgpr_mov_b32 a82, a84
    v_mfma_f32_16x16x32_bf16 v[180:183], a[160:163], a[68:71], v[180:183]
    ds_read_b64_tr_b16 a[134:135], v90 offset:28672
    v_accvgpr_mov_b32 a83, a85
    v_mul_f32 v80, s44, v48
    v_mfma_f32_16x16x32_bf16 v[188:191], a[168:171], a[68:71], v[188:191]
    ds_read_b64_tr_b16 a[136:137], v91 offset:16384
    v_accvgpr_write_b32 a84, v124
    v_mul_f32 v81, s44, v49
    v_mfma_f32_16x16x32_bf16 v[188:191], a[172:175], a[76:79], v[188:191]
    ds_read_b64_tr_b16 a[138:139], v91 offset:20480
    buffer_load_dwordx4 v11, s[56:59], s75 offen offset:1024  lds
    v_accvgpr_write_b32 a85, v125
    v_mfma_f32_16x16x32_bf16 v[184:187], a[172:175], a[72:75], v[184:187]
    ds_read_b64_tr_b16 a[140:141], v91 offset:24576
    v_mul_f32 v82, s44, v50
    v_mfma_f32_16x16x32_bf16 v[184:187], a[168:171], a[64:67], v[184:187]
    ds_read_b64_tr_b16 a[142:143], v91 offset:28672
    v_mul_f32 v83, s44, v51
    s_waitcnt lgkmcnt(8)
    v_mfma_f32_16x16x32_bf16 v[128:131], a[112:115], a[80:83], v[128:131]
    ds_read_b64_tr_b16 a[144:145], v92 offset:16384
    buffer_load_dwordx4 a[16:19], v16, s[32:35], s64 offen offset:0 sc1
    v_mfma_f32_16x16x32_bf16 v[128:131], a[116:119], a[88:91], v[128:131]
    ds_read_b64_tr_b16 a[146:147], v92 offset:20480
    v_exp_f32_e64 v80, v80 clamp
    v_mfma_f32_16x16x32_bf16 v[132:135], a[116:119], a[92:95], v[132:135]
    ds_read_b64_tr_b16 a[148:149], v92 offset:24576
    v_exp_f32_e64 v81, v81 clamp
    v_mfma_f32_16x16x32_bf16 v[132:135], a[112:115], a[84:87], v[132:135]
    ds_read_b64_tr_b16 a[150:151], v92 offset:28672
    v_exp_f32_e64 v82, v82 clamp
    v_mfma_f32_16x16x32_bf16 v[140:143], a[120:123], a[84:87], v[140:143]
    ds_read_b64_tr_b16 a[152:153], v93 offset:16384
    v_exp_f32_e64 v83, v83 clamp
    v_mfma_f32_16x16x32_bf16 v[140:143], a[124:127], a[92:95], v[140:143]
    ds_read_b64_tr_b16 a[154:155], v93 offset:20480
    buffer_load_dwordx4 v12, s[56:59], s75 offen offset:2048  lds
    v_mfma_f32_16x16x32_bf16 v[136:139], a[124:127], a[88:91], v[136:139]
    ds_read_b64_tr_b16 a[156:157], v93 offset:24576
    v_max_f32 v48, 0, v48
    v_mfma_f32_16x16x32_bf16 v[136:139], a[120:123], a[80:83], v[136:139]
    ds_read_b64_tr_b16 a[158:159], v93 offset:28672
    v_max_f32 v49, 0, v49
    s_waitcnt lgkmcnt(8)
    v_mfma_f32_16x16x32_bf16 v[144:147], a[128:131], a[80:83], v[144:147]
    ds_read_b64_tr_b16 a[160:161], v94 offset:16384
    buffer_load_dwordx4 a[20:23], v16, s[32:35], s64 offen offset:1024 sc1
    v_mfma_f32_16x16x32_bf16 v[144:147], a[132:135], a[88:91], v[144:147]
    ds_read_b64_tr_b16 a[162:163], v94 offset:20480
    v_max_f32 v50, 0, v50
    v_mfma_f32_16x16x32_bf16 v[148:151], a[132:135], a[92:95], v[148:151]
    ds_read_b64_tr_b16 a[164:165], v94 offset:24576
    v_max_f32 v51, 0, v51
    v_mfma_f32_16x16x32_bf16 v[148:151], a[128:131], a[84:87], v[148:151]
    ds_read_b64_tr_b16 a[166:167], v94 offset:28672
    v_add_f32 v48, v48, v80
    v_mfma_f32_16x16x32_bf16 v[156:159], a[136:139], a[84:87], v[156:159]
    ds_read_b64_tr_b16 a[168:169], v95 offset:16384
    v_add_f32 v49, v49, v81
    v_mfma_f32_16x16x32_bf16 v[156:159], a[140:143], a[92:95], v[156:159]
    ds_read_b64_tr_b16 a[170:171], v95 offset:20480
    buffer_load_dwordx4 v13, s[56:59], s75 offen offset:3072  lds
    v_mfma_f32_16x16x32_bf16 v[152:155], a[140:143], a[88:91], v[152:155]
    ds_read_b64_tr_b16 a[172:173], v95 offset:24576
    s_add_u32 s75, s75, 131072
    v_add_f32 v50, v50, v82
    v_mfma_f32_16x16x32_bf16 v[152:155], a[136:139], a[80:83], v[152:155]
    ds_read_b64_tr_b16 a[174:175], v95 offset:28672
    v_add_f32 v51, v51, v83
    s_waitcnt vmcnt(14) lgkmcnt(8)
    s_barrier
    v_mfma_f32_16x16x32_bf16 v[160:163], a[144:147], a[80:83], v[160:163]
    ds_read_b64_tr_b16 a[112:113], v96 offset:0
    buffer_load_dwordx4 a[24:27], v16, s[32:35], s64 offen offset:2048 sc1
    v_mfma_f32_16x16x32_bf16 v[160:163], a[148:151], a[88:91], v[160:163]
    ds_read_b64_tr_b16 a[114:115], v96 offset:4096
    v_add_f32 v48, s48, v48
    v_mfma_f32_16x16x32_bf16 v[164:167], a[148:151], a[92:95], v[164:167]
    ds_read_b64_tr_b16 a[116:117], v96 offset:8192
    v_add_f32 v49, s48, v49
    v_mfma_f32_16x16x32_bf16 v[164:167], a[144:147], a[84:87], v[164:167]
    ds_read_b64_tr_b16 a[118:119], v96 offset:12288
    v_add_f32 v50, s48, v50
    v_mfma_f32_16x16x32_bf16 v[172:175], a[152:155], a[84:87], v[172:175]
    ds_read_b64_tr_b16 a[120:121], v97 offset:0
    s_add_u32 m0, s88, 0
    v_add_f32 v51, s48, v51
    v_mfma_f32_16x16x32_bf16 v[172:175], a[156:159], a[92:95], v[172:175]
    ds_read_b64_tr_b16 a[122:123], v97 offset:4096
    buffer_load_dwordx4 v10, s[56:59], s75 offen offset:0  lds
    v_mfma_f32_16x16x32_bf16 v[168:171], a[156:159], a[88:91], v[168:171]
    ds_read_b64_tr_b16 a[124:125], v97 offset:8192
    v_cvt_pk_bf16_f32 v32, v32, v33
    v_mfma_f32_16x16x32_bf16 v[168:171], a[152:155], a[80:83], v[168:171]
    ds_read_b64_tr_b16 a[126:127], v97 offset:12288
    v_cvt_pk_bf16_f32 v33, v34, v35
    s_waitcnt lgkmcnt(8)
    v_mfma_f32_16x16x32_bf16 v[176:179], a[160:163], a[80:83], v[176:179]
    ds_read_b64_tr_b16 a[128:129], v98 offset:0
    buffer_load_dwordx4 a[28:31], v16, s[32:35], s64 offen offset:3072 sc1
    v_mfma_f32_16x16x32_bf16 v[176:179], a[164:167], a[88:91], v[176:179]
    ds_read_b64_tr_b16 a[130:131], v98 offset:4096
    v_cvt_pk_bf16_f32 v34, v48, v49
    v_mfma_f32_16x16x32_bf16 v[180:183], a[164:167], a[92:95], v[180:183]
    ds_read_b64_tr_b16 a[132:133], v98 offset:8192
    s_add_u32 s64, s64, 4096
    v_cvt_pk_bf16_f32 v35, v50, v51
    v_mfma_f32_16x16x32_bf16 v[180:183], a[160:163], a[84:87], v[180:183]
    ds_read_b64_tr_b16 a[134:135], v98 offset:12288
    v_mul_f32 v80, s44, v36
    v_mfma_f32_16x16x32_bf16 v[188:191], a[168:171], a[84:87], v[188:191]
    ds_read_b64_tr_b16 a[136:137], v99 offset:0
    v_mul_f32 v81, s44, v37
    v_mfma_f32_16x16x32_bf16 v[188:191], a[172:175], a[92:95], v[188:191]
    ds_read_b64_tr_b16 a[138:139], v99 offset:4096
    buffer_load_dwordx4 v11, s[56:59], s75 offen offset:1024  lds
    v_mfma_f32_16x16x32_bf16 v[184:187], a[172:175], a[88:91], v[184:187]
    ds_read_b64_tr_b16 a[140:141], v99 offset:8192
    v_mul_f32 v82, s44, v38
    v_mfma_f32_16x16x32_bf16 v[184:187], a[168:171], a[80:83], v[184:187]
    ds_read_b64_tr_b16 a[142:143], v99 offset:12288
    v_mul_f32 v83, s44, v39
    s_waitcnt lgkmcnt(8)
    v_mfma_f32_16x16x32_bf16 v[128:131], a[112:115], a[96:99], v[128:131]
    ds_read_b64_tr_b16 a[144:145], v100 offset:0
    buffer_load_dwordx4 a[32:35], v16, s[32:35], s64 offen offset:0 sc1
    v_mfma_f32_16x16x32_bf16 v[128:131], a[116:119], a[104:107], v[128:131]
    ds_read_b64_tr_b16 a[146:147], v100 offset:4096
    v_exp_f32_e64 v80, v80 clamp
    v_mfma_f32_16x16x32_bf16 v[132:135], a[116:119], a[108:111], v[132:135]
    ds_read_b64_tr_b16 a[148:149], v100 offset:8192
    v_exp_f32_e64 v81, v81 clamp
    v_mfma_f32_16x16x32_bf16 v[132:135], a[112:115], a[100:103], v[132:135]
    ds_read_b64_tr_b16 a[150:151], v100 offset:12288
    v_exp_f32_e64 v82, v82 clamp
    v_mfma_f32_16x16x32_bf16 v[140:143], a[120:123], a[100:103], v[140:143]
    ds_read_b64_tr_b16 a[152:153], v101 offset:0
    v_exp_f32_e64 v83, v83 clamp
    v_mfma_f32_16x16x32_bf16 v[140:143], a[124:127], a[108:111], v[140:143]
    ds_read_b64_tr_b16 a[154:155], v101 offset:4096
    buffer_load_dwordx4 v12, s[56:59], s75 offen offset:2048  lds
    v_mfma_f32_16x16x32_bf16 v[136:139], a[124:127], a[104:107], v[136:139]
    ds_read_b64_tr_b16 a[156:157], v101 offset:8192
    v_max_f32 v36, 0, v36
    v_mfma_f32_16x16x32_bf16 v[136:139], a[120:123], a[96:99], v[136:139]
    ds_read_b64_tr_b16 a[158:159], v101 offset:12288
    v_max_f32 v37, 0, v37
    s_waitcnt lgkmcnt(8)
    v_mfma_f32_16x16x32_bf16 v[144:147], a[128:131], a[96:99], v[144:147]
    ds_read_b64_tr_b16 a[160:161], v102 offset:0
    buffer_load_dwordx4 a[36:39], v16, s[32:35], s64 offen offset:1024 sc1
    v_mfma_f32_16x16x32_bf16 v[144:147], a[132:135], a[104:107], v[144:147]
    ds_read_b64_tr_b16 a[162:163], v102 offset:4096
    v_max_f32 v38, 0, v38
    v_mfma_f32_16x16x32_bf16 v[148:151], a[132:135], a[108:111], v[148:151]
    ds_read_b64_tr_b16 a[164:165], v102 offset:8192
    v_max_f32 v39, 0, v39
    v_mfma_f32_16x16x32_bf16 v[148:151], a[128:131], a[100:103], v[148:151]
    ds_read_b64_tr_b16 a[166:167], v102 offset:12288
    v_add_f32 v36, v36, v80
    v_mfma_f32_16x16x32_bf16 v[156:159], a[136:139], a[100:103], v[156:159]
    ds_read_b64_tr_b16 a[168:169], v103 offset:0
    v_add_f32 v37, v37, v81
    v_mfma_f32_16x16x32_bf16 v[156:159], a[140:143], a[108:111], v[156:159]
    ds_read_b64_tr_b16 a[170:171], v103 offset:4096
    buffer_load_dwordx4 v13, s[56:59], s75 offen offset:3072  lds
    v_mfma_f32_16x16x32_bf16 v[152:155], a[140:143], a[104:107], v[152:155]
    ds_read_b64_tr_b16 a[172:173], v103 offset:8192
    s_add_u32 s75, s75, 131072
    v_add_f32 v38, v38, v82
    v_mfma_f32_16x16x32_bf16 v[152:155], a[136:139], a[96:99], v[152:155]
    ds_read_b64_tr_b16 a[174:175], v103 offset:12288
    v_add_f32 v39, v39, v83
    s_waitcnt vmcnt(13) lgkmcnt(8)
    s_barrier
    v_mfma_f32_16x16x32_bf16 v[160:163], a[144:147], a[96:99], v[160:163]
    ds_read_b64_tr_b16 a[112:113], v88 offset:32768
    buffer_load_dwordx4 a[40:43], v16, s[32:35], s64 offen offset:2048 sc1
    v_mfma_f32_16x16x32_bf16 v[160:163], a[148:151], a[104:107], v[160:163]
    ds_read_b64_tr_b16 a[114:115], v88 offset:36864
    v_add_f32 v36, s48, v36
    v_mfma_f32_16x16x32_bf16 v[164:167], a[148:151], a[108:111], v[164:167]
    ds_read_b64_tr_b16 a[116:117], v88 offset:40960
    v_add_f32 v37, s48, v37
    v_mfma_f32_16x16x32_bf16 v[164:167], a[144:147], a[100:103], v[164:167]
    ds_read_b64_tr_b16 a[118:119], v88 offset:45056
    v_add_f32 v38, s48, v38
    v_mfma_f32_16x16x32_bf16 v[172:175], a[152:155], a[100:103], v[172:175]
    ds_read_b64_tr_b16 a[120:121], v89 offset:32768
    s_add_u32 m0, s88, 16384
    v_add_f32 v39, s48, v39
    v_mfma_f32_16x16x32_bf16 v[172:175], a[156:159], a[108:111], v[172:175]
    ds_read_b64_tr_b16 a[122:123], v89 offset:36864
    buffer_load_dwordx4 v10, s[56:59], s75 offen offset:0  lds
    v_mfma_f32_16x16x32_bf16 v[168:171], a[156:159], a[104:107], v[168:171]
    ds_read_b64_tr_b16 a[124:125], v89 offset:40960
    v_mul_f32 v80, s44, v52
    v_mfma_f32_16x16x32_bf16 v[168:171], a[152:155], a[96:99], v[168:171]
    ds_read_b64_tr_b16 a[126:127], v89 offset:45056
    v_mul_f32 v81, s44, v53
    s_mov_b32 s99, 0
L_ck1:
    v_xor_b32 v2, s92, v2
    v_xor_b32 v3, s93, v3
    v_or_b32 v2, v2, v3
    v_cmp_ne_u32 vcc, 0, v2
    s_cbranch_vccz L_ck1_ok
    buffer_load_dwordx2 v[2:3], v14, s[40:43], s72 offen sc0 sc1
    s_add_u32 s99, s99, 1
    s_cmp_lt_u32 s99, 0x200000
    s_waitcnt vmcnt(0)
    s_cbranch_scc1 L_ck1
L_ck1_ok:
    s_waitcnt lgkmcnt(8)
    v_mfma_f32_16x16x32_bf16 v[176:179], a[160:163], a[96:99], v[176:179]
    ds_read_b64_tr_b16 a[128:129], v90 offset:32768
    buffer_load_dwordx4 a[44:47], v16, s[32:35], s64 offen offset:3072 sc1
    v_mfma_f32_16x16x32_bf16 v[176:179], a[164:167], a[104:107], v[176:179]
    ds_read_b64_tr_b16 a[130:131], v90 offset:36864
    v_mul_f32 v82, s44, v54
    buffer_load_dwordx4 v[224:227], v19, s[40:43], s87 offen sc1
    v_mfma_f32_16x16x32_bf16 v[180:183], a[164:167], a[108:111], v[180:183]
    ds_read_b64_tr_b16 a[132:133], v90 offset:40960
    s_add_u32 s64, s64, 4096
    v_mul_f32 v83, s44, v55
    v_mfma_f32_16x16x32_bf16 v[180:183], a[160:163], a[100:103], v[180:183]
    ds_read_b64_tr_b16 a[134:135], v90 offset:45056
    v_exp_f32_e64 v80, v80 clamp
    v_mfma_f32_16x16x32_bf16 v[188:191], a[168:171], a[100:103], v[188:191]
    ds_read_b64_tr_b16 a[136:137], v91 offset:32768
    v_exp_f32_e64 v81, v81 clamp
    v_mfma_f32_16x16x32_bf16 v[188:191], a[172:175], a[108:111], v[188:191]
    ds_read_b64_tr_b16 a[138:139], v91 offset:36864
    buffer_load_dwordx4 v11, s[56:59], s75 offen offset:1024  lds
    v_mfma_f32_16x16x32_bf16 v[184:187], a[172:175], a[104:107], v[184:187]
    ds_read_b64_tr_b16 a[140:141], v91 offset:40960
    v_exp_f32_e64 v82, v82 clamp
    v_mfma_f32_16x16x32_bf16 v[184:187], a[168:171], a[96:99], v[184:187]
    ds_read_b64_tr_b16 a[142:143], v91 offset:45056
    v_exp_f32_e64 v83, v83 clamp
    buffer_load_dwordx4 v[192:195], v16, s[40:43], s60 offen sc1
    s_waitcnt lgkmcnt(8)
    v_mfma_f32_16x16x32_bf16 v[128:131], a[112:115], a[0:3], v[128:131]
    ds_read_b64_tr_b16 a[144:145], v92 offset:32768
    buffer_load_dwordx4 a[48:51], v16, s[32:35], s64 offen offset:0 sc1
    v_mfma_f32_16x16x32_bf16 v[128:131], a[116:119], a[8:11], v[128:131]
    ds_read_b64_tr_b16 a[146:147], v92 offset:36864
    v_max_f32 v52, 0, v52
    v_mfma_f32_16x16x32_bf16 v[132:135], a[116:119], a[12:15], v[132:135]
    ds_read_b64_tr_b16 a[148:149], v92 offset:40960
    v_max_f32 v53, 0, v53
    v_mfma_f32_16x16x32_bf16 v[132:135], a[112:115], a[4:7], v[132:135]
    ds_read_b64_tr_b16 a[150:151], v92 offset:45056
    v_max_f32 v54, 0, v54
    v_mfma_f32_16x16x32_bf16 v[140:143], a[120:123], a[4:7], v[140:143]
    ds_read_b64_tr_b16 a[152:153], v93 offset:32768
    v_max_f32 v55, 0, v55
    v_mfma_f32_16x16x32_bf16 v[140:143], a[124:127], a[12:15], v[140:143]
    ds_read_b64_tr_b16 a[154:155], v93 offset:36864
    buffer_load_dwordx4 v12, s[56:59], s75 offen offset:2048  lds
    s_add_u32 s60, s60, 4096
    buffer_load_dwordx4 v[196:199], v16, s[40:43], s60 offen sc1
    v_mfma_f32_16x16x32_bf16 v[136:139], a[124:127], a[8:11], v[136:139]
    ds_read_b64_tr_b16 a[156:157], v93 offset:40960
    v_add_f32 v52, v52, v80
    v_mfma_f32_16x16x32_bf16 v[136:139], a[120:123], a[0:3], v[136:139]
    ds_read_b64_tr_b16 a[158:159], v93 offset:45056
    v_add_f32 v53, v53, v81
    s_waitcnt lgkmcnt(8)
    v_mfma_f32_16x16x32_bf16 v[144:147], a[128:131], a[0:3], v[144:147]
    ds_read_b64_tr_b16 a[160:161], v94 offset:32768
    buffer_load_dwordx4 a[52:55], v16, s[32:35], s64 offen offset:1024 sc1
    v_mfma_f32_16x16x32_bf16 v[144:147], a[132:135], a[8:11], v[144:147]
    ds_read_b64_tr_b16 a[162:163], v94 offset:36864
    v_add_f32 v54, v54, v82
    v_mfma_f32_16x16x32_bf16 v[148:151], a[132:135], a[12:15], v[148:151]
    ds_read_b64_tr_b16 a[164:165], v94 offset:40960
    v_add_f32 v55, v55, v83
    v_mfma_f32_16x16x32_bf16 v[148:151], a[128:131], a[4:7], v[148:151]
    ds_read_b64_tr_b16 a[166:167], v94 offset:45056
    v_add_f32 v52, s48, v52
    s_add_u32 s60, s60, 4096
    buffer_load_dwordx4 v[200:203], v16, s[40:43], s60 offen sc1
    v_mfma_f32_16x16x32_bf16 v[156:159], a[136:139], a[4:7], v[156:159]
    ds_read_b64_tr_b16 a[168:169], v95 offset:32768
    v_add_f32 v53, s48, v53
    v_mfma_f32_16x16x32_bf16 v[156:159], a[140:143], a[12:15], v[156:159]
    ds_read_b64_tr_b16 a[170:171], v95 offset:36864
    buffer_load_dwordx4 v13, s[56:59], s75 offen offset:3072  lds
    v_mfma_f32_16x16x32_bf16 v[152:155], a[140:143], a[8:11], v[152:155]
    ds_read_b64_tr_b16 a[172:173], v95 offset:40960
    s_add_u32 s75, s75, 131072
    v_add_f32 v54, s48, v54
    v_mfma_f32_16x16x32_bf16 v[152:155], a[136:139], a[0:3], v[152:155]
    ds_read_b64_tr_b16 a[174:175], v95 offset:45056
    v_add_f32 v55, s48, v55
    s_waitcnt vmcnt(17) lgkmcnt(8)
    s_barrier
    v_mfma_f32_16x16x32_bf16 v[160:163], a[144:147], a[0:3], v[160:163]
    ds_read_b64_tr_b16 a[112:113], v88 offset:49152
    buffer_load_dwordx4 a[56:59], v16, s[32:35], s64 offen offset:2048 sc1
    v_mfma_f32_16x16x32_bf16 v[160:163], a[148:151], a[8:11], v[160:163]
    ds_read_b64_tr_b16 a[114:115], v88 offset:53248
    v_cvt_pk_bf16_f32 v36, v36, v37
    s_add_u32 s60, s60, 4096
    buffer_load_dwordx4 v[204:207], v16, s[40:43], s60 offen sc1
    v_mfma_f32_16x16x32_bf16 v[164:167], a[148:151], a[12:15], v[164:167]
    ds_read_b64_tr_b16 a[116:117], v88 offset:57344
    v_cvt_pk_bf16_f32 v37, v38, v39
    v_mfma_f32_16x16x32_bf16 v[164:167], a[144:147], a[4:7], v[164:167]
    ds_read_b64_tr_b16 a[118:119], v88 offset:61440
    v_cvt_pk_bf16_f32 v38, v52, v53
    v_mfma_f32_16x16x32_bf16 v[172:175], a[152:155], a[4:7], v[172:175]
    ds_read_b64_tr_b16 a[120:121], v89 offset:49152
    s_add_u32 m0, s88, 65536
    v_cvt_pk_bf16_f32 v39, v54, v55
    v_mfma_f32_16x16x32_bf16 v[172:175], a[156:159], a[12:15], v[172:175]
    ds_read_b64_tr_b16 a[122:123], v89 offset:53248
    buffer_load_dwordx4 v10, s[56:59], s75 offen offset:0  lds
    v_mfma_f32_16x16x32_bf16 v[168:171], a[156:159], a[8:11], v[168:171]
    ds_read_b64_tr_b16 a[124:125], v89 offset:57344
    v_lshrrev_b32 v84, 2, v1
    v_mfma_f32_16x16x32_bf16 v[168:171], a[152:155], a[0:3], v[168:171]
    ds_read_b64_tr_b16 a[126:127], v89 offset:61440
    v_and_b32 v85, 3, v1
    s_add_u32 s60, s60, 4096
    buffer_load_dwordx4 v[208:211], v16, s[40:43], s60 offen sc1
    s_waitcnt lgkmcnt(8)
    v_mfma_f32_16x16x32_bf16 v[176:179], a[160:163], a[0:3], v[176:179]
    ds_read_b64_tr_b16 a[128:129], v90 offset:49152
    buffer_load_dwordx4 a[60:63], v16, s[32:35], s64 offen offset:3072 sc1
    v_accvgpr_read_b32 v124, a26
    v_mfma_f32_16x16x32_bf16 v[176:179], a[164:167], a[8:11], v[176:179]
    ds_read_b64_tr_b16 a[130:131], v90 offset:53248
    v_accvgpr_read_b32 v125, a27
    v_lshlrev_b32 v85, 3, v85
    v_mfma_f32_16x16x32_bf16 v[180:183], a[164:167], a[12:15], v[180:183]
    ds_read_b64_tr_b16 a[132:133], v90 offset:57344
    s_add_u32 s64, s64, 4096
    v_accvgpr_mov_b32 a26, a28
    v_mfma_f32_16x16x32_bf16 v[180:183], a[160:163], a[4:7], v[180:183]
    ds_read_b64_tr_b16 a[134:135], v90 offset:61440
    v_accvgpr_mov_b32 a27, a29
    v_lshl_add_u32 v86, v84, 7, v85
    v_mfma_f32_16x16x32_bf16 v[188:191], a[168:171], a[4:7], v[188:191]
    ds_read_b64_tr_b16 a[136:137], v91 offset:49152
    v_accvgpr_write_b32 a28, v124
    v_bfe_u32 v87, v1, 3, 2
    v_mfma_f32_16x16x32_bf16 v[188:191], a[172:175], a[12:15], v[188:191]
    ds_read_b64_tr_b16 a[138:139], v91 offset:53248
    buffer_load_dwordx4 v11, s[56:59], s75 offen offset:1024  lds
    v_accvgpr_write_b32 a29, v125
    s_add_u32 s60, s60, 4096
    buffer_load_dwordx4 v[212:215], v16, s[40:43], s60 offen sc1
    v_mfma_f32_16x16x32_bf16 v[184:187], a[172:175], a[8:11], v[184:187]
    ds_read_b64_tr_b16 a[140:141], v91 offset:57344
    v_xor_b32 v84, 0, v87
    v_mfma_f32_16x16x32_bf16 v[184:187], a[168:171], a[0:3], v[184:187]
    ds_read_b64_tr_b16 a[142:143], v91 offset:61440
    v_lshl_add_u32 v112, v84, 5, v86
    s_waitcnt lgkmcnt(8)
    v_mfma_f32_16x16x32_bf16 v[128:131], a[112:115], a[16:19], v[128:131]
    ds_read_b64_tr_b16 a[144:145], v92 offset:49152
    buffer_load_dwordx4 a[64:67], v16, s[32:35], s64 offen offset:0 sc1
    v_mfma_f32_16x16x32_bf16 v[128:131], a[116:119], a[24:27], v[128:131]
    ds_read_b64_tr_b16 a[146:147], v92 offset:53248
    v_add_u32 v116, 0x10000, v112
    v_mfma_f32_16x16x32_bf16 v[132:135], a[116:119], a[28:31], v[132:135]
    ds_read_b64_tr_b16 a[148:149], v92 offset:57344
    v_add_u32 v120, 0x20000, v112
    v_mfma_f32_16x16x32_bf16 v[132:135], a[112:115], a[20:23], v[132:135]
    ds_read_b64_tr_b16 a[150:151], v92 offset:61440
    v_xor_b32 v84, 1, v87
    s_add_u32 s60, s60, 4096
    buffer_load_dwordx4 v[216:219], v16, s[40:43], s60 offen sc1
    v_mfma_f32_16x16x32_bf16 v[140:143], a[120:123], a[20:23], v[140:143]
    ds_read_b64_tr_b16 a[152:153], v93 offset:49152
    v_lshl_add_u32 v113, v84, 5, v86
    v_mfma_f32_16x16x32_bf16 v[140:143], a[124:127], a[28:31], v[140:143]
    ds_read_b64_tr_b16 a[154:155], v93 offset:53248
    buffer_load_dwordx4 v12, s[56:59], s75 offen offset:2048  lds
    v_mfma_f32_16x16x32_bf16 v[136:139], a[124:127], a[24:27], v[136:139]
    ds_read_b64_tr_b16 a[156:157], v93 offset:57344
    v_add_u32 v117, 0x10000, v113
    v_mfma_f32_16x16x32_bf16 v[136:139], a[120:123], a[16:19], v[136:139]
    ds_read_b64_tr_b16 a[158:159], v93 offset:61440
    v_add_u32 v121, 0x20000, v113
    s_waitcnt lgkmcnt(8)
    v_mfma_f32_16x16x32_bf16 v[144:147], a[128:131], a[16:19], v[144:147]
    ds_read_b64_tr_b16 a[160:161], v94 offset:49152
    buffer_load_dwordx4 a[68:71], v16, s[32:35], s64 offen offset:1024 sc1
    v_mfma_f32_16x16x32_bf16 v[144:147], a[132:135], a[24:27], v[144:147]
    ds_read_b64_tr_b16 a[162:163], v94 offset:53248
    v_xor_b32 v84, 2, v87
    s_add_u32 s60, s60, 4096
    buffer_load_dwordx4 v[220:223], v16, s[40:43], s60 offen sc1
    v_mfma_f32_16x16x32_bf16 v[148:151], a[132:135], a[28:31], v[148:151]
    ds_read_b64_tr_b16 a[164:165], v94 offset:57344
    v_lshl_add_u32 v114, v84, 5, v86
    v_mfma_f32_16x16x32_bf16 v[148:151], a[128:131], a[20:23], v[148:151]
    ds_read_b64_tr_b16 a[166:167], v94 offset:61440
    v_add_u32 v118, 0x10000, v114
    v_mfma_f32_16x16x32_bf16 v[156:159], a[136:139], a[20:23], v[156:159]
    ds_read_b64_tr_b16 a[168:169], v95 offset:49152
    v_add_u32 v122, 0x20000, v114
    v_mfma_f32_16x16x32_bf16 v[156:159], a[140:143], a[28:31], v[156:159]
    ds_read_b64_tr_b16 a[170:171], v95 offset:53248
    buffer_load_dwordx4 v13, s[56:59], s75 offen offset:3072  lds
    v_mfma_f32_16x16x32_bf16 v[152:155], a[140:143], a[24:27], v[152:155]
    ds_read_b64_tr_b16 a[172:173], v95 offset:57344
    s_add_u32 s75, s75, 131072
    v_xor_b32 v84, 3, v87
    v_mfma_f32_16x16x32_bf16 v[152:155], a[136:139], a[16:19], v[152:155]
    ds_read_b64_tr_b16 a[174:175], v95 offset:61440
    v_lshl_add_u32 v115, v84, 5, v86
    s_waitcnt vmcnt(22) lgkmcnt(8)
    s_barrier
    v_mfma_f32_16x16x32_bf16 v[160:163], a[144:147], a[16:19], v[160:163]
    ds_read_b64_tr_b16 a[112:113], v96 offset:16384
    buffer_load_dwordx4 a[72:75], v16, s[32:35], s64 offen offset:2048 sc1
    v_mfma_f32_16x16x32_bf16 v[160:163], a[148:151], a[24:27], v[160:163]
    ds_read_b64_tr_b16 a[114:115], v96 offset:20480
    v_add_u32 v119, 0x10000, v115
    v_mfma_f32_16x16x32_bf16 v[164:167], a[148:151], a[28:31], v[164:167]
    ds_read_b64_tr_b16 a[116:117], v96 offset:24576
    v_add_u32 v123, 0x20000, v115
    v_mfma_f32_16x16x32_bf16 v[164:167], a[144:147], a[20:23], v[164:167]
    ds_read_b64_tr_b16 a[118:119], v96 offset:28672
    v_lshrrev_b32 v84, 3, v1
    v_mfma_f32_16x16x32_bf16 v[172:175], a[152:155], a[20:23], v[172:175]
    ds_read_b64_tr_b16 a[120:121], v97 offset:16384
    s_add_u32 m0, s88, 32768
    v_bfe_u32 v85, v1, 1, 2
    v_mfma_f32_16x16x32_bf16 v[172:175], a[156:159], a[28:31], v[172:175]
    ds_read_b64_tr_b16 a[122:123], v97 offset:20480
    buffer_load_dwordx4 v10, s[56:59], s75 offen offset:0  lds
    v_mfma_f32_16x16x32_bf16 v[168:171], a[156:159], a[24:27], v[168:171]
    ds_read_b64_tr_b16 a[124:125], v97 offset:24576
    v_bfe_u32 v86, v1, 4, 2
    v_mfma_f32_16x16x32_bf16 v[168:171], a[152:155], a[16:19], v[168:171]
    ds_read_b64_tr_b16 a[126:127], v97 offset:28672
    v_xor_b32 v85, v85, v86
    s_waitcnt lgkmcnt(8)
    v_mfma_f32_16x16x32_bf16 v[176:179], a[160:163], a[16:19], v[176:179]
    ds_read_b64_tr_b16 a[128:129], v98 offset:16384
    buffer_load_dwordx4 a[76:79], v16, s[32:35], s64 offen offset:3072 sc1
    v_mfma_f32_16x16x32_bf16 v[176:179], a[164:167], a[24:27], v[176:179]
    ds_read_b64_tr_b16 a[130:131], v98 offset:20480
    v_lshlrev_b32 v6, 11, v84
    v_mfma_f32_16x16x32_bf16 v[180:183], a[164:167], a[28:31], v[180:183]
    ds_read_b64_tr_b16 a[132:133], v98 offset:24576
    s_add_u32 s64, s64, 4096
    v_lshl_add_u32 v6, v85, 5, v6
    v_mfma_f32_16x16x32_bf16 v[180:183], a[160:163], a[20:23], v[180:183]
    ds_read_b64_tr_b16 a[134:135], v98 offset:28672
    v_and_b32 v85, 1, v1
    v_mfma_f32_16x16x32_bf16 v[188:191], a[168:171], a[20:23], v[188:191]
    ds_read_b64_tr_b16 a[136:137], v99 offset:16384
    v_lshl_add_u32 v6, v85, 4, v6
    v_mfma_f32_16x16x32_bf16 v[188:191], a[172:175], a[28:31], v[188:191]
    ds_read_b64_tr_b16 a[138:139], v99 offset:20480
    buffer_load_dwordx4 v11, s[56:59], s75 offen offset:1024  lds
    v_mfma_f32_16x16x32_bf16 v[184:187], a[172:175], a[24:27], v[184:187]
    ds_read_b64_tr_b16 a[140:141], v99 offset:24576
    s_lshl_b32 s54, s21, 8
    v_mfma_f32_16x16x32_bf16 v[184:187], a[168:171], a[16:19], v[184:187]
    ds_read_b64_tr_b16 a[142:143], v99 offset:28672
    s_lshl_b32 s53, s98, 7
    s_waitcnt lgkmcnt(8)
    v_mfma_f32_16x16x32_bf16 v[128:131], a[112:115], a[32:35], v[128:131]
    ds_read_b64_tr_b16 a[144:145], v100 offset:16384
    buffer_load_dwordx4 a[80:83], v16, s[32:35], s64 offen offset:0 sc1
    v_mfma_f32_16x16x32_bf16 v[128:131], a[116:119], a[40:43], v[128:131]
    ds_read_b64_tr_b16 a[146:147], v100 offset:20480
    s_add_u32 s54, s54, s53
    v_mfma_f32_16x16x32_bf16 v[132:135], a[116:119], a[44:47], v[132:135]
    ds_read_b64_tr_b16 a[148:149], v100 offset:24576
    s_lshl_b32 s52, s3, 16
    v_mfma_f32_16x16x32_bf16 v[132:135], a[112:115], a[36:39], v[132:135]
    ds_read_b64_tr_b16 a[150:151], v100 offset:28672
    s_add_u32 s52, s52, s54
    v_mfma_f32_16x16x32_bf16 v[140:143], a[120:123], a[36:39], v[140:143]
    ds_read_b64_tr_b16 a[152:153], v101 offset:16384
    v_add_u32 v6, s52, v6
    v_mfma_f32_16x16x32_bf16 v[140:143], a[124:127], a[44:47], v[140:143]
    ds_read_b64_tr_b16 a[154:155], v101 offset:20480
    buffer_load_dwordx4 v12, s[56:59], s75 offen offset:2048  lds
    v_mfma_f32_16x16x32_bf16 v[136:139], a[124:127], a[40:43], v[136:139]
    ds_read_b64_tr_b16 a[156:157], v101 offset:24576
    v_add_u32 v7, 15360, v6
    v_mfma_f32_16x16x32_bf16 v[136:139], a[120:123], a[32:35], v[136:139]
    ds_read_b64_tr_b16 a[158:159], v101 offset:28672
    v_add_u32 v8, 30720, v6
    s_waitcnt lgkmcnt(8)
    v_mfma_f32_16x16x32_bf16 v[144:147], a[128:131], a[32:35], v[144:147]
    ds_read_b64_tr_b16 a[160:161], v102 offset:16384
    buffer_load_dwordx4 a[84:87], v16, s[32:35], s64 offen offset:1024 sc1
    v_mfma_f32_16x16x32_bf16 v[144:147], a[132:135], a[40:43], v[144:147]
    ds_read_b64_tr_b16 a[162:163], v102 offset:20480
    v_add_u32 v9, 46080, v6
    v_mfma_f32_16x16x32_bf16 v[148:151], a[132:135], a[44:47], v[148:151]
    ds_read_b64_tr_b16 a[164:165], v102 offset:24576
    s_lshl_b32 s74, s2, 2
    v_mfma_f32_16x16x32_bf16 v[148:151], a[128:131], a[36:39], v[148:151]
    ds_read_b64_tr_b16 a[166:167], v102 offset:28672
    s_add_u32 s74, s74, s3
    v_mfma_f32_16x16x32_bf16 v[156:159], a[136:139], a[36:39], v[156:159]
    ds_read_b64_tr_b16 a[168:169], v103 offset:16384
    s_xor_b32 s69, s74, 16
    v_mfma_f32_16x16x32_bf16 v[156:159], a[140:143], a[44:47], v[156:159]
    ds_read_b64_tr_b16 a[170:171], v103 offset:20480
    buffer_load_dwordx4 v13, s[56:59], s75 offen offset:3072  lds
    v_mfma_f32_16x16x32_bf16 v[152:155], a[140:143], a[40:43], v[152:155]
    ds_read_b64_tr_b16 a[172:173], v103 offset:24576
    s_add_u32 s75, s75, 131072
    s_lshl_b32 s67, s74, 13
    v_mfma_f32_16x16x32_bf16 v[152:155], a[136:139], a[32:35], v[152:155]
    ds_read_b64_tr_b16 a[174:175], v103 offset:28672
    s_add_u32 s67, s67, 6291456
    s_waitcnt vmcnt(16) lgkmcnt(8)
    s_barrier
    v_mfma_f32_16x16x32_bf16 v[160:163], a[144:147], a[32:35], v[160:163]
    ds_read_b64_tr_b16 a[112:113], v96 offset:32768
    buffer_load_dwordx4 a[88:91], v16, s[32:35], s64 offen offset:2048 sc1
    v_mfma_f32_16x16x32_bf16 v[160:163], a[148:151], a[40:43], v[160:163]
    ds_read_b64_tr_b16 a[114:115], v96 offset:36864
    s_lshl_b32 s68, s69, 13
    v_mfma_f32_16x16x32_bf16 v[164:167], a[148:151], a[44:47], v[164:167]
    ds_read_b64_tr_b16 a[116:117], v96 offset:40960
    s_add_u32 s68, s68, 6291456
    v_mfma_f32_16x16x32_bf16 v[164:167], a[144:147], a[36:39], v[164:167]
    ds_read_b64_tr_b16 a[118:119], v96 offset:45056
    s_lshl_b32 s74, s74, 7
    v_mfma_f32_16x16x32_bf16 v[172:175], a[152:155], a[36:39], v[172:175]
    ds_read_b64_tr_b16 a[120:121], v97 offset:32768
    s_add_u32 m0, s88, 49152
    s_add_u32 s74, s74, 5898240
    v_mfma_f32_16x16x32_bf16 v[172:175], a[156:159], a[44:47], v[172:175]
    ds_read_b64_tr_b16 a[122:123], v97 offset:36864
    buffer_load_dwordx4 v10, s[56:59], s75 offen offset:0  lds
    v_mfma_f32_16x16x32_bf16 v[168:171], a[156:159], a[40:43], v[168:171]
    ds_read_b64_tr_b16 a[124:125], v97 offset:40960
    s_lshl_b32 s69, s69, 7
    v_mfma_f32_16x16x32_bf16 v[168:171], a[152:155], a[32:35], v[168:171]
    ds_read_b64_tr_b16 a[126:127], v97 offset:45056
    s_add_u32 s69, s69, 5898240
    s_waitcnt lgkmcnt(8)
    v_mfma_f32_16x16x32_bf16 v[176:179], a[160:163], a[32:35], v[176:179]
    ds_read_b64_tr_b16 a[128:129], v98 offset:32768
    buffer_load_dwordx4 a[92:95], v16, s[32:35], s64 offen offset:3072 sc1
    v_mfma_f32_16x16x32_bf16 v[176:179], a[164:167], a[40:43], v[176:179]
    ds_read_b64_tr_b16 a[130:131], v98 offset:36864
    v_and_b32 v20, 31, v1
    v_mfma_f32_16x16x32_bf16 v[180:183], a[164:167], a[44:47], v[180:183]
    ds_read_b64_tr_b16 a[132:133], v98 offset:40960
    s_add_u32 s64, s64, 4096
    s_lshr_b32 s52, s2, 3
    v_mfma_f32_16x16x32_bf16 v[180:183], a[160:163], a[36:39], v[180:183]
    ds_read_b64_tr_b16 a[134:135], v98 offset:45056
    s_lshl_b32 s52, s52, 5
    v_mfma_f32_16x16x32_bf16 v[188:191], a[168:171], a[36:39], v[188:191]
    ds_read_b64_tr_b16 a[136:137], v99 offset:32768
    v_add_u32 v20, s52, v20
    v_mfma_f32_16x16x32_bf16 v[188:191], a[172:175], a[44:47], v[188:191]
    ds_read_b64_tr_b16 a[138:139], v99 offset:36864
    buffer_load_dwordx4 v11, s[56:59], s75 offen offset:1024  lds
    v_mfma_f32_16x16x32_bf16 v[184:187], a[172:175], a[40:43], v[184:187]
    ds_read_b64_tr_b16 a[140:141], v99 offset:40960
    v_lshlrev_b32 v20, 11, v20
    v_mfma_f32_16x16x32_bf16 v[184:187], a[168:171], a[32:35], v[184:187]
    ds_read_b64_tr_b16 a[142:143], v99 offset:45056
    s_lshr_b32 s52, s21, 2
    s_waitcnt lgkmcnt(8)
    v_mfma_f32_16x16x32_bf16 v[128:131], a[112:115], a[48:51], v[128:131]
    ds_read_b64_tr_b16 a[144:145], v100 offset:32768
    buffer_load_dwordx4 a[96:99], v16, s[32:35], s64 offen offset:0 sc1
    v_mfma_f32_16x16x32_bf16 v[128:131], a[116:119], a[56:59], v[128:131]
    ds_read_b64_tr_b16 a[146:147], v100 offset:36864
    s_lshl_b32 s52, s52, 10
    v_mfma_f32_16x16x32_bf16 v[132:135], a[116:119], a[60:63], v[132:135]
    ds_read_b64_tr_b16 a[148:149], v100 offset:40960
    s_add_u32 s52, s52, 384
    v_mfma_f32_16x16x32_bf16 v[132:135], a[112:115], a[52:55], v[132:135]
    ds_read_b64_tr_b16 a[150:151], v100 offset:45056
    v_add_u32 v20, s52, v20
    v_mfma_f32_16x16x32_bf16 v[140:143], a[120:123], a[52:55], v[140:143]
    ds_read_b64_tr_b16 a[152:153], v101 offset:32768
    s_mov_b32 s28, s8
    v_mfma_f32_16x16x32_bf16 v[140:143], a[124:127], a[60:63], v[140:143]
    ds_read_b64_tr_b16 a[154:155], v101 offset:36864
    buffer_load_dwordx4 v12, s[56:59], s75 offen offset:2048  lds
    v_mfma_f32_16x16x32_bf16 v[136:139], a[124:127], a[56:59], v[136:139]
    ds_read_b64_tr_b16 a[156:157], v101 offset:40960
    s_mov_b32 s29, s89
    v_mfma_f32_16x16x32_bf16 v[136:139], a[120:123], a[48:51], v[136:139]
    ds_read_b64_tr_b16 a[158:159], v101 offset:45056
    s_mov_b32 s30, 2097152
    s_waitcnt vmcnt(15)
    v_pk_add_f32 v[192:193], v[192:193], v[208:209]
    v_pk_add_f32 v[194:195], v[194:195], v[210:211]
    v_pk_add_f32 v[196:197], v[196:197], v[212:213]
    v_pk_add_f32 v[198:199], v[198:199], v[214:215]
    v_pk_add_f32 v[200:201], v[200:201], v[216:217]
    v_pk_add_f32 v[202:203], v[202:203], v[218:219]
    v_pk_add_f32 v[204:205], v[204:205], v[220:221]
    v_pk_add_f32 v[206:207], v[206:207], v[222:223]
    v_pk_add_f32 v[192:193], v[192:193], v[200:201]
    v_pk_add_f32 v[194:195], v[194:195], v[202:203]
    v_pk_add_f32 v[196:197], v[196:197], v[204:205]
    v_pk_add_f32 v[198:199], v[198:199], v[206:207]
    v_pk_add_f32 v[192:193], v[192:193], v[196:197]
    v_pk_add_f32 v[194:195], v[194:195], v[198:199]
    v_cvt_pk_bf16_f32 v192, v192, v193
    v_cvt_pk_bf16_f32 v193, v194, v195
    s_and_b32 s76, s3, 1
    s_lshr_b32 s77, s3, 1
    s_lshl_b32 s76, s76, 10
    s_lshl_b32 s77, s77, 3
    s_add_u32 s76, s76, s77
    s_add_u32 s76, s76, 151552
    v_add_u32 v18, s76, v16
    ds_write_b64 v18, v[192:193]
    v_add_u32 v18, 151552, v16
    v_add_f32_dpp v224, v224, v224 quad_perm:[1,0,3,2] row_mask:0xf bank_mask:0xf
    v_add_f32_dpp v225, v225, v225 quad_perm:[1,0,3,2] row_mask:0xf bank_mask:0xf
    v_add_f32_dpp v226, v226, v226 quad_perm:[1,0,3,2] row_mask:0xf bank_mask:0xf
    v_add_f32_dpp v227, v227, v227 quad_perm:[1,0,3,2] row_mask:0xf bank_mask:0xf
    v_add_f32_dpp v224, v224, v224 quad_perm:[2,3,0,1] row_mask:0xf bank_mask:0xf
    v_add_f32_dpp v225, v225, v225 quad_perm:[2,3,0,1] row_mask:0xf bank_mask:0xf
    v_add_f32_dpp v226, v226, v226 quad_perm:[2,3,0,1] row_mask:0xf bank_mask:0xf
    v_add_f32_dpp v227, v227, v227 quad_perm:[2,3,0,1] row_mask:0xf bank_mask:0xf
    v_add_f32_dpp v224, v224, v224 row_half_mirror row_mask:0xf bank_mask:0xf
    v_add_f32_dpp v225, v225, v225 row_half_mirror row_mask:0xf bank_mask:0xf
    v_add_f32_dpp v226, v226, v226 row_half_mirror row_mask:0xf bank_mask:0xf
    v_add_f32_dpp v227, v227, v227 row_half_mirror row_mask:0xf bank_mask:0xf
    v_cvt_pk_bf16_f32 v224, v224, v225
    v_cvt_pk_bf16_f32 v225, v226, v227
    v_mov_b32 v200, v224
    v_mov_b32 v201, v225
    v_mov_b32 v202, v224
    v_mov_b32 v203, v225
    s_nop 1
    v_mov_b32_dpp v200, v224 row_ror:8 row_mask:0xf bank_mask:0xc
    v_mov_b32_dpp v201, v225 row_ror:8 row_mask:0xf bank_mask:0xc
    v_mov_b32_dpp v202, v224 row_ror:8 row_mask:0xf bank_mask:0x3
    v_mov_b32_dpp v203, v225 row_ror:8 row_mask:0xf bank_mask:0x3
    s_waitcnt lgkmcnt(0)
    s_waitcnt lgkmcnt(8)
    v_mfma_f32_16x16x32_bf16 v[144:147], a[128:131], a[48:51], v[144:147]
    ds_read_b64_tr_b16 a[160:161], v102 offset:32768
    buffer_load_dwordx4 a[100:103], v16, s[32:35], s64 offen offset:1024 sc1
    v_mfma_f32_16x16x32_bf16 v[144:147], a[132:135], a[56:59], v[144:147]
    ds_read_b64_tr_b16 a[162:163], v102 offset:36864
    s_mov_b32 s31, 0x00020000
    v_mfma_f32_16x16x32_bf16 v[148:151], a[132:135], a[60:63], v[148:151]
    ds_read_b64_tr_b16 a[164:165], v102 offset:40960
    s_mov_b32 s24, s18
    v_mfma_f32_16x16x32_bf16 v[148:151], a[128:131], a[52:55], v[148:151]
    ds_read_b64_tr_b16 a[166:167], v102 offset:45056
    s_and_b32 s25, s19, 0xffff
    v_mfma_f32_16x16x32_bf16 v[156:159], a[136:139], a[52:55], v[156:159]
    ds_read_b64_tr_b16 a[168:169], v103 offset:32768
    s_mov_b32 s26, 4194304
    v_mfma_f32_16x16x32_bf16 v[156:159], a[140:143], a[60:63], v[156:159]
    ds_read_b64_tr_b16 a[170:171], v103 offset:36864
    buffer_load_dwordx4 v13, s[56:59], s75 offen offset:3072  lds
    v_mfma_f32_16x16x32_bf16 v[152:155], a[140:143], a[56:59], v[152:155]
    ds_read_b64_tr_b16 a[172:173], v103 offset:40960
    s_add_u32 s75, s75, 131072
    s_mov_b32 s27, 0x00020000
    v_mfma_f32_16x16x32_bf16 v[152:155], a[136:139], a[48:51], v[152:155]
    ds_read_b64_tr_b16 a[174:175], v103 offset:45056
    s_waitcnt vmcnt(13) lgkmcnt(8)
    s_barrier
    v_mfma_f32_16x16x32_bf16 v[160:163], a[144:147], a[48:51], v[160:163]
    ds_read_b64_tr_b16 a[112:113], v96 offset:49152
    buffer_load_dwordx4 a[104:107], v16, s[32:35], s64 offen offset:2048 sc1
    v_mfma_f32_16x16x32_bf16 v[160:163], a[148:151], a[56:59], v[160:163]
    ds_read_b64_tr_b16 a[114:115], v96 offset:53248
    v_mfma_f32_16x16x32_bf16 v[164:167], a[148:151], a[60:63], v[164:167]
    ds_read_b64_tr_b16 a[116:117], v96 offset:57344
    v_mfma_f32_16x16x32_bf16 v[164:167], a[144:147], a[52:55], v[164:167]
    ds_read_b64_tr_b16 a[118:119], v96 offset:61440
    v_mfma_f32_16x16x32_bf16 v[172:175], a[152:155], a[52:55], v[172:175]
    ds_read_b64_tr_b16 a[120:121], v97 offset:49152
    s_add_u32 m0, s88, 81920
    v_mfma_f32_16x16x32_bf16 v[172:175], a[156:159], a[60:63], v[172:175]
    ds_read_b64_tr_b16 a[122:123], v97 offset:53248
    buffer_load_dwordx4 v10, s[56:59], s75 offen offset:0  lds
    v_mfma_f32_16x16x32_bf16 v[168:171], a[156:159], a[56:59], v[168:171]
    ds_read_b64_tr_b16 a[124:125], v97 offset:57344
    v_mfma_f32_16x16x32_bf16 v[168:171], a[152:155], a[48:51], v[168:171]
    ds_read_b64_tr_b16 a[126:127], v97 offset:61440
    s_waitcnt lgkmcnt(8)
    v_mfma_f32_16x16x32_bf16 v[176:179], a[160:163], a[48:51], v[176:179]
    ds_read_b64_tr_b16 a[128:129], v98 offset:49152
    buffer_load_dwordx4 a[108:111], v16, s[32:35], s64 offen offset:3072 sc1
    v_mfma_f32_16x16x32_bf16 v[176:179], a[164:167], a[56:59], v[176:179]
    ds_read_b64_tr_b16 a[130:131], v98 offset:53248
    v_mfma_f32_16x16x32_bf16 v[180:183], a[164:167], a[60:63], v[180:183]
    ds_read_b64_tr_b16 a[132:133], v98 offset:57344
    s_add_u32 s64, s64, 4096
    v_mfma_f32_16x16x32_bf16 v[180:183], a[160:163], a[52:55], v[180:183]
    ds_read_b64_tr_b16 a[134:135], v98 offset:61440
    v_mfma_f32_16x16x32_bf16 v[188:191], a[168:171], a[52:55], v[188:191]
    ds_read_b64_tr_b16 a[136:137], v99 offset:49152
    v_mfma_f32_16x16x32_bf16 v[188:191], a[172:175], a[60:63], v[188:191]
    ds_read_b64_tr_b16 a[138:139], v99 offset:53248
    buffer_load_dwordx4 v11, s[56:59], s75 offen offset:1024  lds
    v_mfma_f32_16x16x32_bf16 v[184:187], a[172:175], a[56:59], v[184:187]
    ds_read_b64_tr_b16 a[140:141], v99 offset:57344
    v_mfma_f32_16x16x32_bf16 v[184:187], a[168:171], a[48:51], v[184:187]
    ds_read_b64_tr_b16 a[142:143], v99 offset:61440
    s_waitcnt lgkmcnt(8)
    v_mfma_f32_16x16x32_bf16 v[128:131], a[112:115], a[64:67], v[128:131]
    ds_read_b64_tr_b16 a[144:145], v100 offset:49152
    buffer_load_dwordx4 a[0:3], v16, s[32:35], s64 offen offset:0 sc1
    v_mfma_f32_16x16x32_bf16 v[128:131], a[116:119], a[72:75], v[128:131]
    ds_read_b64_tr_b16 a[146:147], v100 offset:53248
    v_mfma_f32_16x16x32_bf16 v[132:135], a[116:119], a[76:79], v[132:135]
    ds_read_b64_tr_b16 a[148:149], v100 offset:57344
    v_mfma_f32_16x16x32_bf16 v[132:135], a[112:115], a[68:71], v[132:135]
    ds_read_b64_tr_b16 a[150:151], v100 offset:61440
    v_mfma_f32_16x16x32_bf16 v[140:143], a[120:123], a[68:71], v[140:143]
    ds_read_b64_tr_b16 a[152:153], v101 offset:49152
    v_mfma_f32_16x16x32_bf16 v[140:143], a[124:127], a[76:79], v[140:143]
    ds_read_b64_tr_b16 a[154:155], v101 offset:53248
    buffer_load_dwordx4 v12, s[56:59], s75 offen offset:2048  lds
    v_mfma_f32_16x16x32_bf16 v[136:139], a[124:127], a[72:75], v[136:139]
    ds_read_b64_tr_b16 a[156:157], v101 offset:57344
    v_mfma_f32_16x16x32_bf16 v[136:139], a[120:123], a[64:67], v[136:139]
    ds_read_b64_tr_b16 a[158:159], v101 offset:61440
    s_waitcnt lgkmcnt(8)
    v_mfma_f32_16x16x32_bf16 v[144:147], a[128:131], a[64:67], v[144:147]
    ds_read_b64_tr_b16 a[160:161], v102 offset:49152
    buffer_load_dwordx4 a[4:7], v16, s[32:35], s64 offen offset:1024 sc1
    v_mfma_f32_16x16x32_bf16 v[144:147], a[132:135], a[72:75], v[144:147]
    ds_read_b64_tr_b16 a[162:163], v102 offset:53248
    v_mfma_f32_16x16x32_bf16 v[148:151], a[132:135], a[76:79], v[148:151]
    ds_read_b64_tr_b16 a[164:165], v102 offset:57344
    v_mfma_f32_16x16x32_bf16 v[148:151], a[128:131], a[68:71], v[148:151]
    ds_read_b64_tr_b16 a[166:167], v102 offset:61440
    v_mfma_f32_16x16x32_bf16 v[156:159], a[136:139], a[68:71], v[156:159]
    ds_read_b64_tr_b16 a[168:169], v103 offset:49152
    v_mfma_f32_16x16x32_bf16 v[156:159], a[140:143], a[76:79], v[156:159]
    ds_read_b64_tr_b16 a[170:171], v103 offset:53248
    buffer_load_dwordx4 v13, s[56:59], s75 offen offset:3072  lds
    v_mfma_f32_16x16x32_bf16 v[152:155], a[140:143], a[72:75], v[152:155]
    ds_read_b64_tr_b16 a[172:173], v103 offset:57344
    s_add_u32 s75, s75, 131072
    v_mfma_f32_16x16x32_bf16 v[152:155], a[136:139], a[64:67], v[152:155]
    ds_read_b64_tr_b16 a[174:175], v103 offset:61440
    s_waitcnt vmcnt(13) lgkmcnt(8)
    s_barrier
    v_mfma_f32_16x16x32_bf16 v[160:163], a[144:147], a[64:67], v[160:163]
    ds_read_b64_tr_b16 a[112:113], v104 offset:0
    buffer_load_dwordx4 a[8:11], v16, s[32:35], s64 offen offset:2048 sc1
    v_mfma_f32_16x16x32_bf16 v[160:163], a[148:151], a[72:75], v[160:163]
    ds_read_b64_tr_b16 a[114:115], v104 offset:4096
    v_mfma_f32_16x16x32_bf16 v[164:167], a[148:151], a[76:79], v[164:167]
    ds_read_b64_tr_b16 a[116:117], v104 offset:8192
    v_mfma_f32_16x16x32_bf16 v[164:167], a[144:147], a[68:71], v[164:167]
    ds_read_b64_tr_b16 a[118:119], v104 offset:12288
    v_mfma_f32_16x16x32_bf16 v[172:175], a[152:155], a[68:71], v[172:175]
    ds_read_b64_tr_b16 a[120:121], v105 offset:0
    s_add_u32 m0, s88, 98304
    v_mfma_f32_16x16x32_bf16 v[172:175], a[156:159], a[76:79], v[172:175]
    ds_read_b64_tr_b16 a[122:123], v105 offset:4096
    buffer_load_dwordx4 v10, s[56:59], s75 offen offset:0  lds
    v_mfma_f32_16x16x32_bf16 v[168:171], a[156:159], a[72:75], v[168:171]
    ds_read_b64_tr_b16 a[124:125], v105 offset:8192
    v_mfma_f32_16x16x32_bf16 v[168:171], a[152:155], a[64:67], v[168:171]
    ds_read_b64_tr_b16 a[126:127], v105 offset:12288
    ds_read_b128 v[192:195], v18 offset:0
    ds_read_b128 v[196:199], v18 offset:1024
    s_waitcnt lgkmcnt(0)
    v_mfma_f32_16x16x32_bf16 v[208:211], v[192:195], v[24:27], 0
    v_mfma_f32_16x16x32_bf16 v[212:215], v[196:199], v[24:27], 0
    v_mfma_f32_16x16x32_bf16 v[216:219], v[200:203], v[24:27], 0
    v_mfma_f32_16x16x32_bf16 v[220:223], v[192:195], v[28:31], 0
    v_mfma_f32_16x16x32_bf16 v[224:227], v[196:199], v[28:31], 0
    v_mfma_f32_16x16x32_bf16 v[228:231], v[200:203], v[28:31], 0
    v_mfma_f32_16x16x32_bf16 v[232:235], v[192:195], v[32:35], 0
    v_mfma_f32_16x16x32_bf16 v[236:239], v[196:199], v[32:35], 0
    v_mfma_f32_16x16x32_bf16 v[240:243], v[200:203], v[32:35], 0
    v_mfma_f32_16x16x32_bf16 v[244:247], v[192:195], v[36:39], 0
    v_mfma_f32_16x16x32_bf16 v[248:251], v[196:199], v[36:39], 0
    v_mfma_f32_16x16x32_bf16 v[252:255], v[200:203], v[36:39], 0
    s_waitcnt lgkmcnt(8)
    v_mfma_f32_16x16x32_bf16 v[176:179], a[160:163], a[64:67], v[176:179]
    ds_read_b64_tr_b16 a[128:129], v106 offset:0
    buffer_load_dwordx4 a[12:15], v16, s[32:35], s64 offen offset:3072 sc1
    v_accvgpr_read_b32 v124, a82
    v_mfma_f32_16x16x32_bf16 v[176:179], a[164:167], a[72:75], v[176:179]
    ds_read_b64_tr_b16 a[130:131], v106 offset:4096
    v_accvgpr_read_b32 v125, a83
    v_mfma_f32_16x16x32_bf16 v[180:183], a[164:167], a[76:79], v[180:183]
    ds_read_b64_tr_b16 a[132:133], v106 offset:8192
    s_add_u32 s64, s64, 4096
    v_accvgpr_mov_b32 a82, a84
    v_mfma_f32_16x16x32_bf16 v[180:183], a[160:163], a[68:71], v[180:183]
    ds_read_b64_tr_b16 a[134:135], v106 offset:12288
    v_accvgpr_mov_b32 a83, a85
    v_mfma_f32_16x16x32_bf16 v[188:191], a[168:171], a[68:71], v[188:191]
    ds_read_b64_tr_b16 a[136:137], v107 offset:0
    v_accvgpr_write_b32 a84, v124
    v_mfma_f32_16x16x32_bf16 v[188:191], a[172:175], a[76:79], v[188:191]
    ds_read_b64_tr_b16 a[138:139], v107 offset:4096
    buffer_load_dwordx4 v11, s[56:59], s75 offen offset:1024  lds
    v_accvgpr_write_b32 a85, v125
    v_mfma_f32_16x16x32_bf16 v[184:187], a[172:175], a[72:75], v[184:187]
    ds_read_b64_tr_b16 a[140:141], v107 offset:8192
    v_mfma_f32_16x16x32_bf16 v[184:187], a[168:171], a[64:67], v[184:187]
    ds_read_b64_tr_b16 a[142:143], v107 offset:12288
    s_waitcnt lgkmcnt(8)
    v_mfma_f32_16x16x32_bf16 v[128:131], a[112:115], a[80:83], v[128:131]
    ds_read_b64_tr_b16 a[144:145], v108 offset:0
    buffer_load_dwordx4 a[16:19], v16, s[32:35], s64 offen offset:0 sc1
    v_mfma_f32_16x16x32_bf16 v[128:131], a[116:119], a[88:91], v[128:131]
    ds_read_b64_tr_b16 a[146:147], v108 offset:4096
    v_mfma_f32_16x16x32_bf16 v[132:135], a[116:119], a[92:95], v[132:135]
    ds_read_b64_tr_b16 a[148:149], v108 offset:8192
    v_mfma_f32_16x16x32_bf16 v[132:135], a[112:115], a[84:87], v[132:135]
    ds_read_b64_tr_b16 a[150:151], v108 offset:12288
    v_mfma_f32_16x16x32_bf16 v[140:143], a[120:123], a[84:87], v[140:143]
    ds_read_b64_tr_b16 a[152:153], v109 offset:0
    v_mfma_f32_16x16x32_bf16 v[140:143], a[124:127], a[92:95], v[140:143]
    ds_read_b64_tr_b16 a[154:155], v109 offset:4096
    buffer_load_dwordx4 v12, s[56:59], s75 offen offset:2048  lds
    v_mfma_f32_16x16x32_bf16 v[136:139], a[124:127], a[88:91], v[136:139]
    ds_read_b64_tr_b16 a[156:157], v109 offset:8192
    v_mfma_f32_16x16x32_bf16 v[136:139], a[120:123], a[80:83], v[136:139]
    ds_read_b64_tr_b16 a[158:159], v109 offset:12288
    v_add_f32 v216, 0x358637bd, v216
    v_rcp_f32 v216, v216
    s_nop 0
    v_mov_b32 v217, v216
    v_pk_mul_f32 v[208:209], v[208:209], v[216:217]
    v_pk_mul_f32 v[210:211], v[210:211], v[216:217]
    v_pk_mul_f32 v[212:213], v[212:213], v[216:217]
    v_pk_mul_f32 v[214:215], v[214:215], v[216:217]
    v_cvt_pk_bf16_f32 v208, v208, v209
    v_cvt_pk_bf16_f32 v209, v210, v211
    v_cvt_pk_bf16_f32 v210, v212, v213
    v_cvt_pk_bf16_f32 v211, v214, v215
    v_add_f32 v228, 0x358637bd, v228
    v_rcp_f32 v228, v228
    s_nop 0
    v_mov_b32 v229, v228
    v_pk_mul_f32 v[220:221], v[220:221], v[228:229]
    v_pk_mul_f32 v[222:223], v[222:223], v[228:229]
    v_pk_mul_f32 v[224:225], v[224:225], v[228:229]
    v_pk_mul_f32 v[226:227], v[226:227], v[228:229]
    v_cvt_pk_bf16_f32 v220, v220, v221
    v_cvt_pk_bf16_f32 v221, v222, v223
    v_cvt_pk_bf16_f32 v222, v224, v225
    v_cvt_pk_bf16_f32 v223, v226, v227
    v_add_f32 v240, 0x358637bd, v240
    v_rcp_f32 v240, v240
    s_nop 0
    v_mov_b32 v241, v240
    v_pk_mul_f32 v[232:233], v[232:233], v[240:241]
    v_pk_mul_f32 v[234:235], v[234:235], v[240:241]
    v_pk_mul_f32 v[236:237], v[236:237], v[240:241]
    v_pk_mul_f32 v[238:239], v[238:239], v[240:241]
    v_cvt_pk_bf16_f32 v232, v232, v233
    v_cvt_pk_bf16_f32 v233, v234, v235
    v_cvt_pk_bf16_f32 v234, v236, v237
    v_cvt_pk_bf16_f32 v235, v238, v239
    v_add_f32 v252, 0x358637bd, v252
    v_rcp_f32 v252, v252
    s_nop 0
    v_mov_b32 v253, v252
    v_pk_mul_f32 v[244:245], v[244:245], v[252:253]
    v_pk_mul_f32 v[246:247], v[246:247], v[252:253]
    v_pk_mul_f32 v[248:249], v[248:249], v[252:253]
    v_pk_mul_f32 v[250:251], v[250:251], v[252:253]
    v_cvt_pk_bf16_f32 v244, v244, v245
    v_cvt_pk_bf16_f32 v245, v246, v247
    v_cvt_pk_bf16_f32 v246, v248, v249
    v_cvt_pk_bf16_f32 v247, v250, v251
    s_waitcnt lgkmcnt(8)
    v_mfma_f32_16x16x32_bf16 v[144:147], a[128:131], a[80:83], v[144:147]
    ds_read_b64_tr_b16 a[160:161], v110 offset:0
    buffer_load_dwordx4 a[20:23], v16, s[32:35], s64 offen offset:1024 sc1
    v_mfma_f32_16x16x32_bf16 v[144:147], a[132:135], a[88:91], v[144:147]
    ds_read_b64_tr_b16 a[162:163], v110 offset:4096
    buffer_store_dwordx4 v[208:211], v16, s[40:43], s65 offen offset:0 sc1
    v_mfma_f32_16x16x32_bf16 v[148:151], a[132:135], a[92:95], v[148:151]
    ds_read_b64_tr_b16 a[164:165], v110 offset:8192
    v_mfma_f32_16x16x32_bf16 v[148:151], a[128:131], a[84:87], v[148:151]
    ds_read_b64_tr_b16 a[166:167], v110 offset:12288
    v_mfma_f32_16x16x32_bf16 v[156:159], a[136:139], a[84:87], v[156:159]
    ds_read_b64_tr_b16 a[168:169], v111 offset:0
    v_mfma_f32_16x16x32_bf16 v[156:159], a[140:143], a[92:95], v[156:159]
    ds_read_b64_tr_b16 a[170:171], v111 offset:4096
    buffer_load_dwordx4 v13, s[56:59], s75 offen offset:3072  lds
    v_mfma_f32_16x16x32_bf16 v[152:155], a[140:143], a[88:91], v[152:155]
    ds_read_b64_tr_b16 a[172:173], v111 offset:8192
    s_add_u32 s75, s75, 131072
    v_mfma_f32_16x16x32_bf16 v[152:155], a[136:139], a[80:83], v[152:155]
    ds_read_b64_tr_b16 a[174:175], v111 offset:12288
    buffer_store_dwordx4 v[220:223], v16, s[40:43], s65 offen offset:1024 sc1
    s_waitcnt vmcnt(15) lgkmcnt(8)
    s_barrier
    v_mfma_f32_16x16x32_bf16 v[160:163], a[144:147], a[80:83], v[160:163]
    ds_read_b64_tr_b16 a[112:113], v88 offset:0
    buffer_load_dwordx4 a[24:27], v16, s[32:35], s64 offen offset:2048 sc1
    v_mfma_f32_16x16x32_bf16 v[160:163], a[148:151], a[88:91], v[160:163]
    ds_read_b64_tr_b16 a[114:115], v88 offset:4096
    v_mfma_f32_16x16x32_bf16 v[164:167], a[148:151], a[92:95], v[164:167]
    ds_read_b64_tr_b16 a[116:117], v88 offset:8192
    v_mfma_f32_16x16x32_bf16 v[164:167], a[144:147], a[84:87], v[164:167]
    ds_read_b64_tr_b16 a[118:119], v88 offset:12288
    s_cmp_eq_u32 s3, 3
    s_cbranch_scc0 L_l212
    s_add_u32 s76, s70, 3145728
    buffer_load_dword v23, v17, s[56:59], s76 offen
L_l212:
    v_mfma_f32_16x16x32_bf16 v[172:175], a[152:155], a[84:87], v[172:175]
    ds_read_b64_tr_b16 a[120:121], v89 offset:0
    s_add_u32 m0, s88, 114688
    v_mfma_f32_16x16x32_bf16 v[172:175], a[156:159], a[92:95], v[172:175]
    ds_read_b64_tr_b16 a[122:123], v89 offset:4096
    buffer_load_dwordx4 v10, s[56:59], s75 offen offset:0  lds
    buffer_store_dwordx4 v[232:235], v16, s[40:43], s66 offen offset:0 sc1
    v_mfma_f32_16x16x32_bf16 v[168:171], a[156:159], a[88:91], v[168:171]
    ds_read_b64_tr_b16 a[124:125], v89 offset:8192
    v_mfma_f32_16x16x32_bf16 v[168:171], a[152:155], a[80:83], v[168:171]
    ds_read_b64_tr_b16 a[126:127], v89 offset:12288
    s_waitcnt lgkmcnt(8)
    v_mfma_f32_16x16x32_bf16 v[176:179], a[160:163], a[80:83], v[176:179]
    ds_read_b64_tr_b16 a[128:129], v90 offset:0
    buffer_load_dwordx4 a[28:31], v16, s[32:35], s64 offen offset:3072 sc1
    v_mfma_f32_16x16x32_bf16 v[176:179], a[164:167], a[88:91], v[176:179]
    ds_read_b64_tr_b16 a[130:131], v90 offset:4096
    v_mfma_f32_16x16x32_bf16 v[180:183], a[164:167], a[92:95], v[180:183]
    ds_read_b64_tr_b16 a[132:133], v90 offset:8192
    s_add_u32 s64, s64, 4096
    v_mfma_f32_16x16x32_bf16 v[180:183], a[160:163], a[84:87], v[180:183]
    ds_read_b64_tr_b16 a[134:135], v90 offset:12288
    buffer_store_dwordx4 v[244:247], v16, s[40:43], s66 offen offset:1024 sc1
    v_mfma_f32_16x16x32_bf16 v[188:191], a[168:171], a[84:87], v[188:191]
    ds_read_b64_tr_b16 a[136:137], v91 offset:0
    v_mfma_f32_16x16x32_bf16 v[188:191], a[172:175], a[92:95], v[188:191]
    ds_read_b64_tr_b16 a[138:139], v91 offset:4096
    buffer_load_dwordx4 v11, s[56:59], s75 offen offset:1024  lds
    v_mfma_f32_16x16x32_bf16 v[184:187], a[172:175], a[88:91], v[184:187]
    ds_read_b64_tr_b16 a[140:141], v91 offset:8192
    v_mfma_f32_16x16x32_bf16 v[184:187], a[168:171], a[80:83], v[184:187]
    ds_read_b64_tr_b16 a[142:143], v91 offset:12288
    s_waitcnt lgkmcnt(8)
    v_mfma_f32_16x16x32_bf16 v[128:131], a[112:115], a[96:99], v[128:131]
    ds_read_b64_tr_b16 a[144:145], v92 offset:0
    buffer_load_dwordx4 a[32:35], v16, s[32:35], s64 offen offset:0 sc1
    v_mfma_f32_16x16x32_bf16 v[128:131], a[116:119], a[104:107], v[128:131]
    ds_read_b64_tr_b16 a[146:147], v92 offset:4096
    v_mfma_f32_16x16x32_bf16 v[132:135], a[116:119], a[108:111], v[132:135]
    ds_read_b64_tr_b16 a[148:149], v92 offset:8192
    v_mfma_f32_16x16x32_bf16 v[132:135], a[112:115], a[100:103], v[132:135]
    ds_read_b64_tr_b16 a[150:151], v92 offset:12288
    v_mfma_f32_16x16x32_bf16 v[140:143], a[120:123], a[100:103], v[140:143]
    ds_read_b64_tr_b16 a[152:153], v93 offset:0
    v_mfma_f32_16x16x32_bf16 v[140:143], a[124:127], a[108:111], v[140:143]
    ds_read_b64_tr_b16 a[154:155], v93 offset:4096
    buffer_load_dwordx4 v12, s[56:59], s75 offen offset:2048  lds
    v_mfma_f32_16x16x32_bf16 v[136:139], a[124:127], a[104:107], v[136:139]
    ds_read_b64_tr_b16 a[156:157], v93 offset:8192
    v_mfma_f32_16x16x32_bf16 v[136:139], a[120:123], a[96:99], v[136:139]
    ds_read_b64_tr_b16 a[158:159], v93 offset:12288
    s_waitcnt lgkmcnt(8)
    v_mfma_f32_16x16x32_bf16 v[144:147], a[128:131], a[96:99], v[144:147]
    ds_read_b64_tr_b16 a[160:161], v94 offset:0
    buffer_load_dwordx4 a[36:39], v16, s[32:35], s64 offen offset:1024 sc1
    v_mfma_f32_16x16x32_bf16 v[144:147], a[132:135], a[104:107], v[144:147]
    ds_read_b64_tr_b16 a[162:163], v94 offset:4096
    v_mfma_f32_16x16x32_bf16 v[148:151], a[132:135], a[108:111], v[148:151]
    ds_read_b64_tr_b16 a[164:165], v94 offset:8192
    v_mfma_f32_16x16x32_bf16 v[148:151], a[128:131], a[100:103], v[148:151]
    ds_read_b64_tr_b16 a[166:167], v94 offset:12288
    v_mfma_f32_16x16x32_bf16 v[156:159], a[136:139], a[100:103], v[156:159]
    ds_read_b64_tr_b16 a[168:169], v95 offset:0
    v_mfma_f32_16x16x32_bf16 v[156:159], a[140:143], a[108:111], v[156:159]
    ds_read_b64_tr_b16 a[170:171], v95 offset:4096
    buffer_load_dwordx4 v13, s[56:59], s75 offen offset:3072  lds
    v_mfma_f32_16x16x32_bf16 v[152:155], a[140:143], a[104:107], v[152:155]
    ds_read_b64_tr_b16 a[172:173], v95 offset:8192
    s_add_u32 s75, s75, 131072
    v_mfma_f32_16x16x32_bf16 v[152:155], a[136:139], a[96:99], v[152:155]
    ds_read_b64_tr_b16 a[174:175], v95 offset:12288
    s_waitcnt vmcnt(17) lgkmcnt(8)
    s_barrier
    v_mfma_f32_16x16x32_bf16 v[160:163], a[144:147], a[96:99], v[160:163]
    ds_read_b64_tr_b16 a[112:113], v88 offset:16384
    buffer_load_dwordx4 a[40:43], v16, s[32:35], s64 offen offset:2048 sc1
    v_mfma_f32_16x16x32_bf16 v[160:163], a[148:151], a[104:107], v[160:163]
    ds_read_b64_tr_b16 a[114:115], v88 offset:20480
    v_mfma_f32_16x16x32_bf16 v[164:167], a[148:151], a[108:111], v[164:167]
    ds_read_b64_tr_b16 a[116:117], v88 offset:24576
    v_mfma_f32_16x16x32_bf16 v[164:167], a[144:147], a[100:103], v[164:167]
    ds_read_b64_tr_b16 a[118:119], v88 offset:28672
    v_mfma_f32_16x16x32_bf16 v[172:175], a[152:155], a[100:103], v[172:175]
    ds_read_b64_tr_b16 a[120:121], v89 offset:16384
    s_add_u32 m0, s88, 131072
    v_mfma_f32_16x16x32_bf16 v[172:175], a[156:159], a[108:111], v[172:175]
    ds_read_b64_tr_b16 a[122:123], v89 offset:20480
    buffer_load_dwordx4 v10, s[56:59], s75 offen offset:0  lds
    v_mfma_f32_16x16x32_bf16 v[168:171], a[156:159], a[104:107], v[168:171]
    ds_read_b64_tr_b16 a[124:125], v89 offset:24576
    v_mfma_f32_16x16x32_bf16 v[168:171], a[152:155], a[96:99], v[168:171]
    ds_read_b64_tr_b16 a[126:127], v89 offset:28672
    s_waitcnt lgkmcnt(8)
    v_mfma_f32_16x16x32_bf16 v[176:179], a[160:163], a[96:99], v[176:179]
    ds_read_b64_tr_b16 a[128:129], v90 offset:16384
    buffer_load_dwordx4 a[44:47], v16, s[32:35], s64 offen offset:3072 sc1
    v_mfma_f32_16x16x32_bf16 v[176:179], a[164:167], a[104:107], v[176:179]
    ds_read_b64_tr_b16 a[130:131], v90 offset:20480
    v_mfma_f32_16x16x32_bf16 v[180:183], a[164:167], a[108:111], v[180:183]
    ds_read_b64_tr_b16 a[132:133], v90 offset:24576
    s_add_u32 s64, s64, 4096
    v_mfma_f32_16x16x32_bf16 v[180:183], a[160:163], a[100:103], v[180:183]
    ds_read_b64_tr_b16 a[134:135], v90 offset:28672
    v_mfma_f32_16x16x32_bf16 v[188:191], a[168:171], a[100:103], v[188:191]
    ds_read_b64_tr_b16 a[136:137], v91 offset:16384
    v_mfma_f32_16x16x32_bf16 v[188:191], a[172:175], a[108:111], v[188:191]
    ds_read_b64_tr_b16 a[138:139], v91 offset:20480
    buffer_load_dwordx4 v11, s[56:59], s75 offen offset:1024  lds
    v_mfma_f32_16x16x32_bf16 v[184:187], a[172:175], a[104:107], v[184:187]
    ds_read_b64_tr_b16 a[140:141], v91 offset:24576
    v_mfma_f32_16x16x32_bf16 v[184:187], a[168:171], a[96:99], v[184:187]
    ds_read_b64_tr_b16 a[142:143], v91 offset:28672
    s_waitcnt lgkmcnt(8)
    v_mfma_f32_16x16x32_bf16 v[128:131], a[112:115], a[0:3], v[128:131]
    ds_read_b64_tr_b16 a[144:145], v92 offset:16384
    buffer_load_dwordx4 a[48:51], v16, s[32:35], s64 offen offset:0 sc1
    v_mfma_f32_16x16x32_bf16 v[128:131], a[116:119], a[8:11], v[128:131]
    ds_read_b64_tr_b16 a[146:147], v92 offset:20480
    v_mfma_f32_16x16x32_bf16 v[132:135], a[116:119], a[12:15], v[132:135]
    ds_read_b64_tr_b16 a[148:149], v92 offset:24576
    v_mfma_f32_16x16x32_bf16 v[132:135], a[112:115], a[4:7], v[132:135]
    ds_read_b64_tr_b16 a[150:151], v92 offset:28672
    v_mfma_f32_16x16x32_bf16 v[140:143], a[120:123], a[4:7], v[140:143]
    ds_read_b64_tr_b16 a[152:153], v93 offset:16384
    v_mfma_f32_16x16x32_bf16 v[140:143], a[124:127], a[12:15], v[140:143]
    ds_read_b64_tr_b16 a[154:155], v93 offset:20480
    buffer_load_dwordx4 v12, s[56:59], s75 offen offset:2048  lds
    v_mfma_f32_16x16x32_bf16 v[136:139], a[124:127], a[8:11], v[136:139]
    ds_read_b64_tr_b16 a[156:157], v93 offset:24576
    v_mfma_f32_16x16x32_bf16 v[136:139], a[120:123], a[0:3], v[136:139]
    ds_read_b64_tr_b16 a[158:159], v93 offset:28672
    s_waitcnt lgkmcnt(8)
    v_mfma_f32_16x16x32_bf16 v[144:147], a[128:131], a[0:3], v[144:147]
    ds_read_b64_tr_b16 a[160:161], v94 offset:16384
    buffer_load_dwordx4 a[52:55], v16, s[32:35], s64 offen offset:1024 sc1
    v_mfma_f32_16x16x32_bf16 v[144:147], a[132:135], a[8:11], v[144:147]
    ds_read_b64_tr_b16 a[162:163], v94 offset:20480
    v_mfma_f32_16x16x32_bf16 v[148:151], a[132:135], a[12:15], v[148:151]
    ds_read_b64_tr_b16 a[164:165], v94 offset:24576
    v_mfma_f32_16x16x32_bf16 v[148:151], a[128:131], a[4:7], v[148:151]
    ds_read_b64_tr_b16 a[166:167], v94 offset:28672
    v_mfma_f32_16x16x32_bf16 v[156:159], a[136:139], a[4:7], v[156:159]
    ds_read_b64_tr_b16 a[168:169], v95 offset:16384
    v_mfma_f32_16x16x32_bf16 v[156:159], a[140:143], a[12:15], v[156:159]
    ds_read_b64_tr_b16 a[170:171], v95 offset:20480
    buffer_load_dwordx4 v13, s[56:59], s75 offen offset:3072  lds
    v_mfma_f32_16x16x32_bf16 v[152:155], a[140:143], a[8:11], v[152:155]
    ds_read_b64_tr_b16 a[172:173], v95 offset:24576
    s_add_u32 s75, s75, 131072
    v_mfma_f32_16x16x32_bf16 v[152:155], a[136:139], a[0:3], v[152:155]
    ds_read_b64_tr_b16 a[174:175], v95 offset:28672
    s_waitcnt vmcnt(14) lgkmcnt(8)
    s_barrier
    v_mfma_f32_16x16x32_bf16 v[160:163], a[144:147], a[0:3], v[160:163]
    ds_read_b64_tr_b16 a[112:113], v96 offset:0
    buffer_load_dwordx4 a[56:59], v16, s[32:35], s64 offen offset:2048 sc1
    v_mfma_f32_16x16x32_bf16 v[160:163], a[148:151], a[8:11], v[160:163]
    ds_read_b64_tr_b16 a[114:115], v96 offset:4096
    v_mfma_f32_16x16x32_bf16 v[164:167], a[148:151], a[12:15], v[164:167]
    ds_read_b64_tr_b16 a[116:117], v96 offset:8192
    v_mfma_f32_16x16x32_bf16 v[164:167], a[144:147], a[4:7], v[164:167]
    ds_read_b64_tr_b16 a[118:119], v96 offset:12288
    v_mfma_f32_16x16x32_bf16 v[172:175], a[152:155], a[4:7], v[172:175]
    ds_read_b64_tr_b16 a[120:121], v97 offset:0
    s_add_u32 m0, s88, 0
    v_mfma_f32_16x16x32_bf16 v[172:175], a[156:159], a[12:15], v[172:175]
    ds_read_b64_tr_b16 a[122:123], v97 offset:4096
    buffer_load_dwordx4 v10, s[56:59], s75 offen offset:0  lds
    v_mfma_f32_16x16x32_bf16 v[168:171], a[156:159], a[8:11], v[168:171]
    ds_read_b64_tr_b16 a[124:125], v97 offset:8192
    v_mfma_f32_16x16x32_bf16 v[168:171], a[152:155], a[0:3], v[168:171]
    ds_read_b64_tr_b16 a[126:127], v97 offset:12288
    s_waitcnt lgkmcnt(8)
    v_mfma_f32_16x16x32_bf16 v[176:179], a[160:163], a[0:3], v[176:179]
    ds_read_b64_tr_b16 a[128:129], v98 offset:0
    buffer_load_dwordx4 a[60:63], v16, s[32:35], s64 offen offset:3072 sc1
    v_accvgpr_read_b32 v124, a26
    v_mfma_f32_16x16x32_bf16 v[176:179], a[164:167], a[8:11], v[176:179]
    ds_read_b64_tr_b16 a[130:131], v98 offset:4096
    v_accvgpr_read_b32 v125, a27
    v_mfma_f32_16x16x32_bf16 v[180:183], a[164:167], a[12:15], v[180:183]
    ds_read_b64_tr_b16 a[132:133], v98 offset:8192
    s_add_u32 s64, s64, 4096
    v_accvgpr_mov_b32 a26, a28
    v_mfma_f32_16x16x32_bf16 v[180:183], a[160:163], a[4:7], v[180:183]
    ds_read_b64_tr_b16 a[134:135], v98 offset:12288
    v_accvgpr_mov_b32 a27, a29
    v_mfma_f32_16x16x32_bf16 v[188:191], a[168:171], a[4:7], v[188:191]
    ds_read_b64_tr_b16 a[136:137], v99 offset:0
    v_accvgpr_write_b32 a28, v124
    v_mfma_f32_16x16x32_bf16 v[188:191], a[172:175], a[12:15], v[188:191]
    ds_read_b64_tr_b16 a[138:139], v99 offset:4096
    buffer_load_dwordx4 v11, s[56:59], s75 offen offset:1024  lds
    v_accvgpr_write_b32 a29, v125
    v_mfma_f32_16x16x32_bf16 v[184:187], a[172:175], a[8:11], v[184:187]
    ds_read_b64_tr_b16 a[140:141], v99 offset:8192
    v_mfma_f32_16x16x32_bf16 v[184:187], a[168:171], a[0:3], v[184:187]
    ds_read_b64_tr_b16 a[142:143], v99 offset:12288
    s_waitcnt lgkmcnt(8)
    v_mfma_f32_16x16x32_bf16 v[128:131], a[112:115], a[16:19], v[128:131]
    ds_read_b64_tr_b16 a[144:145], v100 offset:0
    buffer_load_dwordx4 a[64:67], v16, s[32:35], s64 offen offset:0 sc1
    v_mfma_f32_16x16x32_bf16 v[128:131], a[116:119], a[24:27], v[128:131]
    ds_read_b64_tr_b16 a[146:147], v100 offset:4096
    v_mfma_f32_16x16x32_bf16 v[132:135], a[116:119], a[28:31], v[132:135]
    ds_read_b64_tr_b16 a[148:149], v100 offset:8192
    v_mfma_f32_16x16x32_bf16 v[132:135], a[112:115], a[20:23], v[132:135]
    ds_read_b64_tr_b16 a[150:151], v100 offset:12288
    v_mfma_f32_16x16x32_bf16 v[140:143], a[120:123], a[20:23], v[140:143]
    ds_read_b64_tr_b16 a[152:153], v101 offset:0
    v_mfma_f32_16x16x32_bf16 v[140:143], a[124:127], a[28:31], v[140:143]
    ds_read_b64_tr_b16 a[154:155], v101 offset:4096
    buffer_load_dwordx4 v12, s[56:59], s75 offen offset:2048  lds
    v_mfma_f32_16x16x32_bf16 v[136:139], a[124:127], a[24:27], v[136:139]
    ds_read_b64_tr_b16 a[156:157], v101 offset:8192
    v_mfma_f32_16x16x32_bf16 v[136:139], a[120:123], a[16:19], v[136:139]
    ds_read_b64_tr_b16 a[158:159], v101 offset:12288
    s_waitcnt vmcnt(19)
    s_waitcnt lgkmcnt(8)
    v_mfma_f32_16x16x32_bf16 v[144:147], a[128:131], a[16:19], v[144:147]
    ds_read_b64_tr_b16 a[160:161], v102 offset:0
    buffer_load_dwordx4 a[68:71], v16, s[32:35], s64 offen offset:1024 sc1
    v_mfma_f32_16x16x32_bf16 v[144:147], a[132:135], a[24:27], v[144:147]
    ds_read_b64_tr_b16 a[162:163], v102 offset:4096
    v_mfma_f32_16x16x32_bf16 v[148:151], a[132:135], a[28:31], v[148:151]
    ds_read_b64_tr_b16 a[164:165], v102 offset:8192
    v_mfma_f32_16x16x32_bf16 v[148:151], a[128:131], a[20:23], v[148:151]
    ds_read_b64_tr_b16 a[166:167], v102 offset:12288
    v_mfma_f32_16x16x32_bf16 v[156:159], a[136:139], a[20:23], v[156:159]
    ds_read_b64_tr_b16 a[168:169], v103 offset:0
    v_mfma_f32_16x16x32_bf16 v[156:159], a[140:143], a[28:31], v[156:159]
    ds_read_b64_tr_b16 a[170:171], v103 offset:4096
    buffer_load_dwordx4 v13, s[56:59], s75 offen offset:3072  lds
    v_mfma_f32_16x16x32_bf16 v[152:155], a[140:143], a[24:27], v[152:155]
    ds_read_b64_tr_b16 a[172:173], v103 offset:8192
    s_add_u32 s75, s75, 131072
    v_mfma_f32_16x16x32_bf16 v[152:155], a[136:139], a[16:19], v[152:155]
    ds_read_b64_tr_b16 a[174:175], v103 offset:12288
    s_waitcnt vmcnt(13) lgkmcnt(8)
    s_barrier
    v_mfma_f32_16x16x32_bf16 v[160:163], a[144:147], a[16:19], v[160:163]
    ds_read_b64_tr_b16 a[112:113], v88 offset:32768
    buffer_load_dwordx4 a[72:75], v16, s[32:35], s64 offen offset:2048 sc1
    v_mfma_f32_16x16x32_bf16 v[160:163], a[148:151], a[24:27], v[160:163]
    ds_read_b64_tr_b16 a[114:115], v88 offset:36864
    v_mfma_f32_16x16x32_bf16 v[164:167], a[148:151], a[28:31], v[164:167]
    ds_read_b64_tr_b16 a[116:117], v88 offset:40960
    v_mfma_f32_16x16x32_bf16 v[164:167], a[144:147], a[20:23], v[164:167]
    ds_read_b64_tr_b16 a[118:119], v88 offset:45056
    v_mfma_f32_16x16x32_bf16 v[172:175], a[152:155], a[20:23], v[172:175]
    ds_read_b64_tr_b16 a[120:121], v89 offset:32768
    s_add_u32 m0, s88, 16384
    v_mfma_f32_16x16x32_bf16 v[172:175], a[156:159], a[28:31], v[172:175]
    ds_read_b64_tr_b16 a[122:123], v89 offset:36864
    buffer_load_dwordx4 v10, s[56:59], s75 offen offset:0  lds
    v_mfma_f32_16x16x32_bf16 v[168:171], a[156:159], a[24:27], v[168:171]
    ds_read_b64_tr_b16 a[124:125], v89 offset:40960
    v_mfma_f32_16x16x32_bf16 v[168:171], a[152:155], a[16:19], v[168:171]
    ds_read_b64_tr_b16 a[126:127], v89 offset:45056
    s_waitcnt lgkmcnt(8)
    v_mfma_f32_16x16x32_bf16 v[176:179], a[160:163], a[16:19], v[176:179]
    ds_read_b64_tr_b16 a[128:129], v90 offset:32768
    buffer_load_dwordx4 a[76:79], v16, s[32:35], s64 offen offset:3072 sc1
    v_mfma_f32_16x16x32_bf16 v[176:179], a[164:167], a[24:27], v[176:179]
    ds_read_b64_tr_b16 a[130:131], v90 offset:36864
    v_mfma_f32_16x16x32_bf16 v[180:183], a[164:167], a[28:31], v[180:183]
    ds_read_b64_tr_b16 a[132:133], v90 offset:40960
    s_add_u32 s64, s64, 4096
    v_mfma_f32_16x16x32_bf16 v[180:183], a[160:163], a[20:23], v[180:183]
    ds_read_b64_tr_b16 a[134:135], v90 offset:45056
    v_mfma_f32_16x16x32_bf16 v[188:191], a[168:171], a[20:23], v[188:191]
    ds_read_b64_tr_b16 a[136:137], v91 offset:32768
    v_mfma_f32_16x16x32_bf16 v[188:191], a[172:175], a[28:31], v[188:191]
    ds_read_b64_tr_b16 a[138:139], v91 offset:36864
    buffer_load_dwordx4 v11, s[56:59], s75 offen offset:1024  lds
    v_mfma_f32_16x16x32_bf16 v[184:187], a[172:175], a[24:27], v[184:187]
    ds_read_b64_tr_b16 a[140:141], v91 offset:40960
    v_mfma_f32_16x16x32_bf16 v[184:187], a[168:171], a[16:19], v[184:187]
    ds_read_b64_tr_b16 a[142:143], v91 offset:45056
    s_waitcnt lgkmcnt(8)
    v_mfma_f32_16x16x32_bf16 v[128:131], a[112:115], a[32:35], v[128:131]
    ds_read_b64_tr_b16 a[144:145], v92 offset:32768
    buffer_load_dwordx4 a[80:83], v16, s[32:35], s64 offen offset:0 sc1
    v_mfma_f32_16x16x32_bf16 v[128:131], a[116:119], a[40:43], v[128:131]
    ds_read_b64_tr_b16 a[146:147], v92 offset:36864
    v_mfma_f32_16x16x32_bf16 v[132:135], a[116:119], a[44:47], v[132:135]
    ds_read_b64_tr_b16 a[148:149], v92 offset:40960
    v_mfma_f32_16x16x32_bf16 v[132:135], a[112:115], a[36:39], v[132:135]
    ds_read_b64_tr_b16 a[150:151], v92 offset:45056
    v_mfma_f32_16x16x32_bf16 v[140:143], a[120:123], a[36:39], v[140:143]
    ds_read_b64_tr_b16 a[152:153], v93 offset:32768
    v_mfma_f32_16x16x32_bf16 v[140:143], a[124:127], a[44:47], v[140:143]
    ds_read_b64_tr_b16 a[154:155], v93 offset:36864
    buffer_load_dwordx4 v12, s[56:59], s75 offen offset:2048  lds
    v_mfma_f32_16x16x32_bf16 v[136:139], a[124:127], a[40:43], v[136:139]
    ds_read_b64_tr_b16 a[156:157], v93 offset:40960
    v_mfma_f32_16x16x32_bf16 v[136:139], a[120:123], a[32:35], v[136:139]
    ds_read_b64_tr_b16 a[158:159], v93 offset:45056
    s_cmp_eq_u32 s3, 0
    s_cbranch_scc0 L_sig3
    v_mov_b32 v76, s92
    v_mov_b32 v77, s93
    v_mov_b32 v78, s92
    v_mov_b32 v79, s93
    s_mov_b64 exec, 0xff
    buffer_store_dwordx4 v[76:79], v16, s[40:43], s86 offen sc0 sc1
    s_mov_b64 exec, -1
    s_nop 0
L_sig3:
    s_waitcnt lgkmcnt(8)
    v_mfma_f32_16x16x32_bf16 v[144:147], a[128:131], a[32:35], v[144:147]
    ds_read_b64_tr_b16 a[160:161], v94 offset:32768
    buffer_load_dwordx4 a[84:87], v16, s[32:35], s64 offen offset:1024 sc1
    v_mfma_f32_16x16x32_bf16 v[144:147], a[132:135], a[40:43], v[144:147]
    ds_read_b64_tr_b16 a[162:163], v94 offset:36864
    v_mfma_f32_16x16x32_bf16 v[148:151], a[132:135], a[44:47], v[148:151]
    ds_read_b64_tr_b16 a[164:165], v94 offset:40960
    v_mfma_f32_16x16x32_bf16 v[148:151], a[128:131], a[36:39], v[148:151]
    ds_read_b64_tr_b16 a[166:167], v94 offset:45056
    v_mfma_f32_16x16x32_bf16 v[156:159], a[136:139], a[36:39], v[156:159]
    ds_read_b64_tr_b16 a[168:169], v95 offset:32768
    v_mfma_f32_16x16x32_bf16 v[156:159], a[140:143], a[44:47], v[156:159]
    ds_read_b64_tr_b16 a[170:171], v95 offset:36864
    buffer_load_dwordx4 v13, s[56:59], s75 offen offset:3072  lds
    v_mfma_f32_16x16x32_bf16 v[152:155], a[140:143], a[40:43], v[152:155]
    ds_read_b64_tr_b16 a[172:173], v95 offset:40960
    s_add_u32 s75, s75, 131072
    v_mfma_f32_16x16x32_bf16 v[152:155], a[136:139], a[32:35], v[152:155]
    ds_read_b64_tr_b16 a[174:175], v95 offset:45056
    s_waitcnt vmcnt(13) lgkmcnt(8)
    s_barrier
    v_mfma_f32_16x16x32_bf16 v[160:163], a[144:147], a[32:35], v[160:163]
    ds_read_b64_tr_b16 a[112:113], v88 offset:49152
    buffer_load_dwordx4 a[88:91], v16, s[32:35], s64 offen offset:2048 sc1
    v_mfma_f32_16x16x32_bf16 v[160:163], a[148:151], a[40:43], v[160:163]
    ds_read_b64_tr_b16 a[114:115], v88 offset:53248
    v_mfma_f32_16x16x32_bf16 v[164:167], a[148:151], a[44:47], v[164:167]
    ds_read_b64_tr_b16 a[116:117], v88 offset:57344
    v_mfma_f32_16x16x32_bf16 v[164:167], a[144:147], a[36:39], v[164:167]
    ds_read_b64_tr_b16 a[118:119], v88 offset:61440
    s_cmp_eq_u32 s3, 0
    s_cbranch_scc0 L_l2s0
    s_mov_b32 s76, 0
    buffer_load_dword v23, v20, s[28:31], s76 offen
L_l2s0:
    v_mfma_f32_16x16x32_bf16 v[172:175], a[152:155], a[36:39], v[172:175]
    ds_read_b64_tr_b16 a[120:121], v89 offset:49152
    s_add_u32 m0, s88, 65536
    v_mfma_f32_16x16x32_bf16 v[172:175], a[156:159], a[44:47], v[172:175]
    ds_read_b64_tr_b16 a[122:123], v89 offset:53248
    buffer_load_dwordx4 v10, s[56:59], s75 offen offset:0  lds
    v_mfma_f32_16x16x32_bf16 v[168:171], a[156:159], a[40:43], v[168:171]
    ds_read_b64_tr_b16 a[124:125], v89 offset:57344
    v_mfma_f32_16x16x32_bf16 v[168:171], a[152:155], a[32:35], v[168:171]
    ds_read_b64_tr_b16 a[126:127], v89 offset:61440
    s_waitcnt lgkmcnt(8)
    v_mfma_f32_16x16x32_bf16 v[176:179], a[160:163], a[32:35], v[176:179]
    ds_read_b64_tr_b16 a[128:129], v90 offset:49152
    buffer_load_dwordx4 a[92:95], v16, s[32:35], s64 offen offset:3072 sc1
    v_mfma_f32_16x16x32_bf16 v[176:179], a[164:167], a[40:43], v[176:179]
    ds_read_b64_tr_b16 a[130:131], v90 offset:53248
    v_mfma_f32_16x16x32_bf16 v[180:183], a[164:167], a[44:47], v[180:183]
    ds_read_b64_tr_b16 a[132:133], v90 offset:57344
    s_add_u32 s64, s64, 4096
    v_mfma_f32_16x16x32_bf16 v[180:183], a[160:163], a[36:39], v[180:183]
    ds_read_b64_tr_b16 a[134:135], v90 offset:61440
    v_mfma_f32_16x16x32_bf16 v[188:191], a[168:171], a[36:39], v[188:191]
    ds_read_b64_tr_b16 a[136:137], v91 offset:49152
    v_mfma_f32_16x16x32_bf16 v[188:191], a[172:175], a[44:47], v[188:191]
    ds_read_b64_tr_b16 a[138:139], v91 offset:53248
    buffer_load_dwordx4 v11, s[56:59], s75 offen offset:1024  lds
    v_mfma_f32_16x16x32_bf16 v[184:187], a[172:175], a[40:43], v[184:187]
    ds_read_b64_tr_b16 a[140:141], v91 offset:57344
    v_mfma_f32_16x16x32_bf16 v[184:187], a[168:171], a[32:35], v[184:187]
    ds_read_b64_tr_b16 a[142:143], v91 offset:61440
    s_waitcnt lgkmcnt(8)
    v_mfma_f32_16x16x32_bf16 v[128:131], a[112:115], a[48:51], v[128:131]
    ds_read_b64_tr_b16 a[144:145], v92 offset:49152
    buffer_load_dwordx4 a[96:99], v16, s[32:35], s64 offen offset:0 sc1
    v_mfma_f32_16x16x32_bf16 v[128:131], a[116:119], a[56:59], v[128:131]
    ds_read_b64_tr_b16 a[146:147], v92 offset:53248
    v_mfma_f32_16x16x32_bf16 v[132:135], a[116:119], a[60:63], v[132:135]
    ds_read_b64_tr_b16 a[148:149], v92 offset:57344
    v_mfma_f32_16x16x32_bf16 v[132:135], a[112:115], a[52:55], v[132:135]
    ds_read_b64_tr_b16 a[150:151], v92 offset:61440
    v_mfma_f32_16x16x32_bf16 v[140:143], a[120:123], a[52:55], v[140:143]
    ds_read_b64_tr_b16 a[152:153], v93 offset:49152
    v_mfma_f32_16x16x32_bf16 v[140:143], a[124:127], a[60:63], v[140:143]
    ds_read_b64_tr_b16 a[154:155], v93 offset:53248
    buffer_load_dwordx4 v12, s[56:59], s75 offen offset:2048  lds
    v_mfma_f32_16x16x32_bf16 v[136:139], a[124:127], a[56:59], v[136:139]
    ds_read_b64_tr_b16 a[156:157], v93 offset:57344
    v_mfma_f32_16x16x32_bf16 v[136:139], a[120:123], a[48:51], v[136:139]
    ds_read_b64_tr_b16 a[158:159], v93 offset:61440
    s_waitcnt lgkmcnt(8)
    v_mfma_f32_16x16x32_bf16 v[144:147], a[128:131], a[48:51], v[144:147]
    ds_read_b64_tr_b16 a[160:161], v94 offset:49152
    buffer_load_dwordx4 a[100:103], v16, s[32:35], s64 offen offset:1024 sc1
    v_mfma_f32_16x16x32_bf16 v[144:147], a[132:135], a[56:59], v[144:147]
    ds_read_b64_tr_b16 a[162:163], v94 offset:53248
    v_mfma_f32_16x16x32_bf16 v[148:151], a[132:135], a[60:63], v[148:151]
    ds_read_b64_tr_b16 a[164:165], v94 offset:57344
    v_mfma_f32_16x16x32_bf16 v[148:151], a[128:131], a[52:55], v[148:151]
    ds_read_b64_tr_b16 a[166:167], v94 offset:61440
    v_mfma_f32_16x16x32_bf16 v[156:159], a[136:139], a[52:55], v[156:159]
    ds_read_b64_tr_b16 a[168:169], v95 offset:49152
    v_mfma_f32_16x16x32_bf16 v[156:159], a[140:143], a[60:63], v[156:159]
    ds_read_b64_tr_b16 a[170:171], v95 offset:53248
    buffer_load_dwordx4 v13, s[56:59], s75 offen offset:3072  lds
    v_mfma_f32_16x16x32_bf16 v[152:155], a[140:143], a[56:59], v[152:155]
    ds_read_b64_tr_b16 a[172:173], v95 offset:57344
    s_add_u32 s75, s75, 131072
    v_mfma_f32_16x16x32_bf16 v[152:155], a[136:139], a[48:51], v[152:155]
    ds_read_b64_tr_b16 a[174:175], v95 offset:61440
    s_waitcnt vmcnt(13) lgkmcnt(8)
    s_barrier
    v_mfma_f32_16x16x32_bf16 v[160:163], a[144:147], a[48:51], v[160:163]
    ds_read_b64_tr_b16 a[112:113], v96 offset:16384
    buffer_load_dwordx4 a[104:107], v16, s[32:35], s64 offen offset:2048 sc1
    v_mfma_f32_16x16x32_bf16 v[160:163], a[148:151], a[56:59], v[160:163]
    ds_read_b64_tr_b16 a[114:115], v96 offset:20480
    v_mfma_f32_16x16x32_bf16 v[164:167], a[148:151], a[60:63], v[164:167]
    ds_read_b64_tr_b16 a[116:117], v96 offset:24576
    v_mfma_f32_16x16x32_bf16 v[164:167], a[144:147], a[52:55], v[164:167]
    ds_read_b64_tr_b16 a[118:119], v96 offset:28672
    v_mfma_f32_16x16x32_bf16 v[172:175], a[152:155], a[52:55], v[172:175]
    ds_read_b64_tr_b16 a[120:121], v97 offset:16384
    s_add_u32 m0, s88, 32768
    v_mfma_f32_16x16x32_bf16 v[172:175], a[156:159], a[60:63], v[172:175]
    ds_read_b64_tr_b16 a[122:123], v97 offset:20480
    buffer_load_dwordx4 v10, s[56:59], s75 offen offset:0  lds
    v_mfma_f32_16x16x32_bf16 v[168:171], a[156:159], a[56:59], v[168:171]
    ds_read_b64_tr_b16 a[124:125], v97 offset:24576
    v_mfma_f32_16x16x32_bf16 v[168:171], a[152:155], a[48:51], v[168:171]
    ds_read_b64_tr_b16 a[126:127], v97 offset:28672
    s_waitcnt lgkmcnt(8)
    v_mfma_f32_16x16x32_bf16 v[176:179], a[160:163], a[48:51], v[176:179]
    ds_read_b64_tr_b16 a[128:129], v98 offset:16384
    buffer_load_dwordx4 a[108:111], v16, s[32:35], s64 offen offset:3072 sc1
    v_mfma_f32_16x16x32_bf16 v[176:179], a[164:167], a[56:59], v[176:179]
    ds_read_b64_tr_b16 a[130:131], v98 offset:20480
    v_mfma_f32_16x16x32_bf16 v[180:183], a[164:167], a[60:63], v[180:183]
    ds_read_b64_tr_b16 a[132:133], v98 offset:24576
    s_add_u32 s64, s64, 4096
    v_mfma_f32_16x16x32_bf16 v[180:183], a[160:163], a[52:55], v[180:183]
    ds_read_b64_tr_b16 a[134:135], v98 offset:28672
    v_mfma_f32_16x16x32_bf16 v[188:191], a[168:171], a[52:55], v[188:191]
    ds_read_b64_tr_b16 a[136:137], v99 offset:16384
    v_mfma_f32_16x16x32_bf16 v[188:191], a[172:175], a[60:63], v[188:191]
    ds_read_b64_tr_b16 a[138:139], v99 offset:20480
    buffer_load_dwordx4 v11, s[56:59], s75 offen offset:1024  lds
    v_mfma_f32_16x16x32_bf16 v[184:187], a[172:175], a[56:59], v[184:187]
    ds_read_b64_tr_b16 a[140:141], v99 offset:24576
    v_mfma_f32_16x16x32_bf16 v[184:187], a[168:171], a[48:51], v[184:187]
    ds_read_b64_tr_b16 a[142:143], v99 offset:28672
    s_waitcnt lgkmcnt(8)
    v_mfma_f32_16x16x32_bf16 v[128:131], a[112:115], a[64:67], v[128:131]
    ds_read_b64_tr_b16 a[144:145], v100 offset:16384
    buffer_load_dwordx4 a[0:3], v16, s[32:35], s64 offen offset:0 sc1
    v_mfma_f32_16x16x32_bf16 v[128:131], a[116:119], a[72:75], v[128:131]
    ds_read_b64_tr_b16 a[146:147], v100 offset:20480
    v_mfma_f32_16x16x32_bf16 v[132:135], a[116:119], a[76:79], v[132:135]
    ds_read_b64_tr_b16 a[148:149], v100 offset:24576
    v_mfma_f32_16x16x32_bf16 v[132:135], a[112:115], a[68:71], v[132:135]
    ds_read_b64_tr_b16 a[150:151], v100 offset:28672
    v_mfma_f32_16x16x32_bf16 v[140:143], a[120:123], a[68:71], v[140:143]
    ds_read_b64_tr_b16 a[152:153], v101 offset:16384
    v_mfma_f32_16x16x32_bf16 v[140:143], a[124:127], a[76:79], v[140:143]
    ds_read_b64_tr_b16 a[154:155], v101 offset:20480
    buffer_load_dwordx4 v12, s[56:59], s75 offen offset:2048  lds
    v_mfma_f32_16x16x32_bf16 v[136:139], a[124:127], a[72:75], v[136:139]
    ds_read_b64_tr_b16 a[156:157], v101 offset:24576
    v_mfma_f32_16x16x32_bf16 v[136:139], a[120:123], a[64:67], v[136:139]
    ds_read_b64_tr_b16 a[158:159], v101 offset:28672
    s_waitcnt lgkmcnt(8)
    v_mfma_f32_16x16x32_bf16 v[144:147], a[128:131], a[64:67], v[144:147]
    ds_read_b64_tr_b16 a[160:161], v102 offset:16384
    buffer_load_dwordx4 a[4:7], v16, s[32:35], s64 offen offset:1024 sc1
    v_mfma_f32_16x16x32_bf16 v[144:147], a[132:135], a[72:75], v[144:147]
    ds_read_b64_tr_b16 a[162:163], v102 offset:20480
    v_mfma_f32_16x16x32_bf16 v[148:151], a[132:135], a[76:79], v[148:151]
    ds_read_b64_tr_b16 a[164:165], v102 offset:24576
    v_mfma_f32_16x16x32_bf16 v[148:151], a[128:131], a[68:71], v[148:151]
    ds_read_b64_tr_b16 a[166:167], v102 offset:28672
    v_mfma_f32_16x16x32_bf16 v[156:159], a[136:139], a[68:71], v[156:159]
    ds_read_b64_tr_b16 a[168:169], v103 offset:16384
    v_mfma_f32_16x16x32_bf16 v[156:159], a[140:143], a[76:79], v[156:159]
    ds_read_b64_tr_b16 a[170:171], v103 offset:20480
    buffer_load_dwordx4 v13, s[56:59], s75 offen offset:3072  lds
    v_mfma_f32_16x16x32_bf16 v[152:155], a[140:143], a[72:75], v[152:155]
    ds_read_b64_tr_b16 a[172:173], v103 offset:24576
    s_add_u32 s75, s75, 131072
    v_mfma_f32_16x16x32_bf16 v[152:155], a[136:139], a[64:67], v[152:155]
    ds_read_b64_tr_b16 a[174:175], v103 offset:28672
    s_waitcnt vmcnt(13) lgkmcnt(8)
    s_barrier
    v_mfma_f32_16x16x32_bf16 v[160:163], a[144:147], a[64:67], v[160:163]
    ds_read_b64_tr_b16 a[112:113], v96 offset:32768
    buffer_load_dwordx4 a[8:11], v16, s[32:35], s64 offen offset:2048 sc1
    v_mfma_f32_16x16x32_bf16 v[160:163], a[148:151], a[72:75], v[160:163]
    ds_read_b64_tr_b16 a[114:115], v96 offset:36864
    v_mfma_f32_16x16x32_bf16 v[164:167], a[148:151], a[76:79], v[164:167]
    ds_read_b64_tr_b16 a[116:117], v96 offset:40960
    v_mfma_f32_16x16x32_bf16 v[164:167], a[144:147], a[68:71], v[164:167]
    ds_read_b64_tr_b16 a[118:119], v96 offset:45056
    v_mfma_f32_16x16x32_bf16 v[172:175], a[152:155], a[68:71], v[172:175]
    ds_read_b64_tr_b16 a[120:121], v97 offset:32768
    s_add_u32 m0, s88, 49152
    v_mfma_f32_16x16x32_bf16 v[172:175], a[156:159], a[76:79], v[172:175]
    ds_read_b64_tr_b16 a[122:123], v97 offset:36864
    buffer_load_dwordx4 v10, s[56:59], s75 offen offset:0  lds
    v_mfma_f32_16x16x32_bf16 v[168:171], a[156:159], a[72:75], v[168:171]
    ds_read_b64_tr_b16 a[124:125], v97 offset:40960
    v_mfma_f32_16x16x32_bf16 v[168:171], a[152:155], a[64:67], v[168:171]
    ds_read_b64_tr_b16 a[126:127], v97 offset:45056
    s_waitcnt lgkmcnt(8)
    v_mfma_f32_16x16x32_bf16 v[176:179], a[160:163], a[64:67], v[176:179]
    ds_read_b64_tr_b16 a[128:129], v98 offset:32768
    buffer_load_dwordx4 a[12:15], v16, s[32:35], s64 offen offset:3072 sc1
    v_accvgpr_read_b32 v124, a82
    v_mfma_f32_16x16x32_bf16 v[176:179], a[164:167], a[72:75], v[176:179]
    ds_read_b64_tr_b16 a[130:131], v98 offset:36864
    v_accvgpr_read_b32 v125, a83
    v_mfma_f32_16x16x32_bf16 v[180:183], a[164:167], a[76:79], v[180:183]
    ds_read_b64_tr_b16 a[132:133], v98 offset:40960
    s_add_u32 s64, s64, 4096
    v_accvgpr_mov_b32 a82, a84
    v_mfma_f32_16x16x32_bf16 v[180:183], a[160:163], a[68:71], v[180:183]
    ds_read_b64_tr_b16 a[134:135], v98 offset:45056
    v_accvgpr_mov_b32 a83, a85
    v_mfma_f32_16x16x32_bf16 v[188:191], a[168:171], a[68:71], v[188:191]
    ds_read_b64_tr_b16 a[136:137], v99 offset:32768
    v_accvgpr_write_b32 a84, v124
    v_mfma_f32_16x16x32_bf16 v[188:191], a[172:175], a[76:79], v[188:191]
    ds_read_b64_tr_b16 a[138:139], v99 offset:36864
    buffer_load_dwordx4 v11, s[56:59], s75 offen offset:1024  lds
    v_accvgpr_write_b32 a85, v125
    v_mfma_f32_16x16x32_bf16 v[184:187], a[172:175], a[72:75], v[184:187]
    ds_read_b64_tr_b16 a[140:141], v99 offset:40960
    v_mfma_f32_16x16x32_bf16 v[184:187], a[168:171], a[64:67], v[184:187]
    ds_read_b64_tr_b16 a[142:143], v99 offset:45056
    s_waitcnt lgkmcnt(8)
    v_mfma_f32_16x16x32_bf16 v[128:131], a[112:115], a[80:83], v[128:131]
    ds_read_b64_tr_b16 a[144:145], v100 offset:32768
    buffer_load_dwordx4 a[16:19], v16, s[32:35], s64 offen offset:0 sc1
    v_mfma_f32_16x16x32_bf16 v[128:131], a[116:119], a[88:91], v[128:131]
    ds_read_b64_tr_b16 a[146:147], v100 offset:36864
    v_mfma_f32_16x16x32_bf16 v[132:135], a[116:119], a[92:95], v[132:135]
    ds_read_b64_tr_b16 a[148:149], v100 offset:40960
    v_mfma_f32_16x16x32_bf16 v[132:135], a[112:115], a[84:87], v[132:135]
    ds_read_b64_tr_b16 a[150:151], v100 offset:45056
    v_mfma_f32_16x16x32_bf16 v[140:143], a[120:123], a[84:87], v[140:143]
    ds_read_b64_tr_b16 a[152:153], v101 offset:32768
    v_mfma_f32_16x16x32_bf16 v[140:143], a[124:127], a[92:95], v[140:143]
    ds_read_b64_tr_b16 a[154:155], v101 offset:36864
    buffer_load_dwordx4 v12, s[56:59], s75 offen offset:2048  lds
    v_mfma_f32_16x16x32_bf16 v[136:139], a[124:127], a[88:91], v[136:139]
    ds_read_b64_tr_b16 a[156:157], v101 offset:40960
    v_mfma_f32_16x16x32_bf16 v[136:139], a[120:123], a[80:83], v[136:139]
    ds_read_b64_tr_b16 a[158:159], v101 offset:45056
    s_waitcnt lgkmcnt(8)
    v_mfma_f32_16x16x32_bf16 v[144:147], a[128:131], a[80:83], v[144:147]
    ds_read_b64_tr_b16 a[160:161], v102 offset:32768
    buffer_load_dwordx4 a[20:23], v16, s[32:35], s64 offen offset:1024 sc1
    v_mfma_f32_16x16x32_bf16 v[144:147], a[132:135], a[88:91], v[144:147]
    ds_read_b64_tr_b16 a[162:163], v102 offset:36864
    v_mfma_f32_16x16x32_bf16 v[148:151], a[132:135], a[92:95], v[148:151]
    ds_read_b64_tr_b16 a[164:165], v102 offset:40960
    v_mfma_f32_16x16x32_bf16 v[148:151], a[128:131], a[84:87], v[148:151]
    ds_read_b64_tr_b16 a[166:167], v102 offset:45056
    v_mfma_f32_16x16x32_bf16 v[156:159], a[136:139], a[84:87], v[156:159]
    ds_read_b64_tr_b16 a[168:169], v103 offset:32768
    v_mfma_f32_16x16x32_bf16 v[156:159], a[140:143], a[92:95], v[156:159]
    ds_read_b64_tr_b16 a[170:171], v103 offset:36864
    buffer_load_dwordx4 v13, s[56:59], s75 offen offset:3072  lds
    v_mfma_f32_16x16x32_bf16 v[152:155], a[140:143], a[88:91], v[152:155]
    ds_read_b64_tr_b16 a[172:173], v103 offset:40960
    s_add_u32 s75, s75, 131072
    v_mfma_f32_16x16x32_bf16 v[152:155], a[136:139], a[80:83], v[152:155]
    ds_read_b64_tr_b16 a[174:175], v103 offset:45056
    s_waitcnt vmcnt(13) lgkmcnt(8)
    s_barrier
    v_mfma_f32_16x16x32_bf16 v[160:163], a[144:147], a[80:83], v[160:163]
    ds_read_b64_tr_b16 a[112:113], v96 offset:49152
    buffer_load_dwordx4 a[24:27], v16, s[32:35], s64 offen offset:2048 sc1
    v_mfma_f32_16x16x32_bf16 v[160:163], a[148:151], a[88:91], v[160:163]
    ds_read_b64_tr_b16 a[114:115], v96 offset:53248
    v_mfma_f32_16x16x32_bf16 v[164:167], a[148:151], a[92:95], v[164:167]
    ds_read_b64_tr_b16 a[116:117], v96 offset:57344
    v_mfma_f32_16x16x32_bf16 v[164:167], a[144:147], a[84:87], v[164:167]
    ds_read_b64_tr_b16 a[118:119], v96 offset:61440
    v_mfma_f32_16x16x32_bf16 v[172:175], a[152:155], a[84:87], v[172:175]
    ds_read_b64_tr_b16 a[120:121], v97 offset:49152
    s_add_u32 m0, s88, 81920
    v_mfma_f32_16x16x32_bf16 v[172:175], a[156:159], a[92:95], v[172:175]
    ds_read_b64_tr_b16 a[122:123], v97 offset:53248
    buffer_load_dwordx4 v10, s[56:59], s75 offen offset:0  lds
    v_mfma_f32_16x16x32_bf16 v[168:171], a[156:159], a[88:91], v[168:171]
    ds_read_b64_tr_b16 a[124:125], v97 offset:57344
    v_mfma_f32_16x16x32_bf16 v[168:171], a[152:155], a[80:83], v[168:171]
    ds_read_b64_tr_b16 a[126:127], v97 offset:61440
    s_waitcnt lgkmcnt(8)
    v_mfma_f32_16x16x32_bf16 v[176:179], a[160:163], a[80:83], v[176:179]
    ds_read_b64_tr_b16 a[128:129], v98 offset:49152
    buffer_load_dwordx4 a[28:31], v16, s[32:35], s64 offen offset:3072 sc1
    v_mfma_f32_16x16x32_bf16 v[176:179], a[164:167], a[88:91], v[176:179]
    ds_read_b64_tr_b16 a[130:131], v98 offset:53248
    v_mfma_f32_16x16x32_bf16 v[180:183], a[164:167], a[92:95], v[180:183]
    ds_read_b64_tr_b16 a[132:133], v98 offset:57344
    s_add_u32 s64, s64, 4096
    v_mfma_f32_16x16x32_bf16 v[180:183], a[160:163], a[84:87], v[180:183]
    ds_read_b64_tr_b16 a[134:135], v98 offset:61440
    v_mfma_f32_16x16x32_bf16 v[188:191], a[168:171], a[84:87], v[188:191]
    ds_read_b64_tr_b16 a[136:137], v99 offset:49152
    v_mfma_f32_16x16x32_bf16 v[188:191], a[172:175], a[92:95], v[188:191]
    ds_read_b64_tr_b16 a[138:139], v99 offset:53248
    buffer_load_dwordx4 v11, s[56:59], s75 offen offset:1024  lds
    v_mfma_f32_16x16x32_bf16 v[184:187], a[172:175], a[88:91], v[184:187]
    ds_read_b64_tr_b16 a[140:141], v99 offset:57344
    v_mfma_f32_16x16x32_bf16 v[184:187], a[168:171], a[80:83], v[184:187]
    ds_read_b64_tr_b16 a[142:143], v99 offset:61440
    s_waitcnt lgkmcnt(8)
    v_mfma_f32_16x16x32_bf16 v[128:131], a[112:115], a[96:99], v[128:131]
    ds_read_b64_tr_b16 a[144:145], v100 offset:49152
    buffer_load_dwordx4 a[32:35], v16, s[32:35], s64 offen offset:0 sc1
    v_mfma_f32_16x16x32_bf16 v[128:131], a[116:119], a[104:107], v[128:131]
    ds_read_b64_tr_b16 a[146:147], v100 offset:53248
    v_mfma_f32_16x16x32_bf16 v[132:135], a[116:119], a[108:111], v[132:135]
    ds_read_b64_tr_b16 a[148:149], v100 offset:57344
    v_mfma_f32_16x16x32_bf16 v[132:135], a[112:115], a[100:103], v[132:135]
    ds_read_b64_tr_b16 a[150:151], v100 offset:61440
    v_mfma_f32_16x16x32_bf16 v[140:143], a[120:123], a[100:103], v[140:143]
    ds_read_b64_tr_b16 a[152:153], v101 offset:49152
    v_mfma_f32_16x16x32_bf16 v[140:143], a[124:127], a[108:111], v[140:143]
    ds_read_b64_tr_b16 a[154:155], v101 offset:53248
    buffer_load_dwordx4 v12, s[56:59], s75 offen offset:2048  lds
    v_mfma_f32_16x16x32_bf16 v[136:139], a[124:127], a[104:107], v[136:139]
    ds_read_b64_tr_b16 a[156:157], v101 offset:57344
    v_mfma_f32_16x16x32_bf16 v[136:139], a[120:123], a[96:99], v[136:139]
    ds_read_b64_tr_b16 a[158:159], v101 offset:61440
    s_waitcnt lgkmcnt(8)
    v_mfma_f32_16x16x32_bf16 v[144:147], a[128:131], a[96:99], v[144:147]
    ds_read_b64_tr_b16 a[160:161], v102 offset:49152
    buffer_load_dwordx4 a[36:39], v16, s[32:35], s64 offen offset:1024 sc1
    v_mfma_f32_16x16x32_bf16 v[144:147], a[132:135], a[104:107], v[144:147]
    ds_read_b64_tr_b16 a[162:163], v102 offset:53248
    v_mfma_f32_16x16x32_bf16 v[148:151], a[132:135], a[108:111], v[148:151]
    ds_read_b64_tr_b16 a[164:165], v102 offset:57344
    v_mfma_f32_16x16x32_bf16 v[148:151], a[128:131], a[100:103], v[148:151]
    ds_read_b64_tr_b16 a[166:167], v102 offset:61440
    v_mfma_f32_16x16x32_bf16 v[156:159], a[136:139], a[100:103], v[156:159]
    ds_read_b64_tr_b16 a[168:169], v103 offset:49152
    v_mfma_f32_16x16x32_bf16 v[156:159], a[140:143], a[108:111], v[156:159]
    ds_read_b64_tr_b16 a[170:171], v103 offset:53248
    buffer_load_dwordx4 v13, s[56:59], s75 offen offset:3072  lds
    v_mfma_f32_16x16x32_bf16 v[152:155], a[140:143], a[104:107], v[152:155]
    ds_read_b64_tr_b16 a[172:173], v103 offset:57344
    s_add_u32 s75, s75, 131072
    v_mfma_f32_16x16x32_bf16 v[152:155], a[136:139], a[96:99], v[152:155]
    ds_read_b64_tr_b16 a[174:175], v103 offset:61440
    s_waitcnt vmcnt(13) lgkmcnt(8)
    s_barrier
    v_mfma_f32_16x16x32_bf16 v[160:163], a[144:147], a[96:99], v[160:163]
    ds_read_b64_tr_b16 a[112:113], v104 offset:0
    buffer_load_dwordx4 a[40:43], v16, s[32:35], s64 offen offset:2048 sc1
    v_mfma_f32_16x16x32_bf16 v[160:163], a[148:151], a[104:107], v[160:163]
    ds_read_b64_tr_b16 a[114:115], v104 offset:4096
    v_mfma_f32_16x16x32_bf16 v[164:167], a[148:151], a[108:111], v[164:167]
    ds_read_b64_tr_b16 a[116:117], v104 offset:8192
    v_mfma_f32_16x16x32_bf16 v[164:167], a[144:147], a[100:103], v[164:167]
    ds_read_b64_tr_b16 a[118:119], v104 offset:12288
    s_mov_b32 s75, 0
    v_mfma_f32_16x16x32_bf16 v[172:175], a[152:155], a[100:103], v[172:175]
    ds_read_b64_tr_b16 a[120:121], v105 offset:0
    s_add_u32 m0, s88, 98304
    v_mfma_f32_16x16x32_bf16 v[172:175], a[156:159], a[108:111], v[172:175]
    ds_read_b64_tr_b16 a[122:123], v105 offset:4096
    buffer_load_dwordx4 v6, s[28:31], s75 offen offset:0  lds
    v_mfma_f32_16x16x32_bf16 v[168:171], a[156:159], a[104:107], v[168:171]
    ds_read_b64_tr_b16 a[124:125], v105 offset:8192
    v_mfma_f32_16x16x32_bf16 v[168:171], a[152:155], a[96:99], v[168:171]
    ds_read_b64_tr_b16 a[126:127], v105 offset:12288
    v_and_b32 v14, 31, v1
    v_lshlrev_b32 v14, 7, v14
    buffer_load_dwordx2 v[2:3], v14, s[40:43], s73 offen sc0 sc1
    s_waitcnt lgkmcnt(8)
    v_mfma_f32_16x16x32_bf16 v[176:179], a[160:163], a[96:99], v[176:179]
    ds_read_b64_tr_b16 a[128:129], v106 offset:0
    buffer_load_dwordx4 a[44:47], v16, s[32:35], s64 offen offset:3072 sc1
    v_mfma_f32_16x16x32_bf16 v[176:179], a[164:167], a[104:107], v[176:179]
    ds_read_b64_tr_b16 a[130:131], v106 offset:4096
    v_mfma_f32_16x16x32_bf16 v[180:183], a[164:167], a[108:111], v[180:183]
    ds_read_b64_tr_b16 a[132:133], v106 offset:8192
    s_add_u32 s64, s64, 4096
    v_mfma_f32_16x16x32_bf16 v[180:183], a[160:163], a[100:103], v[180:183]
    ds_read_b64_tr_b16 a[134:135], v106 offset:12288
    v_mfma_f32_16x16x32_bf16 v[188:191], a[168:171], a[100:103], v[188:191]
    ds_read_b64_tr_b16 a[136:137], v107 offset:0
    v_mfma_f32_16x16x32_bf16 v[188:191], a[172:175], a[108:111], v[188:191]
    ds_read_b64_tr_b16 a[138:139], v107 offset:4096
    buffer_load_dwordx4 v7, s[28:31], s75 offen offset:1024  lds
    v_mfma_f32_16x16x32_bf16 v[184:187], a[172:175], a[104:107], v[184:187]
    ds_read_b64_tr_b16 a[140:141], v107 offset:8192
    v_mfma_f32_16x16x32_bf16 v[184:187], a[168:171], a[96:99], v[184:187]
    ds_read_b64_tr_b16 a[142:143], v107 offset:12288
    s_waitcnt lgkmcnt(8)
    v_mfma_f32_16x16x32_bf16 v[128:131], a[112:115], a[0:3], v[128:131]
    ds_read_b64_tr_b16 a[144:145], v108 offset:0
    buffer_load_dwordx4 a[48:51], v16, s[32:35], s64 offen offset:0 sc1
    v_mfma_f32_16x16x32_bf16 v[128:131], a[116:119], a[8:11], v[128:131]
    ds_read_b64_tr_b16 a[146:147], v108 offset:4096
    v_mfma_f32_16x16x32_bf16 v[132:135], a[116:119], a[12:15], v[132:135]
    ds_read_b64_tr_b16 a[148:149], v108 offset:8192
    v_mfma_f32_16x16x32_bf16 v[132:135], a[112:115], a[4:7], v[132:135]
    ds_read_b64_tr_b16 a[150:151], v108 offset:12288
    v_mfma_f32_16x16x32_bf16 v[140:143], a[120:123], a[4:7], v[140:143]
    ds_read_b64_tr_b16 a[152:153], v109 offset:0
    v_mfma_f32_16x16x32_bf16 v[140:143], a[124:127], a[12:15], v[140:143]
    ds_read_b64_tr_b16 a[154:155], v109 offset:4096
    buffer_load_dwordx4 v8, s[28:31], s75 offen offset:2048  lds
    v_mfma_f32_16x16x32_bf16 v[136:139], a[124:127], a[8:11], v[136:139]
    ds_read_b64_tr_b16 a[156:157], v109 offset:8192
    v_mfma_f32_16x16x32_bf16 v[136:139], a[120:123], a[0:3], v[136:139]
    ds_read_b64_tr_b16 a[158:159], v109 offset:12288
    s_waitcnt lgkmcnt(8)
    v_mfma_f32_16x16x32_bf16 v[144:147], a[128:131], a[0:3], v[144:147]
    ds_read_b64_tr_b16 a[160:161], v110 offset:0
    buffer_load_dwordx4 a[52:55], v16, s[32:35], s64 offen offset:1024 sc1
    v_mfma_f32_16x16x32_bf16 v[144:147], a[132:135], a[8:11], v[144:147]
    ds_read_b64_tr_b16 a[162:163], v110 offset:4096
    v_mfma_f32_16x16x32_bf16 v[148:151], a[132:135], a[12:15], v[148:151]
    ds_read_b64_tr_b16 a[164:165], v110 offset:8192
    v_mfma_f32_16x16x32_bf16 v[148:151], a[128:131], a[4:7], v[148:151]
    ds_read_b64_tr_b16 a[166:167], v110 offset:12288
    v_mfma_f32_16x16x32_bf16 v[156:159], a[136:139], a[4:7], v[156:159]
    ds_read_b64_tr_b16 a[168:169], v111 offset:0
    v_mfma_f32_16x16x32_bf16 v[156:159], a[140:143], a[12:15], v[156:159]
    ds_read_b64_tr_b16 a[170:171], v111 offset:4096
    buffer_load_dwordx4 v9, s[28:31], s75 offen offset:3072  lds
    v_mfma_f32_16x16x32_bf16 v[152:155], a[140:143], a[8:11], v[152:155]
    ds_read_b64_tr_b16 a[172:173], v111 offset:8192
    s_add_u32 s75, s75, 262144
    v_mfma_f32_16x16x32_bf16 v[152:155], a[136:139], a[0:3], v[152:155]
    ds_read_b64_tr_b16 a[174:175], v111 offset:12288
    s_waitcnt vmcnt(14) lgkmcnt(8)
    s_barrier
    v_mfma_f32_16x16x32_bf16 v[160:163], a[144:147], a[0:3], v[160:163]
    ds_read_b64_tr_b16 a[112:113], v88 offset:0
    buffer_load_dwordx4 a[56:59], v16, s[32:35], s64 offen offset:2048 sc1
    v_mfma_f32_16x16x32_bf16 v[160:163], a[148:151], a[8:11], v[160:163]
    ds_read_b64_tr_b16 a[114:115], v88 offset:4096
    v_mfma_f32_16x16x32_bf16 v[164:167], a[148:151], a[12:15], v[164:167]
    ds_read_b64_tr_b16 a[116:117], v88 offset:8192
    v_mfma_f32_16x16x32_bf16 v[164:167], a[144:147], a[4:7], v[164:167]
    ds_read_b64_tr_b16 a[118:119], v88 offset:12288
    v_mfma_f32_16x16x32_bf16 v[172:175], a[152:155], a[4:7], v[172:175]
    ds_read_b64_tr_b16 a[120:121], v89 offset:0
    s_add_u32 m0, s88, 114688
    v_mfma_f32_16x16x32_bf16 v[172:175], a[156:159], a[12:15], v[172:175]
    ds_read_b64_tr_b16 a[122:123], v89 offset:4096
    buffer_load_dwordx4 v6, s[28:31], s75 offen offset:0  lds
    v_mfma_f32_16x16x32_bf16 v[168:171], a[156:159], a[8:11], v[168:171]
    ds_read_b64_tr_b16 a[124:125], v89 offset:8192
    v_mfma_f32_16x16x32_bf16 v[168:171], a[152:155], a[0:3], v[168:171]
    ds_read_b64_tr_b16 a[126:127], v89 offset:12288
    s_waitcnt lgkmcnt(8)
    v_mfma_f32_16x16x32_bf16 v[176:179], a[160:163], a[0:3], v[176:179]
    ds_read_b64_tr_b16 a[128:129], v90 offset:0
    buffer_load_dwordx4 a[60:63], v16, s[32:35], s64 offen offset:3072 sc1
    v_accvgpr_read_b32 v124, a26
    v_mfma_f32_16x16x32_bf16 v[176:179], a[164:167], a[8:11], v[176:179]
    ds_read_b64_tr_b16 a[130:131], v90 offset:4096
    v_accvgpr_read_b32 v125, a27
    v_mfma_f32_16x16x32_bf16 v[180:183], a[164:167], a[12:15], v[180:183]
    ds_read_b64_tr_b16 a[132:133], v90 offset:8192
    s_add_u32 s64, s64, 4096
    v_accvgpr_mov_b32 a26, a28
    v_mfma_f32_16x16x32_bf16 v[180:183], a[160:163], a[4:7], v[180:183]
    ds_read_b64_tr_b16 a[134:135], v90 offset:12288
    v_accvgpr_mov_b32 a27, a29
    v_mfma_f32_16x16x32_bf16 v[188:191], a[168:171], a[4:7], v[188:191]
    ds_read_b64_tr_b16 a[136:137], v91 offset:0
    v_accvgpr_write_b32 a28, v124
    v_mfma_f32_16x16x32_bf16 v[188:191], a[172:175], a[12:15], v[188:191]
    ds_read_b64_tr_b16 a[138:139], v91 offset:4096
    buffer_load_dwordx4 v7, s[28:31], s75 offen offset:1024  lds
    v_accvgpr_write_b32 a29, v125
    v_mfma_f32_16x16x32_bf16 v[184:187], a[172:175], a[8:11], v[184:187]
    ds_read_b64_tr_b16 a[140:141], v91 offset:8192
    v_mfma_f32_16x16x32_bf16 v[184:187], a[168:171], a[0:3], v[184:187]
    ds_read_b64_tr_b16 a[142:143], v91 offset:12288
    s_waitcnt lgkmcnt(8)
    v_mfma_f32_16x16x32_bf16 v[128:131], a[112:115], a[16:19], v[128:131]
    ds_read_b64_tr_b16 a[144:145], v92 offset:0
    buffer_load_dwordx4 a[64:67], v16, s[32:35], s64 offen offset:0 sc1
    v_mfma_f32_16x16x32_bf16 v[128:131], a[116:119], a[24:27], v[128:131]
    ds_read_b64_tr_b16 a[146:147], v92 offset:4096
    v_mfma_f32_16x16x32_bf16 v[132:135], a[116:119], a[28:31], v[132:135]
    ds_read_b64_tr_b16 a[148:149], v92 offset:8192
    v_mfma_f32_16x16x32_bf16 v[132:135], a[112:115], a[20:23], v[132:135]
    ds_read_b64_tr_b16 a[150:151], v92 offset:12288
    v_mfma_f32_16x16x32_bf16 v[140:143], a[120:123], a[20:23], v[140:143]
    ds_read_b64_tr_b16 a[152:153], v93 offset:0
    v_mfma_f32_16x16x32_bf16 v[140:143], a[124:127], a[28:31], v[140:143]
    ds_read_b64_tr_b16 a[154:155], v93 offset:4096
    buffer_load_dwordx4 v8, s[28:31], s75 offen offset:2048  lds
    v_mfma_f32_16x16x32_bf16 v[136:139], a[124:127], a[24:27], v[136:139]
    ds_read_b64_tr_b16 a[156:157], v93 offset:8192
    v_mfma_f32_16x16x32_bf16 v[136:139], a[120:123], a[16:19], v[136:139]
    ds_read_b64_tr_b16 a[158:159], v93 offset:12288
    s_waitcnt lgkmcnt(8)
    v_mfma_f32_16x16x32_bf16 v[144:147], a[128:131], a[16:19], v[144:147]
    ds_read_b64_tr_b16 a[160:161], v94 offset:0
    buffer_load_dwordx4 a[68:71], v16, s[32:35], s64 offen offset:1024 sc1
    v_mfma_f32_16x16x32_bf16 v[144:147], a[132:135], a[24:27], v[144:147]
    ds_read_b64_tr_b16 a[162:163], v94 offset:4096
    v_mfma_f32_16x16x32_bf16 v[148:151], a[132:135], a[28:31], v[148:151]
    ds_read_b64_tr_b16 a[164:165], v94 offset:8192
    v_mfma_f32_16x16x32_bf16 v[148:151], a[128:131], a[20:23], v[148:151]
    ds_read_b64_tr_b16 a[166:167], v94 offset:12288
    v_mfma_f32_16x16x32_bf16 v[156:159], a[136:139], a[20:23], v[156:159]
    ds_read_b64_tr_b16 a[168:169], v95 offset:0
    v_mfma_f32_16x16x32_bf16 v[156:159], a[140:143], a[28:31], v[156:159]
    ds_read_b64_tr_b16 a[170:171], v95 offset:4096
    buffer_load_dwordx4 v9, s[28:31], s75 offen offset:3072  lds
    v_mfma_f32_16x16x32_bf16 v[152:155], a[140:143], a[24:27], v[152:155]
    ds_read_b64_tr_b16 a[172:173], v95 offset:8192
    s_add_u32 s75, s75, 262144
    v_mfma_f32_16x16x32_bf16 v[152:155], a[136:139], a[16:19], v[152:155]
    ds_read_b64_tr_b16 a[174:175], v95 offset:12288
    s_waitcnt vmcnt(13) lgkmcnt(8)
    s_barrier
    v_mfma_f32_16x16x32_bf16 v[160:163], a[144:147], a[16:19], v[160:163]
    ds_read_b64_tr_b16 a[112:113], v88 offset:16384
    buffer_load_dwordx4 a[72:75], v16, s[32:35], s64 offen offset:2048 sc1
    v_mfma_f32_16x16x32_bf16 v[160:163], a[148:151], a[24:27], v[160:163]
    ds_read_b64_tr_b16 a[114:115], v88 offset:20480
    v_mfma_f32_16x16x32_bf16 v[164:167], a[148:151], a[28:31], v[164:167]
    ds_read_b64_tr_b16 a[116:117], v88 offset:24576
    v_mfma_f32_16x16x32_bf16 v[164:167], a[144:147], a[20:23], v[164:167]
    ds_read_b64_tr_b16 a[118:119], v88 offset:28672
    v_mfma_f32_16x16x32_bf16 v[172:175], a[152:155], a[20:23], v[172:175]
    ds_read_b64_tr_b16 a[120:121], v89 offset:16384
    s_add_u32 m0, s88, 131072
    v_mfma_f32_16x16x32_bf16 v[172:175], a[156:159], a[28:31], v[172:175]
    ds_read_b64_tr_b16 a[122:123], v89 offset:20480
    buffer_load_dwordx4 v6, s[28:31], s75 offen offset:0  lds
    v_mfma_f32_16x16x32_bf16 v[168:171], a[156:159], a[24:27], v[168:171]
    ds_read_b64_tr_b16 a[124:125], v89 offset:24576
    v_mfma_f32_16x16x32_bf16 v[168:171], a[152:155], a[16:19], v[168:171]
    ds_read_b64_tr_b16 a[126:127], v89 offset:28672
    s_waitcnt lgkmcnt(8)
    v_mfma_f32_16x16x32_bf16 v[176:179], a[160:163], a[16:19], v[176:179]
    ds_read_b64_tr_b16 a[128:129], v90 offset:16384
    buffer_load_dwordx4 a[76:79], v16, s[32:35], s64 offen offset:3072 sc1
    v_mfma_f32_16x16x32_bf16 v[176:179], a[164:167], a[24:27], v[176:179]
    ds_read_b64_tr_b16 a[130:131], v90 offset:20480
    v_mfma_f32_16x16x32_bf16 v[180:183], a[164:167], a[28:31], v[180:183]
    ds_read_b64_tr_b16 a[132:133], v90 offset:24576
    s_add_u32 s64, s64, 4096
    v_mfma_f32_16x16x32_bf16 v[180:183], a[160:163], a[20:23], v[180:183]
    ds_read_b64_tr_b16 a[134:135], v90 offset:28672
    v_mfma_f32_16x16x32_bf16 v[188:191], a[168:171], a[20:23], v[188:191]
    ds_read_b64_tr_b16 a[136:137], v91 offset:16384
    v_mfma_f32_16x16x32_bf16 v[188:191], a[172:175], a[28:31], v[188:191]
    ds_read_b64_tr_b16 a[138:139], v91 offset:20480
    buffer_load_dwordx4 v7, s[28:31], s75 offen offset:1024  lds
    v_mfma_f32_16x16x32_bf16 v[184:187], a[172:175], a[24:27], v[184:187]
    ds_read_b64_tr_b16 a[140:141], v91 offset:24576
    v_mfma_f32_16x16x32_bf16 v[184:187], a[168:171], a[16:19], v[184:187]
    ds_read_b64_tr_b16 a[142:143], v91 offset:28672
    s_waitcnt lgkmcnt(8)
    v_mfma_f32_16x16x32_bf16 v[128:131], a[112:115], a[32:35], v[128:131]
    ds_read_b64_tr_b16 a[144:145], v92 offset:16384
    buffer_load_dwordx4 a[80:83], v16, s[32:35], s64 offen offset:0 sc1
    v_mfma_f32_16x16x32_bf16 v[128:131], a[116:119], a[40:43], v[128:131]
    ds_read_b64_tr_b16 a[146:147], v92 offset:20480
    v_mfma_f32_16x16x32_bf16 v[132:135], a[116:119], a[44:47], v[132:135]
    ds_read_b64_tr_b16 a[148:149], v92 offset:24576
    v_mfma_f32_16x16x32_bf16 v[132:135], a[112:115], a[36:39], v[132:135]
    ds_read_b64_tr_b16 a[150:151], v92 offset:28672
    v_mfma_f32_16x16x32_bf16 v[140:143], a[120:123], a[36:39], v[140:143]
    ds_read_b64_tr_b16 a[152:153], v93 offset:16384
    v_mfma_f32_16x16x32_bf16 v[140:143], a[124:127], a[44:47], v[140:143]
    ds_read_b64_tr_b16 a[154:155], v93 offset:20480
    buffer_load_dwordx4 v8, s[28:31], s75 offen offset:2048  lds
    v_mfma_f32_16x16x32_bf16 v[136:139], a[124:127], a[40:43], v[136:139]
    ds_read_b64_tr_b16 a[156:157], v93 offset:24576
    v_mfma_f32_16x16x32_bf16 v[136:139], a[120:123], a[32:35], v[136:139]
    ds_read_b64_tr_b16 a[158:159], v93 offset:28672
    s_waitcnt lgkmcnt(8)
    v_mfma_f32_16x16x32_bf16 v[144:147], a[128:131], a[32:35], v[144:147]
    ds_read_b64_tr_b16 a[160:161], v94 offset:16384
    buffer_load_dwordx4 a[84:87], v16, s[32:35], s64 offen offset:1024 sc1
    v_mfma_f32_16x16x32_bf16 v[144:147], a[132:135], a[40:43], v[144:147]
    ds_read_b64_tr_b16 a[162:163], v94 offset:20480
    v_mfma_f32_16x16x32_bf16 v[148:151], a[132:135], a[44:47], v[148:151]
    ds_read_b64_tr_b16 a[164:165], v94 offset:24576
    v_mfma_f32_16x16x32_bf16 v[148:151], a[128:131], a[36:39], v[148:151]
    ds_read_b64_tr_b16 a[166:167], v94 offset:28672
    v_mfma_f32_16x16x32_bf16 v[156:159], a[136:139], a[36:39], v[156:159]
    ds_read_b64_tr_b16 a[168:169], v95 offset:16384
    v_mfma_f32_16x16x32_bf16 v[156:159], a[140:143], a[44:47], v[156:159]
    ds_read_b64_tr_b16 a[170:171], v95 offset:20480
    buffer_load_dwordx4 v9, s[28:31], s75 offen offset:3072  lds
    v_mfma_f32_16x16x32_bf16 v[152:155], a[140:143], a[40:43], v[152:155]
    ds_read_b64_tr_b16 a[172:173], v95 offset:24576
    s_add_u32 s75, s75, 262144
    v_mfma_f32_16x16x32_bf16 v[152:155], a[136:139], a[32:35], v[152:155]
    ds_read_b64_tr_b16 a[174:175], v95 offset:28672
    s_waitcnt vmcnt(13) lgkmcnt(8)
    s_barrier
    v_mfma_f32_16x16x32_bf16 v[160:163], a[144:147], a[32:35], v[160:163]
    ds_read_b64_tr_b16 a[112:113], v96 offset:0
    buffer_load_dwordx4 a[88:91], v16, s[32:35], s64 offen offset:2048 sc1
    v_mfma_f32_16x16x32_bf16 v[160:163], a[148:151], a[40:43], v[160:163]
    ds_read_b64_tr_b16 a[114:115], v96 offset:4096
    v_mfma_f32_16x16x32_bf16 v[164:167], a[148:151], a[44:47], v[164:167]
    ds_read_b64_tr_b16 a[116:117], v96 offset:8192
    v_mfma_f32_16x16x32_bf16 v[164:167], a[144:147], a[36:39], v[164:167]
    ds_read_b64_tr_b16 a[118:119], v96 offset:12288
    v_mfma_f32_16x16x32_bf16 v[172:175], a[152:155], a[36:39], v[172:175]
    ds_read_b64_tr_b16 a[120:121], v97 offset:0
    s_add_u32 m0, s88, 0
    v_mfma_f32_16x16x32_bf16 v[172:175], a[156:159], a[44:47], v[172:175]
    ds_read_b64_tr_b16 a[122:123], v97 offset:4096
    buffer_load_dwordx4 v6, s[28:31], s75 offen offset:0  lds
    v_mfma_f32_16x16x32_bf16 v[168:171], a[156:159], a[40:43], v[168:171]
    ds_read_b64_tr_b16 a[124:125], v97 offset:8192
    v_mfma_f32_16x16x32_bf16 v[168:171], a[152:155], a[32:35], v[168:171]
    ds_read_b64_tr_b16 a[126:127], v97 offset:12288
    s_mov_b32 s99, 0
L_ck2:
    v_xor_b32 v2, s92, v2
    v_xor_b32 v3, s93, v3
    v_or_b32 v2, v2, v3
    v_cmp_ne_u32 vcc, 0, v2
    s_cbranch_vccz L_ck2_ok
    buffer_load_dwordx2 v[2:3], v14, s[40:43], s73 offen sc0 sc1
    s_add_u32 s99, s99, 1
    s_cmp_lt_u32 s99, 0x200000
    s_waitcnt vmcnt(0)
    s_cbranch_scc1 L_ck2
L_ck2_ok:
    s_waitcnt lgkmcnt(8)
    v_mfma_f32_16x16x32_bf16 v[176:179], a[160:163], a[32:35], v[176:179]
    ds_read_b64_tr_b16 a[128:129], v98 offset:0
    buffer_load_dwordx4 a[92:95], v16, s[32:35], s64 offen offset:3072 sc1
    v_mfma_f32_16x16x32_bf16 v[176:179], a[164:167], a[40:43], v[176:179]
    ds_read_b64_tr_b16 a[130:131], v98 offset:4096
    v_mfma_f32_16x16x32_bf16 v[180:183], a[164:167], a[44:47], v[180:183]
    ds_read_b64_tr_b16 a[132:133], v98 offset:8192
    s_add_u32 s64, s64, 4096
    v_mfma_f32_16x16x32_bf16 v[180:183], a[160:163], a[36:39], v[180:183]
    ds_read_b64_tr_b16 a[134:135], v98 offset:12288
    v_mfma_f32_16x16x32_bf16 v[188:191], a[168:171], a[36:39], v[188:191]
    ds_read_b64_tr_b16 a[136:137], v99 offset:0
    v_mfma_f32_16x16x32_bf16 v[188:191], a[172:175], a[44:47], v[188:191]
    ds_read_b64_tr_b16 a[138:139], v99 offset:4096
    buffer_load_dwordx4 v7, s[28:31], s75 offen offset:1024  lds
    v_mfma_f32_16x16x32_bf16 v[184:187], a[172:175], a[40:43], v[184:187]
    ds_read_b64_tr_b16 a[140:141], v99 offset:8192
    v_mfma_f32_16x16x32_bf16 v[184:187], a[168:171], a[32:35], v[184:187]
    ds_read_b64_tr_b16 a[142:143], v99 offset:12288
    s_waitcnt lgkmcnt(8)
    v_mfma_f32_16x16x32_bf16 v[128:131], a[112:115], a[48:51], v[128:131]
    ds_read_b64_tr_b16 a[144:145], v100 offset:0
    buffer_load_dwordx4 a[96:99], v16, s[32:35], s64 offen offset:0 sc1
    v_mfma_f32_16x16x32_bf16 v[128:131], a[116:119], a[56:59], v[128:131]
    ds_read_b64_tr_b16 a[146:147], v100 offset:4096
    v_mfma_f32_16x16x32_bf16 v[132:135], a[116:119], a[60:63], v[132:135]
    ds_read_b64_tr_b16 a[148:149], v100 offset:8192
    v_mfma_f32_16x16x32_bf16 v[132:135], a[112:115], a[52:55], v[132:135]
    ds_read_b64_tr_b16 a[150:151], v100 offset:12288
    v_mfma_f32_16x16x32_bf16 v[140:143], a[120:123], a[52:55], v[140:143]
    ds_read_b64_tr_b16 a[152:153], v101 offset:0
    v_mfma_f32_16x16x32_bf16 v[140:143], a[124:127], a[60:63], v[140:143]
    ds_read_b64_tr_b16 a[154:155], v101 offset:4096
    buffer_load_dwordx4 v8, s[28:31], s75 offen offset:2048  lds
    v_mfma_f32_16x16x32_bf16 v[136:139], a[124:127], a[56:59], v[136:139]
    ds_read_b64_tr_b16 a[156:157], v101 offset:8192
    v_mfma_f32_16x16x32_bf16 v[136:139], a[120:123], a[48:51], v[136:139]
    ds_read_b64_tr_b16 a[158:159], v101 offset:12288
    s_waitcnt lgkmcnt(8)
    v_mfma_f32_16x16x32_bf16 v[144:147], a[128:131], a[48:51], v[144:147]
    ds_read_b64_tr_b16 a[160:161], v102 offset:0
    buffer_load_dwordx4 a[100:103], v16, s[32:35], s64 offen offset:1024 sc1
    v_mfma_f32_16x16x32_bf16 v[144:147], a[132:135], a[56:59], v[144:147]
    ds_read_b64_tr_b16 a[162:163], v102 offset:4096
    v_mfma_f32_16x16x32_bf16 v[148:151], a[132:135], a[60:63], v[148:151]
    ds_read_b64_tr_b16 a[164:165], v102 offset:8192
    v_mfma_f32_16x16x32_bf16 v[148:151], a[128:131], a[52:55], v[148:151]
    ds_read_b64_tr_b16 a[166:167], v102 offset:12288
    v_mfma_f32_16x16x32_bf16 v[156:159], a[136:139], a[52:55], v[156:159]
    ds_read_b64_tr_b16 a[168:169], v103 offset:0
    v_mfma_f32_16x16x32_bf16 v[156:159], a[140:143], a[60:63], v[156:159]
    ds_read_b64_tr_b16 a[170:171], v103 offset:4096
    buffer_load_dwordx4 v9, s[28:31], s75 offen offset:3072  lds
    v_mfma_f32_16x16x32_bf16 v[152:155], a[140:143], a[56:59], v[152:155]
    ds_read_b64_tr_b16 a[172:173], v103 offset:8192
    s_add_u32 s75, s75, 262144
    v_mfma_f32_16x16x32_bf16 v[152:155], a[136:139], a[48:51], v[152:155]
    ds_read_b64_tr_b16 a[174:175], v103 offset:12288
    s_waitcnt vmcnt(13) lgkmcnt(8)
    s_barrier
    v_mfma_f32_16x16x32_bf16 v[160:163], a[144:147], a[48:51], v[160:163]
    ds_read_b64_tr_b16 a[112:113], v88 offset:32768
    buffer_load_dwordx4 a[104:107], v16, s[32:35], s64 offen offset:2048 sc1
    v_mfma_f32_16x16x32_bf16 v[160:163], a[148:151], a[56:59], v[160:163]
    ds_read_b64_tr_b16 a[114:115], v88 offset:36864
    v_mfma_f32_16x16x32_bf16 v[164:167], a[148:151], a[60:63], v[164:167]
    ds_read_b64_tr_b16 a[116:117], v88 offset:40960
    v_mfma_f32_16x16x32_bf16 v[164:167], a[144:147], a[52:55], v[164:167]
    ds_read_b64_tr_b16 a[118:119], v88 offset:45056
    v_mfma_f32_16x16x32_bf16 v[172:175], a[152:155], a[52:55], v[172:175]
    ds_read_b64_tr_b16 a[120:121], v89 offset:32768
    s_add_u32 m0, s88, 16384
    v_mfma_f32_16x16x32_bf16 v[172:175], a[156:159], a[60:63], v[172:175]
    ds_read_b64_tr_b16 a[122:123], v89 offset:36864
    buffer_load_dwordx4 v6, s[28:31], s75 offen offset:0  lds
    v_mfma_f32_16x16x32_bf16 v[168:171], a[156:159], a[56:59], v[168:171]
    ds_read_b64_tr_b16 a[124:125], v89 offset:40960
    v_mfma_f32_16x16x32_bf16 v[168:171], a[152:155], a[48:51], v[168:171]
    ds_read_b64_tr_b16 a[126:127], v89 offset:45056
    s_waitcnt lgkmcnt(8)
    v_mfma_f32_16x16x32_bf16 v[176:179], a[160:163], a[48:51], v[176:179]
    ds_read_b64_tr_b16 a[128:129], v90 offset:32768
    buffer_load_dwordx4 a[108:111], v16, s[32:35], s64 offen offset:3072 sc1
    v_mfma_f32_16x16x32_bf16 v[176:179], a[164:167], a[56:59], v[176:179]
    ds_read_b64_tr_b16 a[130:131], v90 offset:36864
    v_mfma_f32_16x16x32_bf16 v[180:183], a[164:167], a[60:63], v[180:183]
    ds_read_b64_tr_b16 a[132:133], v90 offset:40960
    s_mov_b32 s64, 229376
    v_mfma_f32_16x16x32_bf16 v[180:183], a[160:163], a[52:55], v[180:183]
    ds_read_b64_tr_b16 a[134:135], v90 offset:45056
    v_mfma_f32_16x16x32_bf16 v[188:191], a[168:171], a[52:55], v[188:191]
    ds_read_b64_tr_b16 a[136:137], v91 offset:32768
    v_mfma_f32_16x16x32_bf16 v[188:191], a[172:175], a[60:63], v[188:191]
    ds_read_b64_tr_b16 a[138:139], v91 offset:36864
    buffer_load_dwordx4 v7, s[28:31], s75 offen offset:1024  lds
    v_mfma_f32_16x16x32_bf16 v[184:187], a[172:175], a[56:59], v[184:187]
    ds_read_b64_tr_b16 a[140:141], v91 offset:40960
    v_mfma_f32_16x16x32_bf16 v[184:187], a[168:171], a[48:51], v[184:187]
    ds_read_b64_tr_b16 a[142:143], v91 offset:45056
    s_waitcnt lgkmcnt(8)
    v_mfma_f32_16x16x32_bf16 v[128:131], a[112:115], a[64:67], v[128:131]
    ds_read_b64_tr_b16 a[144:145], v92 offset:32768
    buffer_load_dwordx4 a[0:3], v16, s[32:35], s64 offen offset:0 sc1
    v_mfma_f32_16x16x32_bf16 v[128:131], a[116:119], a[72:75], v[128:131]
    ds_read_b64_tr_b16 a[146:147], v92 offset:36864
    v_mfma_f32_16x16x32_bf16 v[132:135], a[116:119], a[76:79], v[132:135]
    ds_read_b64_tr_b16 a[148:149], v92 offset:40960
    v_mfma_f32_16x16x32_bf16 v[132:135], a[112:115], a[68:71], v[132:135]
    ds_read_b64_tr_b16 a[150:151], v92 offset:45056
    v_mfma_f32_16x16x32_bf16 v[140:143], a[120:123], a[68:71], v[140:143]
    ds_read_b64_tr_b16 a[152:153], v93 offset:32768
    v_mfma_f32_16x16x32_bf16 v[140:143], a[124:127], a[76:79], v[140:143]
    ds_read_b64_tr_b16 a[154:155], v93 offset:36864
    buffer_load_dwordx4 v8, s[28:31], s75 offen offset:2048  lds
    v_mfma_f32_16x16x32_bf16 v[136:139], a[124:127], a[72:75], v[136:139]
    ds_read_b64_tr_b16 a[156:157], v93 offset:40960
    v_mfma_f32_16x16x32_bf16 v[136:139], a[120:123], a[64:67], v[136:139]
    ds_read_b64_tr_b16 a[158:159], v93 offset:45056
    s_waitcnt lgkmcnt(8)
    v_mfma_f32_16x16x32_bf16 v[144:147], a[128:131], a[64:67], v[144:147]
    ds_read_b64_tr_b16 a[160:161], v94 offset:32768
    buffer_load_dwordx4 a[4:7], v16, s[32:35], s64 offen offset:1024 sc1
    v_mfma_f32_16x16x32_bf16 v[144:147], a[132:135], a[72:75], v[144:147]
    ds_read_b64_tr_b16 a[162:163], v94 offset:36864
    v_mfma_f32_16x16x32_bf16 v[148:151], a[132:135], a[76:79], v[148:151]
    ds_read_b64_tr_b16 a[164:165], v94 offset:40960
    v_mfma_f32_16x16x32_bf16 v[148:151], a[128:131], a[68:71], v[148:151]
    ds_read_b64_tr_b16 a[166:167], v94 offset:45056
    v_mfma_f32_16x16x32_bf16 v[156:159], a[136:139], a[68:71], v[156:159]
    ds_read_b64_tr_b16 a[168:169], v95 offset:32768
    v_mfma_f32_16x16x32_bf16 v[156:159], a[140:143], a[76:79], v[156:159]
    ds_read_b64_tr_b16 a[170:171], v95 offset:36864
    buffer_load_dwordx4 v9, s[28:31], s75 offen offset:3072  lds
    v_mfma_f32_16x16x32_bf16 v[152:155], a[140:143], a[72:75], v[152:155]
    ds_read_b64_tr_b16 a[172:173], v95 offset:40960
    s_add_u32 s75, s75, 262144
    v_mfma_f32_16x16x32_bf16 v[152:155], a[136:139], a[64:67], v[152:155]
    ds_read_b64_tr_b16 a[174:175], v95 offset:45056
    s_waitcnt vmcnt(13) lgkmcnt(8)
    s_barrier
    v_mfma_f32_16x16x32_bf16 v[160:163], a[144:147], a[64:67], v[160:163]
    ds_read_b64_tr_b16 a[112:113], v88 offset:49152
    buffer_load_dwordx4 a[8:11], v16, s[32:35], s64 offen offset:2048 sc1
    v_mfma_f32_16x16x32_bf16 v[160:163], a[148:151], a[72:75], v[160:163]
    ds_read_b64_tr_b16 a[114:115], v88 offset:53248
    v_mfma_f32_16x16x32_bf16 v[164:167], a[148:151], a[76:79], v[164:167]
    ds_read_b64_tr_b16 a[116:117], v88 offset:57344
    v_mfma_f32_16x16x32_bf16 v[164:167], a[144:147], a[68:71], v[164:167]
    ds_read_b64_tr_b16 a[118:119], v88 offset:61440
    v_mfma_f32_16x16x32_bf16 v[172:175], a[152:155], a[68:71], v[172:175]
    ds_read_b64_tr_b16 a[120:121], v89 offset:49152
    s_add_u32 m0, s88, 65536
    v_mfma_f32_16x16x32_bf16 v[172:175], a[156:159], a[76:79], v[172:175]
    ds_read_b64_tr_b16 a[122:123], v89 offset:53248
    buffer_load_dwordx4 v6, s[28:31], s75 offen offset:0  lds
    v_mfma_f32_16x16x32_bf16 v[168:171], a[156:159], a[72:75], v[168:171]
    ds_read_b64_tr_b16 a[124:125], v89 offset:57344
    v_mfma_f32_16x16x32_bf16 v[168:171], a[152:155], a[64:67], v[168:171]
    ds_read_b64_tr_b16 a[126:127], v89 offset:61440
    s_waitcnt lgkmcnt(8)
    v_mfma_f32_16x16x32_bf16 v[176:179], a[160:163], a[64:67], v[176:179]
    ds_read_b64_tr_b16 a[128:129], v90 offset:49152
    buffer_load_dwordx4 a[12:15], v16, s[32:35], s64 offen offset:3072 sc1
    v_accvgpr_read_b32 v124, a82
    v_mfma_f32_16x16x32_bf16 v[176:179], a[164:167], a[72:75], v[176:179]
    ds_read_b64_tr_b16 a[130:131], v90 offset:53248
    v_accvgpr_read_b32 v125, a83
    v_mfma_f32_16x16x32_bf16 v[180:183], a[164:167], a[76:79], v[180:183]
    ds_read_b64_tr_b16 a[132:133], v90 offset:57344
    s_add_u32 s64, s64, 4096
    v_accvgpr_mov_b32 a82, a84
    v_mfma_f32_16x16x32_bf16 v[180:183], a[160:163], a[68:71], v[180:183]
    ds_read_b64_tr_b16 a[134:135], v90 offset:61440
    v_accvgpr_mov_b32 a83, a85
    v_mfma_f32_16x16x32_bf16 v[188:191], a[168:171], a[68:71], v[188:191]
    ds_read_b64_tr_b16 a[136:137], v91 offset:49152
    v_accvgpr_write_b32 a84, v124
    v_mfma_f32_16x16x32_bf16 v[188:191], a[172:175], a[76:79], v[188:191]
    ds_read_b64_tr_b16 a[138:139], v91 offset:53248
    buffer_load_dwordx4 v7, s[28:31], s75 offen offset:1024  lds
    v_accvgpr_write_b32 a85, v125
    v_mfma_f32_16x16x32_bf16 v[184:187], a[172:175], a[72:75], v[184:187]
    ds_read_b64_tr_b16 a[140:141], v91 offset:57344
    v_mfma_f32_16x16x32_bf16 v[184:187], a[168:171], a[64:67], v[184:187]
    ds_read_b64_tr_b16 a[142:143], v91 offset:61440
    s_waitcnt lgkmcnt(8)
    v_mfma_f32_16x16x32_bf16 v[128:131], a[112:115], a[80:83], v[128:131]
    ds_read_b64_tr_b16 a[144:145], v92 offset:49152
    buffer_load_dwordx4 a[16:19], v16, s[32:35], s64 offen offset:0 sc1
    v_mfma_f32_16x16x32_bf16 v[128:131], a[116:119], a[88:91], v[128:131]
    ds_read_b64_tr_b16 a[146:147], v92 offset:53248
    buffer_load_dwordx4 a[20:23], v16, s[32:35], s64 offen offset:1024 sc1
    v_mfma_f32_16x16x32_bf16 v[132:135], a[116:119], a[92:95], v[132:135]
    ds_read_b64_tr_b16 a[148:149], v92 offset:57344
    v_mfma_f32_16x16x32_bf16 v[132:135], a[112:115], a[84:87], v[132:135]
    ds_read_b64_tr_b16 a[150:151], v92 offset:61440
    v_mfma_f32_16x16x32_bf16 v[140:143], a[120:123], a[84:87], v[140:143]
    ds_read_b64_tr_b16 a[152:153], v93 offset:49152
    buffer_load_dwordx4 a[24:27], v16, s[32:35], s64 offen offset:2048 sc1
    v_mfma_f32_16x16x32_bf16 v[140:143], a[124:127], a[92:95], v[140:143]
    ds_read_b64_tr_b16 a[154:155], v93 offset:53248
    buffer_load_dwordx4 a[28:31], v16, s[32:35], s64 offen offset:3072 sc1
    buffer_load_dwordx4 v8, s[28:31], s75 offen offset:2048  lds
    v_mfma_f32_16x16x32_bf16 v[136:139], a[124:127], a[88:91], v[136:139]
    ds_read_b64_tr_b16 a[156:157], v93 offset:57344
    s_add_u32 s64, s64, 4096
    v_mfma_f32_16x16x32_bf16 v[136:139], a[120:123], a[80:83], v[136:139]
    ds_read_b64_tr_b16 a[158:159], v93 offset:61440
    s_waitcnt lgkmcnt(8)
    v_mfma_f32_16x16x32_bf16 v[144:147], a[128:131], a[80:83], v[144:147]
    ds_read_b64_tr_b16 a[160:161], v94 offset:49152
    buffer_load_dwordx4 a[32:35], v16, s[32:35], s64 offen offset:0 sc1
    v_mfma_f32_16x16x32_bf16 v[144:147], a[132:135], a[88:91], v[144:147]
    ds_read_b64_tr_b16 a[162:163], v94 offset:53248
    buffer_load_dwordx4 a[36:39], v16, s[32:35], s64 offen offset:1024 sc1
    v_mfma_f32_16x16x32_bf16 v[148:151], a[132:135], a[92:95], v[148:151]
    ds_read_b64_tr_b16 a[164:165], v94 offset:57344
    v_mfma_f32_16x16x32_bf16 v[148:151], a[128:131], a[84:87], v[148:151]
    ds_read_b64_tr_b16 a[166:167], v94 offset:61440
    v_mfma_f32_16x16x32_bf16 v[156:159], a[136:139], a[84:87], v[156:159]
    ds_read_b64_tr_b16 a[168:169], v95 offset:49152
    v_mfma_f32_16x16x32_bf16 v[156:159], a[140:143], a[92:95], v[156:159]
    ds_read_b64_tr_b16 a[170:171], v95 offset:53248
    buffer_load_dwordx4 v9, s[28:31], s75 offen offset:3072  lds
    v_mfma_f32_16x16x32_bf16 v[152:155], a[140:143], a[88:91], v[152:155]
    ds_read_b64_tr_b16 a[172:173], v95 offset:57344
    s_add_u32 s75, s75, 262144
    v_mfma_f32_16x16x32_bf16 v[152:155], a[136:139], a[80:83], v[152:155]
    ds_read_b64_tr_b16 a[174:175], v95 offset:61440
    s_waitcnt vmcnt(17) lgkmcnt(8)
    s_barrier
    v_mfma_f32_16x16x32_bf16 v[160:163], a[144:147], a[80:83], v[160:163]
    ds_read_b64_tr_b16 a[112:113], v96 offset:16384
    buffer_load_dwordx4 a[40:43], v16, s[32:35], s64 offen offset:2048 sc1
    v_mfma_f32_16x16x32_bf16 v[160:163], a[148:151], a[88:91], v[160:163]
    ds_read_b64_tr_b16 a[114:115], v96 offset:20480
    v_mfma_f32_16x16x32_bf16 v[164:167], a[148:151], a[92:95], v[164:167]
    ds_read_b64_tr_b16 a[116:117], v96 offset:24576
    v_mfma_f32_16x16x32_bf16 v[164:167], a[144:147], a[84:87], v[164:167]
    ds_read_b64_tr_b16 a[118:119], v96 offset:28672
    v_mfma_f32_16x16x32_bf16 v[172:175], a[152:155], a[84:87], v[172:175]
    ds_read_b64_tr_b16 a[120:121], v97 offset:16384
    s_add_u32 m0, s88, 32768
    v_mfma_f32_16x16x32_bf16 v[172:175], a[156:159], a[92:95], v[172:175]
    ds_read_b64_tr_b16 a[122:123], v97 offset:20480
    buffer_load_dwordx4 v6, s[28:31], s75 offen offset:0  lds
    v_mfma_f32_16x16x32_bf16 v[168:171], a[156:159], a[88:91], v[168:171]
    ds_read_b64_tr_b16 a[124:125], v97 offset:24576
    v_mfma_f32_16x16x32_bf16 v[168:171], a[152:155], a[80:83], v[168:171]
    ds_read_b64_tr_b16 a[126:127], v97 offset:28672
    s_waitcnt lgkmcnt(8)
    v_mfma_f32_16x16x32_bf16 v[176:179], a[160:163], a[80:83], v[176:179]
    ds_read_b64_tr_b16 a[128:129], v98 offset:16384
    buffer_load_dwordx4 a[44:47], v16, s[32:35], s64 offen offset:3072 sc1
    v_mfma_f32_16x16x32_bf16 v[176:179], a[164:167], a[88:91], v[176:179]
    ds_read_b64_tr_b16 a[130:131], v98 offset:20480
    v_mfma_f32_16x16x32_bf16 v[180:183], a[164:167], a[92:95], v[180:183]
    ds_read_b64_tr_b16 a[132:133], v98 offset:24576
    s_add_u32 s64, s64, 4096
    v_mfma_f32_16x16x32_bf16 v[180:183], a[160:163], a[84:87], v[180:183]
    ds_read_b64_tr_b16 a[134:135], v98 offset:28672
    v_mfma_f32_16x16x32_bf16 v[188:191], a[168:171], a[84:87], v[188:191]
    ds_read_b64_tr_b16 a[136:137], v99 offset:16384
    v_mfma_f32_16x16x32_bf16 v[188:191], a[172:175], a[92:95], v[188:191]
    ds_read_b64_tr_b16 a[138:139], v99 offset:20480
    buffer_load_dwordx4 v7, s[28:31], s75 offen offset:1024  lds
    v_mfma_f32_16x16x32_bf16 v[184:187], a[172:175], a[88:91], v[184:187]
    ds_read_b64_tr_b16 a[140:141], v99 offset:24576
    v_mfma_f32_16x16x32_bf16 v[184:187], a[168:171], a[80:83], v[184:187]
    ds_read_b64_tr_b16 a[142:143], v99 offset:28672
    s_waitcnt lgkmcnt(8)
    v_mfma_f32_16x16x32_bf16 v[128:131], a[112:115], a[96:99], v[128:131]
    ds_read_b64_tr_b16 a[144:145], v100 offset:16384
    buffer_load_dwordx4 a[48:51], v16, s[32:35], s64 offen offset:0 sc1
    v_mfma_f32_16x16x32_bf16 v[128:131], a[116:119], a[104:107], v[128:131]
    ds_read_b64_tr_b16 a[146:147], v100 offset:20480
    v_mfma_f32_16x16x32_bf16 v[132:135], a[116:119], a[108:111], v[132:135]
    ds_read_b64_tr_b16 a[148:149], v100 offset:24576
    v_mfma_f32_16x16x32_bf16 v[132:135], a[112:115], a[100:103], v[132:135]
    ds_read_b64_tr_b16 a[150:151], v100 offset:28672
    v_mfma_f32_16x16x32_bf16 v[140:143], a[120:123], a[100:103], v[140:143]
    ds_read_b64_tr_b16 a[152:153], v101 offset:16384
    v_mfma_f32_16x16x32_bf16 v[140:143], a[124:127], a[108:111], v[140:143]
    ds_read_b64_tr_b16 a[154:155], v101 offset:20480
    buffer_load_dwordx4 v8, s[28:31], s75 offen offset:2048  lds
    v_mfma_f32_16x16x32_bf16 v[136:139], a[124:127], a[104:107], v[136:139]
    ds_read_b64_tr_b16 a[156:157], v101 offset:24576
    v_mfma_f32_16x16x32_bf16 v[136:139], a[120:123], a[96:99], v[136:139]
    ds_read_b64_tr_b16 a[158:159], v101 offset:28672
    s_waitcnt lgkmcnt(8)
    v_mfma_f32_16x16x32_bf16 v[144:147], a[128:131], a[96:99], v[144:147]
    ds_read_b64_tr_b16 a[160:161], v102 offset:16384
    buffer_load_dwordx4 a[52:55], v16, s[32:35], s64 offen offset:1024 sc1
    v_mfma_f32_16x16x32_bf16 v[144:147], a[132:135], a[104:107], v[144:147]
    ds_read_b64_tr_b16 a[162:163], v102 offset:20480
    v_mfma_f32_16x16x32_bf16 v[148:151], a[132:135], a[108:111], v[148:151]
    ds_read_b64_tr_b16 a[164:165], v102 offset:24576
    v_mfma_f32_16x16x32_bf16 v[148:151], a[128:131], a[100:103], v[148:151]
    ds_read_b64_tr_b16 a[166:167], v102 offset:28672
    v_mfma_f32_16x16x32_bf16 v[156:159], a[136:139], a[100:103], v[156:159]
    ds_read_b64_tr_b16 a[168:169], v103 offset:16384
    v_mfma_f32_16x16x32_bf16 v[156:159], a[140:143], a[108:111], v[156:159]
    ds_read_b64_tr_b16 a[170:171], v103 offset:20480
    buffer_load_dwordx4 v9, s[28:31], s75 offen offset:3072  lds
    v_mfma_f32_16x16x32_bf16 v[152:155], a[140:143], a[104:107], v[152:155]
    ds_read_b64_tr_b16 a[172:173], v103 offset:24576
    s_add_u32 s75, s75, 262144
    v_mfma_f32_16x16x32_bf16 v[152:155], a[136:139], a[96:99], v[152:155]
    ds_read_b64_tr_b16 a[174:175], v103 offset:28672
    s_waitcnt vmcnt(17) lgkmcnt(8)
    s_barrier
    v_mfma_f32_16x16x32_bf16 v[160:163], a[144:147], a[96:99], v[160:163]
    ds_read_b64_tr_b16 a[112:113], v116 offset:32768
    buffer_load_dwordx4 a[56:59], v16, s[32:35], s64 offen offset:2048 sc1
    v_mfma_f32_16x16x32_bf16 v[160:163], a[148:151], a[104:107], v[160:163]
    ds_read_b64_tr_b16 a[114:115], v116 offset:34816
    v_mfma_f32_16x16x32_bf16 v[164:167], a[148:151], a[108:111], v[164:167]
    ds_read_b64_tr_b16 a[116:117], v116 offset:36864
    v_mfma_f32_16x16x32_bf16 v[164:167], a[144:147], a[100:103], v[164:167]
    ds_read_b64_tr_b16 a[118:119], v116 offset:38912
    v_mfma_f32_16x16x32_bf16 v[172:175], a[152:155], a[100:103], v[172:175]
    ds_read_b64_tr_b16 a[120:121], v117 offset:32768
    s_add_u32 m0, s88, 49152
    v_mfma_f32_16x16x32_bf16 v[172:175], a[156:159], a[108:111], v[172:175]
    ds_read_b64_tr_b16 a[122:123], v117 offset:34816
    buffer_load_dwordx4 v6, s[28:31], s75 offen offset:0  lds
    v_mfma_f32_16x16x32_bf16 v[168:171], a[156:159], a[104:107], v[168:171]
    ds_read_b64_tr_b16 a[124:125], v117 offset:36864
    v_mfma_f32_16x16x32_bf16 v[168:171], a[152:155], a[96:99], v[168:171]
    ds_read_b64_tr_b16 a[126:127], v117 offset:38912
    s_waitcnt lgkmcnt(8)
    v_mfma_f32_16x16x32_bf16 v[176:179], a[160:163], a[96:99], v[176:179]
    ds_read_b64_tr_b16 a[128:129], v118 offset:32768
    buffer_load_dwordx4 a[60:63], v16, s[32:35], s64 offen offset:3072 sc1
    v_mfma_f32_16x16x32_bf16 v[176:179], a[164:167], a[104:107], v[176:179]
    ds_read_b64_tr_b16 a[130:131], v118 offset:34816
    v_mfma_f32_16x16x32_bf16 v[180:183], a[164:167], a[108:111], v[180:183]
    ds_read_b64_tr_b16 a[132:133], v118 offset:36864
    s_add_u32 s64, s64, 4096
    v_mfma_f32_16x16x32_bf16 v[180:183], a[160:163], a[100:103], v[180:183]
    ds_read_b64_tr_b16 a[134:135], v118 offset:38912
    v_mfma_f32_16x16x32_bf16 v[188:191], a[168:171], a[100:103], v[188:191]
    ds_read_b64_tr_b16 a[136:137], v119 offset:32768
    v_mfma_f32_16x16x32_bf16 v[188:191], a[172:175], a[108:111], v[188:191]
    ds_read_b64_tr_b16 a[138:139], v119 offset:34816
    buffer_load_dwordx4 v7, s[28:31], s75 offen offset:1024  lds
    v_mfma_f32_16x16x32_bf16 v[184:187], a[172:175], a[104:107], v[184:187]
    ds_read_b64_tr_b16 a[140:141], v119 offset:36864
    v_mfma_f32_16x16x32_bf16 v[184:187], a[168:171], a[96:99], v[184:187]
    ds_read_b64_tr_b16 a[142:143], v119 offset:38912
    s_waitcnt lgkmcnt(8)
    v_mfma_f32_16x16x32_bf16 v[192:195], a[112:115], a[0:3], 0
    ds_read_b64_tr_b16 a[144:145], v116 offset:40960
    buffer_load_dwordx4 a[64:67], v16, s[32:35], s64 offen offset:0 sc1
    v_mfma_f32_16x16x32_bf16 v[192:195], a[116:119], a[8:11], v[192:195]
    ds_read_b64_tr_b16 a[146:147], v116 offset:43008
    v_mfma_f32_16x16x32_bf16 v[196:199], a[116:119], a[12:15], 0
    ds_read_b64_tr_b16 a[148:149], v116 offset:45056
    v_mfma_f32_16x16x32_bf16 v[196:199], a[112:115], a[4:7], v[196:199]
    ds_read_b64_tr_b16 a[150:151], v116 offset:47104
    v_mfma_f32_16x16x32_bf16 v[204:207], a[120:123], a[4:7], 0
    ds_read_b64_tr_b16 a[152:153], v117 offset:40960
    buffer_load_dwordx4 a[68:71], v16, s[32:35], s64 offen offset:1024 sc1
    v_mfma_f32_16x16x32_bf16 v[204:207], a[124:127], a[12:15], v[204:207]
    ds_read_b64_tr_b16 a[154:155], v117 offset:43008
    buffer_load_dwordx4 v8, s[28:31], s75 offen offset:2048  lds
    v_mfma_f32_16x16x32_bf16 v[200:203], a[124:127], a[8:11], 0
    ds_read_b64_tr_b16 a[156:157], v117 offset:45056
    v_mfma_f32_16x16x32_bf16 v[200:203], a[120:123], a[0:3], v[200:203]
    ds_read_b64_tr_b16 a[158:159], v117 offset:47104
    s_waitcnt lgkmcnt(8)
    v_mfma_f32_16x16x32_bf16 v[208:211], a[128:131], a[0:3], 0
    ds_read_b64_tr_b16 a[160:161], v118 offset:40960
    buffer_load_dwordx4 a[72:75], v16, s[32:35], s64 offen offset:2048 sc1
    v_cvt_pk_bf16_f32 v160, v160, v161
    v_cvt_pk_bf16_f32 v161, v162, v163
    v_mfma_f32_16x16x32_bf16 v[208:211], a[132:135], a[8:11], v[208:211]
    ds_read_b64_tr_b16 a[162:163], v118 offset:43008
    v_cvt_pk_bf16_f32 v162, v164, v165
    v_cvt_pk_bf16_f32 v163, v166, v167
    v_mfma_f32_16x16x32_bf16 v[212:215], a[132:135], a[12:15], 0
    ds_read_b64_tr_b16 a[164:165], v118 offset:45056
    v_cvt_pk_bf16_f32 v164, v168, v169
    v_cvt_pk_bf16_f32 v165, v170, v171
    v_mfma_f32_16x16x32_bf16 v[212:215], a[128:131], a[4:7], v[212:215]
    ds_read_b64_tr_b16 a[166:167], v118 offset:47104
    v_cvt_pk_bf16_f32 v166, v172, v173
    v_cvt_pk_bf16_f32 v167, v174, v175
    v_mfma_f32_16x16x32_bf16 v[220:223], a[136:139], a[4:7], 0
    ds_read_b64_tr_b16 a[168:169], v119 offset:40960
    buffer_load_dwordx4 a[76:79], v16, s[32:35], s64 offen offset:3072 sc1
    v_cvt_pk_bf16_f32 v168, v176, v177
    v_cvt_pk_bf16_f32 v169, v178, v179
    v_mfma_f32_16x16x32_bf16 v[220:223], a[140:143], a[12:15], v[220:223]
    ds_read_b64_tr_b16 a[170:171], v119 offset:43008
    buffer_load_dwordx4 v9, s[28:31], s75 offen offset:3072  lds
    v_cvt_pk_bf16_f32 v170, v180, v181
    v_cvt_pk_bf16_f32 v171, v182, v183
    v_mfma_f32_16x16x32_bf16 v[216:219], a[140:143], a[8:11], 0
    ds_read_b64_tr_b16 a[172:173], v119 offset:45056
    s_add_u32 s64, s64, 4096
    s_add_u32 s75, s75, 262144
    v_cvt_pk_bf16_f32 v172, v184, v185
    v_cvt_pk_bf16_f32 v173, v186, v187
    v_mfma_f32_16x16x32_bf16 v[216:219], a[136:139], a[0:3], v[216:219]
    ds_read_b64_tr_b16 a[174:175], v119 offset:47104
    v_cvt_pk_bf16_f32 v174, v188, v189
    v_cvt_pk_bf16_f32 v175, v190, v191
    s_waitcnt vmcnt(15) lgkmcnt(8)
    s_barrier
    v_mfma_f32_16x16x32_bf16 v[192:195], a[144:147], a[16:19], v[192:195]
    ds_read_b64_tr_b16 a[112:113], v116 offset:49152
    buffer_load_dwordx4 a[80:83], v16, s[32:35], s64 offen offset:0 sc1
    v_mfma_f32_16x16x32_bf16 v[192:195], a[148:151], a[24:27], v[192:195]
    ds_read_b64_tr_b16 a[114:115], v116 offset:51200
    v_mfma_f32_16x16x32_bf16 v[196:199], a[148:151], a[28:31], v[196:199]
    ds_read_b64_tr_b16 a[116:117], v116 offset:53248
    v_mfma_f32_16x16x32_bf16 v[196:199], a[144:147], a[20:23], v[196:199]
    ds_read_b64_tr_b16 a[118:119], v116 offset:55296
    v_mfma_f32_16x16x32_bf16 v[204:207], a[152:155], a[20:23], v[204:207]
    ds_read_b64_tr_b16 a[120:121], v117 offset:49152
    buffer_load_dwordx4 a[84:87], v16, s[32:35], s64 offen offset:1024 sc1
    v_mfma_f32_16x16x32_bf16 v[204:207], a[156:159], a[28:31], v[204:207]
    ds_read_b64_tr_b16 a[122:123], v117 offset:51200
    buffer_store_dwordx4 v[160:163], v16, s[40:43], s67 offen offset:0 sc1
    v_mfma_f32_16x16x32_bf16 v[200:203], a[156:159], a[24:27], v[200:203]
    ds_read_b64_tr_b16 a[124:125], v117 offset:53248
    v_mfma_f32_16x16x32_bf16 v[200:203], a[152:155], a[16:19], v[200:203]
    ds_read_b64_tr_b16 a[126:127], v117 offset:55296
    s_waitcnt lgkmcnt(8)
    v_mfma_f32_16x16x32_bf16 v[208:211], a[160:163], a[16:19], v[208:211]
    ds_read_b64_tr_b16 a[128:129], v118 offset:49152
    buffer_load_dwordx4 a[88:91], v16, s[32:35], s64 offen offset:2048 sc1
    v_mfma_f32_16x16x32_bf16 v[208:211], a[164:167], a[24:27], v[208:211]
    ds_read_b64_tr_b16 a[130:131], v118 offset:51200
    v_mfma_f32_16x16x32_bf16 v[212:215], a[164:167], a[28:31], v[212:215]
    ds_read_b64_tr_b16 a[132:133], v118 offset:53248
    v_mfma_f32_16x16x32_bf16 v[212:215], a[160:163], a[20:23], v[212:215]
    ds_read_b64_tr_b16 a[134:135], v118 offset:55296
    buffer_store_dwordx4 v[164:167], v16, s[40:43], s67 offen offset:1024 sc1
    v_mfma_f32_16x16x32_bf16 v[220:223], a[168:171], a[20:23], v[220:223]
    ds_read_b64_tr_b16 a[136:137], v119 offset:49152
    buffer_load_dwordx4 a[92:95], v16, s[32:35], s64 offen offset:3072 sc1
    v_mfma_f32_16x16x32_bf16 v[220:223], a[172:175], a[28:31], v[220:223]
    ds_read_b64_tr_b16 a[138:139], v119 offset:51200
    v_mfma_f32_16x16x32_bf16 v[216:219], a[172:175], a[24:27], v[216:219]
    ds_read_b64_tr_b16 a[140:141], v119 offset:53248
    s_add_u32 s64, s64, 4096
    v_mfma_f32_16x16x32_bf16 v[216:219], a[168:171], a[16:19], v[216:219]
    ds_read_b64_tr_b16 a[142:143], v119 offset:55296
    s_waitcnt lgkmcnt(8)
    v_mfma_f32_16x16x32_bf16 v[192:195], a[112:115], a[32:35], v[192:195]
    ds_read_b64_tr_b16 a[144:145], v116 offset:57344
    buffer_load_dwordx4 a[96:99], v16, s[32:35], s64 offen offset:0 sc1
    v_mfma_f32_16x16x32_bf16 v[192:195], a[116:119], a[40:43], v[192:195]
    ds_read_b64_tr_b16 a[146:147], v116 offset:59392
    buffer_store_dwordx4 v[168:171], v16, s[40:43], s67 offen offset:2048 sc1
    v_mfma_f32_16x16x32_bf16 v[196:199], a[116:119], a[44:47], v[196:199]
    ds_read_b64_tr_b16 a[148:149], v116 offset:61440
    v_mfma_f32_16x16x32_bf16 v[196:199], a[112:115], a[36:39], v[196:199]
    ds_read_b64_tr_b16 a[150:151], v116 offset:63488
    v_mfma_f32_16x16x32_bf16 v[204:207], a[120:123], a[36:39], v[204:207]
    ds_read_b64_tr_b16 a[152:153], v117 offset:57344
    buffer_load_dwordx4 a[100:103], v16, s[32:35], s64 offen offset:1024 sc1
    v_mfma_f32_16x16x32_bf16 v[204:207], a[124:127], a[44:47], v[204:207]
    ds_read_b64_tr_b16 a[154:155], v117 offset:59392
    v_mfma_f32_16x16x32_bf16 v[200:203], a[124:127], a[40:43], v[200:203]
    ds_read_b64_tr_b16 a[156:157], v117 offset:61440
    v_mfma_f32_16x16x32_bf16 v[200:203], a[120:123], a[32:35], v[200:203]
    ds_read_b64_tr_b16 a[158:159], v117 offset:63488
    buffer_store_dwordx4 v[172:175], v16, s[40:43], s67 offen offset:3072 sc1
    s_waitcnt lgkmcnt(8)
    v_mfma_f32_16x16x32_bf16 v[208:211], a[128:131], a[32:35], v[208:211]
    ds_read_b64_tr_b16 a[160:161], v118 offset:57344
    buffer_load_dwordx4 a[104:107], v16, s[32:35], s64 offen offset:2048 sc1
    v_mfma_f32_16x16x32_bf16 v[208:211], a[132:135], a[40:43], v[208:211]
    ds_read_b64_tr_b16 a[162:163], v118 offset:59392
    v_mfma_f32_16x16x32_bf16 v[212:215], a[132:135], a[44:47], v[212:215]
    ds_read_b64_tr_b16 a[164:165], v118 offset:61440
    v_mfma_f32_16x16x32_bf16 v[212:215], a[128:131], a[36:39], v[212:215]
    ds_read_b64_tr_b16 a[166:167], v118 offset:63488
    v_mfma_f32_16x16x32_bf16 v[220:223], a[136:139], a[36:39], v[220:223]
    ds_read_b64_tr_b16 a[168:169], v119 offset:57344
    buffer_load_dwordx4 a[108:111], v16, s[32:35], s64 offen offset:3072 sc1
    v_mfma_f32_16x16x32_bf16 v[220:223], a[140:143], a[44:47], v[220:223]
    ds_read_b64_tr_b16 a[170:171], v119 offset:59392
    v_mfma_f32_16x16x32_bf16 v[216:219], a[140:143], a[40:43], v[216:219]
    ds_read_b64_tr_b16 a[172:173], v119 offset:61440
    s_add_u32 s64, s64, 4096
    v_mfma_f32_16x16x32_bf16 v[216:219], a[136:139], a[32:35], v[216:219]
    ds_read_b64_tr_b16 a[174:175], v119 offset:63488
    s_waitcnt vmcnt(13) lgkmcnt(8)
    s_barrier
    v_mfma_f32_16x16x32_bf16 v[192:195], a[144:147], a[48:51], v[192:195]
    ds_read_b64_tr_b16 a[112:113], v120 offset:0
    buffer_load_dwordx4 a[0:3], v16, s[32:35], s64 offen offset:0 sc1
    v_mfma_f32_16x16x32_bf16 v[192:195], a[148:151], a[56:59], v[192:195]
    ds_read_b64_tr_b16 a[114:115], v120 offset:2048
    v_mfma_f32_16x16x32_bf16 v[196:199], a[148:151], a[60:63], v[196:199]
    ds_read_b64_tr_b16 a[116:117], v120 offset:4096
    v_mfma_f32_16x16x32_bf16 v[196:199], a[144:147], a[52:55], v[196:199]
    ds_read_b64_tr_b16 a[118:119], v120 offset:6144
    v_mfma_f32_16x16x32_bf16 v[204:207], a[152:155], a[52:55], v[204:207]
    ds_read_b64_tr_b16 a[120:121], v121 offset:0
    buffer_load_dwordx4 a[4:7], v16, s[32:35], s64 offen offset:1024 sc1
    v_mfma_f32_16x16x32_bf16 v[204:207], a[156:159], a[60:63], v[204:207]
    ds_read_b64_tr_b16 a[122:123], v121 offset:2048
    v_mfma_f32_16x16x32_bf16 v[200:203], a[156:159], a[56:59], v[200:203]
    ds_read_b64_tr_b16 a[124:125], v121 offset:4096
    v_mfma_f32_16x16x32_bf16 v[200:203], a[152:155], a[48:51], v[200:203]
    ds_read_b64_tr_b16 a[126:127], v121 offset:6144
    s_waitcnt lgkmcnt(8)
    v_mfma_f32_16x16x32_bf16 v[208:211], a[160:163], a[48:51], v[208:211]
    ds_read_b64_tr_b16 a[128:129], v122 offset:0
    buffer_load_dwordx4 a[8:11], v16, s[32:35], s64 offen offset:2048 sc1
    v_mfma_f32_16x16x32_bf16 v[208:211], a[164:167], a[56:59], v[208:211]
    ds_read_b64_tr_b16 a[130:131], v122 offset:2048
    v_mfma_f32_16x16x32_bf16 v[212:215], a[164:167], a[60:63], v[212:215]
    ds_read_b64_tr_b16 a[132:133], v122 offset:4096
    v_mfma_f32_16x16x32_bf16 v[212:215], a[160:163], a[52:55], v[212:215]
    ds_read_b64_tr_b16 a[134:135], v122 offset:6144
    v_mfma_f32_16x16x32_bf16 v[220:223], a[168:171], a[52:55], v[220:223]
    ds_read_b64_tr_b16 a[136:137], v123 offset:0
    buffer_load_dwordx4 a[12:15], v16, s[32:35], s64 offen offset:3072 sc1
    v_mfma_f32_16x16x32_bf16 v[220:223], a[172:175], a[60:63], v[220:223]
    ds_read_b64_tr_b16 a[138:139], v123 offset:2048
    v_mfma_f32_16x16x32_bf16 v[216:219], a[172:175], a[56:59], v[216:219]
    ds_read_b64_tr_b16 a[140:141], v123 offset:4096
    s_add_u32 s64, s64, 4096
    v_mfma_f32_16x16x32_bf16 v[216:219], a[168:171], a[48:51], v[216:219]
    ds_read_b64_tr_b16 a[142:143], v123 offset:6144
    s_waitcnt lgkmcnt(8)
    v_mfma_f32_16x16x32_bf16 v[192:195], a[112:115], a[64:67], v[192:195]
    ds_read_b64_tr_b16 a[144:145], v120 offset:8192
    buffer_load_dwordx4 a[16:19], v16, s[32:35], s64 offen offset:0 sc1
    v_mfma_f32_16x16x32_bf16 v[192:195], a[116:119], a[72:75], v[192:195]
    ds_read_b64_tr_b16 a[146:147], v120 offset:10240
    v_mfma_f32_16x16x32_bf16 v[196:199], a[116:119], a[76:79], v[196:199]
    ds_read_b64_tr_b16 a[148:149], v120 offset:12288
    v_mfma_f32_16x16x32_bf16 v[196:199], a[112:115], a[68:71], v[196:199]
    ds_read_b64_tr_b16 a[150:151], v120 offset:14336
    v_mfma_f32_16x16x32_bf16 v[204:207], a[120:123], a[68:71], v[204:207]
    ds_read_b64_tr_b16 a[152:153], v121 offset:8192
    buffer_load_dwordx4 a[20:23], v16, s[32:35], s64 offen offset:1024 sc1
    v_mfma_f32_16x16x32_bf16 v[204:207], a[124:127], a[76:79], v[204:207]
    ds_read_b64_tr_b16 a[154:155], v121 offset:10240
    v_mfma_f32_16x16x32_bf16 v[200:203], a[124:127], a[72:75], v[200:203]
    ds_read_b64_tr_b16 a[156:157], v121 offset:12288
    v_mfma_f32_16x16x32_bf16 v[200:203], a[120:123], a[64:67], v[200:203]
    ds_read_b64_tr_b16 a[158:159], v121 offset:14336
    s_waitcnt lgkmcnt(8)
    v_mfma_f32_16x16x32_bf16 v[208:211], a[128:131], a[64:67], v[208:211]
    ds_read_b64_tr_b16 a[160:161], v122 offset:8192
    buffer_load_dwordx4 a[24:27], v16, s[32:35], s64 offen offset:2048 sc1
    v_mfma_f32_16x16x32_bf16 v[208:211], a[132:135], a[72:75], v[208:211]
    ds_read_b64_tr_b16 a[162:163], v122 offset:10240
    v_mfma_f32_16x16x32_bf16 v[212:215], a[132:135], a[76:79], v[212:215]
    ds_read_b64_tr_b16 a[164:165], v122 offset:12288
    v_mfma_f32_16x16x32_bf16 v[212:215], a[128:131], a[68:71], v[212:215]
    ds_read_b64_tr_b16 a[166:167], v122 offset:14336
    v_mfma_f32_16x16x32_bf16 v[220:223], a[136:139], a[68:71], v[220:223]
    ds_read_b64_tr_b16 a[168:169], v123 offset:8192
    buffer_load_dwordx4 a[28:31], v16, s[32:35], s64 offen offset:3072 sc1
    v_mfma_f32_16x16x32_bf16 v[220:223], a[140:143], a[76:79], v[220:223]
    ds_read_b64_tr_b16 a[170:171], v123 offset:10240
    v_mfma_f32_16x16x32_bf16 v[216:219], a[140:143], a[72:75], v[216:219]
    ds_read_b64_tr_b16 a[172:173], v123 offset:12288
    s_add_u32 s64, s64, 4096
    v_mfma_f32_16x16x32_bf16 v[216:219], a[136:139], a[64:67], v[216:219]
    ds_read_b64_tr_b16 a[174:175], v123 offset:14336
    s_waitcnt vmcnt(8) lgkmcnt(8)
    s_barrier
    v_mfma_f32_16x16x32_bf16 v[192:195], a[144:147], a[80:83], v[192:195]
    ds_read_b64_tr_b16 a[112:113], v112 offset:0
    buffer_load_dwordx4 a[32:35], v16, s[32:35], s64 offen offset:0 sc1
    v_mfma_f32_16x16x32_bf16 v[192:195], a[148:151], a[88:91], v[192:195]
    ds_read_b64_tr_b16 a[114:115], v112 offset:2048
    v_mfma_f32_16x16x32_bf16 v[196:199], a[148:151], a[92:95], v[196:199]
    ds_read_b64_tr_b16 a[116:117], v112 offset:4096
    v_mfma_f32_16x16x32_bf16 v[196:199], a[144:147], a[84:87], v[196:199]
    ds_read_b64_tr_b16 a[118:119], v112 offset:6144
    v_mfma_f32_16x16x32_bf16 v[204:207], a[152:155], a[84:87], v[204:207]
    ds_read_b64_tr_b16 a[120:121], v113 offset:0
    buffer_load_dwordx4 a[36:39], v16, s[32:35], s64 offen offset:1024 sc1
    v_mfma_f32_16x16x32_bf16 v[204:207], a[156:159], a[92:95], v[204:207]
    ds_read_b64_tr_b16 a[122:123], v113 offset:2048
    v_mfma_f32_16x16x32_bf16 v[200:203], a[156:159], a[88:91], v[200:203]
    ds_read_b64_tr_b16 a[124:125], v113 offset:4096
    v_mfma_f32_16x16x32_bf16 v[200:203], a[152:155], a[80:83], v[200:203]
    ds_read_b64_tr_b16 a[126:127], v113 offset:6144
    s_waitcnt lgkmcnt(8)
    v_mfma_f32_16x16x32_bf16 v[208:211], a[160:163], a[80:83], v[208:211]
    ds_read_b64_tr_b16 a[128:129], v114 offset:0
    buffer_load_dwordx4 a[40:43], v16, s[32:35], s64 offen offset:2048 sc1
    v_mfma_f32_16x16x32_bf16 v[208:211], a[164:167], a[88:91], v[208:211]
    ds_read_b64_tr_b16 a[130:131], v114 offset:2048
    v_mfma_f32_16x16x32_bf16 v[212:215], a[164:167], a[92:95], v[212:215]
    ds_read_b64_tr_b16 a[132:133], v114 offset:4096
    v_mfma_f32_16x16x32_bf16 v[212:215], a[160:163], a[84:87], v[212:215]
    ds_read_b64_tr_b16 a[134:135], v114 offset:6144
    v_mfma_f32_16x16x32_bf16 v[220:223], a[168:171], a[84:87], v[220:223]
    ds_read_b64_tr_b16 a[136:137], v115 offset:0
    buffer_load_dwordx4 a[44:47], v16, s[32:35], s64 offen offset:3072 sc1
    v_mfma_f32_16x16x32_bf16 v[220:223], a[172:175], a[92:95], v[220:223]
    ds_read_b64_tr_b16 a[138:139], v115 offset:2048
    v_mfma_f32_16x16x32_bf16 v[216:219], a[172:175], a[88:91], v[216:219]
    ds_read_b64_tr_b16 a[140:141], v115 offset:4096
    s_add_u32 s64, s64, 4096
    v_mfma_f32_16x16x32_bf16 v[216:219], a[168:171], a[80:83], v[216:219]
    ds_read_b64_tr_b16 a[142:143], v115 offset:6144
    s_waitcnt lgkmcnt(8)
    v_mfma_f32_16x16x32_bf16 v[192:195], a[112:115], a[96:99], v[192:195]
    ds_read_b64_tr_b16 a[144:145], v112 offset:8192
    buffer_load_dwordx4 a[48:51], v16, s[32:35], s64 offen offset:0 sc1
    v_mfma_f32_16x16x32_bf16 v[192:195], a[116:119], a[104:107], v[192:195]
    ds_read_b64_tr_b16 a[146:147], v112 offset:10240
    v_mfma_f32_16x16x32_bf16 v[196:199], a[116:119], a[108:111], v[196:199]
    ds_read_b64_tr_b16 a[148:149], v112 offset:12288
    v_mfma_f32_16x16x32_bf16 v[196:199], a[112:115], a[100:103], v[196:199]
    ds_read_b64_tr_b16 a[150:151], v112 offset:14336
    v_mfma_f32_16x16x32_bf16 v[204:207], a[120:123], a[100:103], v[204:207]
    ds_read_b64_tr_b16 a[152:153], v113 offset:8192
    buffer_load_dwordx4 a[52:55], v16, s[32:35], s64 offen offset:1024 sc1
    v_mfma_f32_16x16x32_bf16 v[204:207], a[124:127], a[108:111], v[204:207]
    ds_read_b64_tr_b16 a[154:155], v113 offset:10240
    v_mfma_f32_16x16x32_bf16 v[200:203], a[124:127], a[104:107], v[200:203]
    ds_read_b64_tr_b16 a[156:157], v113 offset:12288
    v_mfma_f32_16x16x32_bf16 v[200:203], a[120:123], a[96:99], v[200:203]
    ds_read_b64_tr_b16 a[158:159], v113 offset:14336
    s_waitcnt lgkmcnt(8)
    v_mfma_f32_16x16x32_bf16 v[208:211], a[128:131], a[96:99], v[208:211]
    ds_read_b64_tr_b16 a[160:161], v114 offset:8192
    buffer_load_dwordx4 a[56:59], v16, s[32:35], s64 offen offset:2048 sc1
    v_mfma_f32_16x16x32_bf16 v[208:211], a[132:135], a[104:107], v[208:211]
    ds_read_b64_tr_b16 a[162:163], v114 offset:10240
    v_mfma_f32_16x16x32_bf16 v[212:215], a[132:135], a[108:111], v[212:215]
    ds_read_b64_tr_b16 a[164:165], v114 offset:12288
    v_mfma_f32_16x16x32_bf16 v[212:215], a[128:131], a[100:103], v[212:215]
    ds_read_b64_tr_b16 a[166:167], v114 offset:14336
    v_mov_b32 v76, s92
    v_mov_b32 v77, s93
    v_mov_b32 v78, s92
    v_mov_b32 v79, s93
    s_mov_b64 exec, 0xff
    buffer_store_dwordx4 v[76:79], v16, s[40:43], s74 offen sc0 sc1
    s_mov_b64 exec, -1
    s_nop 0
    v_mfma_f32_16x16x32_bf16 v[220:223], a[136:139], a[100:103], v[220:223]
    ds_read_b64_tr_b16 a[168:169], v115 offset:8192
    buffer_load_dwordx4 a[60:63], v16, s[32:35], s64 offen offset:3072 sc1
    v_mfma_f32_16x16x32_bf16 v[220:223], a[140:143], a[108:111], v[220:223]
    ds_read_b64_tr_b16 a[170:171], v115 offset:10240
    v_mfma_f32_16x16x32_bf16 v[216:219], a[140:143], a[104:107], v[216:219]
    ds_read_b64_tr_b16 a[172:173], v115 offset:12288
    s_add_u32 s64, s64, 4096
    v_mfma_f32_16x16x32_bf16 v[216:219], a[136:139], a[96:99], v[216:219]
    ds_read_b64_tr_b16 a[174:175], v115 offset:14336
    s_waitcnt vmcnt(9) lgkmcnt(8)
    s_barrier
    v_mfma_f32_16x16x32_bf16 v[192:195], a[144:147], a[0:3], v[192:195]
    ds_read_b64_tr_b16 a[112:113], v112 offset:16384
    buffer_load_dwordx4 a[64:67], v16, s[32:35], s64 offen offset:0 sc1
    v_mfma_f32_16x16x32_bf16 v[192:195], a[148:151], a[8:11], v[192:195]
    ds_read_b64_tr_b16 a[114:115], v112 offset:18432
    v_mfma_f32_16x16x32_bf16 v[196:199], a[148:151], a[12:15], v[196:199]
    ds_read_b64_tr_b16 a[116:117], v112 offset:20480
    v_mfma_f32_16x16x32_bf16 v[196:199], a[144:147], a[4:7], v[196:199]
    ds_read_b64_tr_b16 a[118:119], v112 offset:22528
    v_mfma_f32_16x16x32_bf16 v[204:207], a[152:155], a[4:7], v[204:207]
    ds_read_b64_tr_b16 a[120:121], v113 offset:16384
    buffer_load_dwordx4 a[68:71], v16, s[32:35], s64 offen offset:1024 sc1
    v_mfma_f32_16x16x32_bf16 v[204:207], a[156:159], a[12:15], v[204:207]
    ds_read_b64_tr_b16 a[122:123], v113 offset:18432
    v_mfma_f32_16x16x32_bf16 v[200:203], a[156:159], a[8:11], v[200:203]
    ds_read_b64_tr_b16 a[124:125], v113 offset:20480
    v_mfma_f32_16x16x32_bf16 v[200:203], a[152:155], a[0:3], v[200:203]
    ds_read_b64_tr_b16 a[126:127], v113 offset:22528
    s_waitcnt lgkmcnt(8)
    v_mfma_f32_16x16x32_bf16 v[208:211], a[160:163], a[0:3], v[208:211]
    ds_read_b64_tr_b16 a[128:129], v114 offset:16384
    buffer_load_dwordx4 a[72:75], v16, s[32:35], s64 offen offset:2048 sc1
    v_mfma_f32_16x16x32_bf16 v[208:211], a[164:167], a[8:11], v[208:211]
    ds_read_b64_tr_b16 a[130:131], v114 offset:18432
    v_mfma_f32_16x16x32_bf16 v[212:215], a[164:167], a[12:15], v[212:215]
    ds_read_b64_tr_b16 a[132:133], v114 offset:20480
    v_mfma_f32_16x16x32_bf16 v[212:215], a[160:163], a[4:7], v[212:215]
    ds_read_b64_tr_b16 a[134:135], v114 offset:22528
    v_mfma_f32_16x16x32_bf16 v[220:223], a[168:171], a[4:7], v[220:223]
    ds_read_b64_tr_b16 a[136:137], v115 offset:16384
    buffer_load_dwordx4 a[76:79], v16, s[32:35], s64 offen offset:3072 sc1
    v_mfma_f32_16x16x32_bf16 v[220:223], a[172:175], a[12:15], v[220:223]
    ds_read_b64_tr_b16 a[138:139], v115 offset:18432
    v_mfma_f32_16x16x32_bf16 v[216:219], a[172:175], a[8:11], v[216:219]
    ds_read_b64_tr_b16 a[140:141], v115 offset:20480
    s_add_u32 s64, s64, 4096
    v_mfma_f32_16x16x32_bf16 v[216:219], a[168:171], a[0:3], v[216:219]
    ds_read_b64_tr_b16 a[142:143], v115 offset:22528
    s_waitcnt lgkmcnt(8)
    v_mfma_f32_16x16x32_bf16 v[192:195], a[112:115], a[16:19], v[192:195]
    ds_read_b64_tr_b16 a[144:145], v112 offset:24576
    buffer_load_dwordx4 a[80:83], v16, s[32:35], s64 offen offset:0 sc1
    v_mfma_f32_16x16x32_bf16 v[192:195], a[116:119], a[24:27], v[192:195]
    ds_read_b64_tr_b16 a[146:147], v112 offset:26624
    v_mfma_f32_16x16x32_bf16 v[196:199], a[116:119], a[28:31], v[196:199]
    ds_read_b64_tr_b16 a[148:149], v112 offset:28672
    v_mfma_f32_16x16x32_bf16 v[196:199], a[112:115], a[20:23], v[196:199]
    ds_read_b64_tr_b16 a[150:151], v112 offset:30720
    v_mfma_f32_16x16x32_bf16 v[204:207], a[120:123], a[20:23], v[204:207]
    ds_read_b64_tr_b16 a[152:153], v113 offset:24576
    buffer_load_dwordx4 a[84:87], v16, s[32:35], s64 offen offset:1024 sc1
    v_mfma_f32_16x16x32_bf16 v[204:207], a[124:127], a[28:31], v[204:207]
    ds_read_b64_tr_b16 a[154:155], v113 offset:26624
    v_mfma_f32_16x16x32_bf16 v[200:203], a[124:127], a[24:27], v[200:203]
    ds_read_b64_tr_b16 a[156:157], v113 offset:28672
    v_mfma_f32_16x16x32_bf16 v[200:203], a[120:123], a[16:19], v[200:203]
    ds_read_b64_tr_b16 a[158:159], v113 offset:30720
    s_waitcnt lgkmcnt(8)
    v_mfma_f32_16x16x32_bf16 v[208:211], a[128:131], a[16:19], v[208:211]
    ds_read_b64_tr_b16 a[160:161], v114 offset:24576
    buffer_load_dwordx4 a[88:91], v16, s[32:35], s64 offen offset:2048 sc1
    v_mfma_f32_16x16x32_bf16 v[208:211], a[132:135], a[24:27], v[208:211]
    ds_read_b64_tr_b16 a[162:163], v114 offset:26624
    v_mfma_f32_16x16x32_bf16 v[212:215], a[132:135], a[28:31], v[212:215]
    ds_read_b64_tr_b16 a[164:165], v114 offset:28672
    v_mfma_f32_16x16x32_bf16 v[212:215], a[128:131], a[20:23], v[212:215]
    ds_read_b64_tr_b16 a[166:167], v114 offset:30720
    v_mfma_f32_16x16x32_bf16 v[220:223], a[136:139], a[20:23], v[220:223]
    ds_read_b64_tr_b16 a[168:169], v115 offset:24576
    buffer_load_dwordx4 a[92:95], v16, s[32:35], s64 offen offset:3072 sc1
    v_mfma_f32_16x16x32_bf16 v[220:223], a[140:143], a[28:31], v[220:223]
    ds_read_b64_tr_b16 a[170:171], v115 offset:26624
    v_mfma_f32_16x16x32_bf16 v[216:219], a[140:143], a[24:27], v[216:219]
    ds_read_b64_tr_b16 a[172:173], v115 offset:28672
    s_add_u32 s64, s64, 4096
    v_mfma_f32_16x16x32_bf16 v[216:219], a[136:139], a[16:19], v[216:219]
    ds_read_b64_tr_b16 a[174:175], v115 offset:30720
    s_waitcnt vmcnt(8) lgkmcnt(8)
    s_barrier
    v_mfma_f32_16x16x32_bf16 v[192:195], a[144:147], a[32:35], v[192:195]
    ds_read_b64_tr_b16 a[112:113], v116 offset:0
    buffer_load_dwordx4 a[96:99], v16, s[32:35], s64 offen offset:0 sc1
    v_mfma_f32_16x16x32_bf16 v[192:195], a[148:151], a[40:43], v[192:195]
    ds_read_b64_tr_b16 a[114:115], v116 offset:2048
    v_mfma_f32_16x16x32_bf16 v[196:199], a[148:151], a[44:47], v[196:199]
    ds_read_b64_tr_b16 a[116:117], v116 offset:4096
    v_mfma_f32_16x16x32_bf16 v[196:199], a[144:147], a[36:39], v[196:199]
    ds_read_b64_tr_b16 a[118:119], v116 offset:6144
    v_mfma_f32_16x16x32_bf16 v[204:207], a[152:155], a[36:39], v[204:207]
    ds_read_b64_tr_b16 a[120:121], v117 offset:0
    buffer_load_dwordx4 a[100:103], v16, s[32:35], s64 offen offset:1024 sc1
    v_mfma_f32_16x16x32_bf16 v[204:207], a[156:159], a[44:47], v[204:207]
    ds_read_b64_tr_b16 a[122:123], v117 offset:2048
    v_mfma_f32_16x16x32_bf16 v[200:203], a[156:159], a[40:43], v[200:203]
    ds_read_b64_tr_b16 a[124:125], v117 offset:4096
    v_mfma_f32_16x16x32_bf16 v[200:203], a[152:155], a[32:35], v[200:203]
    ds_read_b64_tr_b16 a[126:127], v117 offset:6144
    s_waitcnt lgkmcnt(8)
    v_mfma_f32_16x16x32_bf16 v[208:211], a[160:163], a[32:35], v[208:211]
    ds_read_b64_tr_b16 a[128:129], v118 offset:0
    buffer_load_dwordx4 a[104:107], v16, s[32:35], s64 offen offset:2048 sc1
    v_mfma_f32_16x16x32_bf16 v[208:211], a[164:167], a[40:43], v[208:211]
    ds_read_b64_tr_b16 a[130:131], v118 offset:2048
    v_mfma_f32_16x16x32_bf16 v[212:215], a[164:167], a[44:47], v[212:215]
    ds_read_b64_tr_b16 a[132:133], v118 offset:4096
    v_mfma_f32_16x16x32_bf16 v[212:215], a[160:163], a[36:39], v[212:215]
    ds_read_b64_tr_b16 a[134:135], v118 offset:6144
    v_mfma_f32_16x16x32_bf16 v[220:223], a[168:171], a[36:39], v[220:223]
    ds_read_b64_tr_b16 a[136:137], v119 offset:0
    buffer_load_dwordx4 a[108:111], v16, s[32:35], s64 offen offset:3072 sc1
    v_mfma_f32_16x16x32_bf16 v[220:223], a[172:175], a[44:47], v[220:223]
    ds_read_b64_tr_b16 a[138:139], v119 offset:2048
    v_mfma_f32_16x16x32_bf16 v[216:219], a[172:175], a[40:43], v[216:219]
    ds_read_b64_tr_b16 a[140:141], v119 offset:4096
    s_add_u32 s64, s64, 4096
    v_mfma_f32_16x16x32_bf16 v[216:219], a[168:171], a[32:35], v[216:219]
    ds_read_b64_tr_b16 a[142:143], v119 offset:6144
    s_waitcnt lgkmcnt(8)
    v_mfma_f32_16x16x32_bf16 v[192:195], a[112:115], a[48:51], v[192:195]
    ds_read_b64_tr_b16 a[144:145], v116 offset:8192
    buffer_load_dwordx4 a[0:3], v16, s[32:35], s64 offen offset:0 sc1
    v_mfma_f32_16x16x32_bf16 v[192:195], a[116:119], a[56:59], v[192:195]
    ds_read_b64_tr_b16 a[146:147], v116 offset:10240
    v_mfma_f32_16x16x32_bf16 v[196:199], a[116:119], a[60:63], v[196:199]
    ds_read_b64_tr_b16 a[148:149], v116 offset:12288
    v_mfma_f32_16x16x32_bf16 v[196:199], a[112:115], a[52:55], v[196:199]
    ds_read_b64_tr_b16 a[150:151], v116 offset:14336
    v_mov_b32 v14, 0
    buffer_load_dwordx2 v[2:3], v14, s[40:43], s69 offen sc0 sc1
    v_mfma_f32_16x16x32_bf16 v[204:207], a[120:123], a[52:55], v[204:207]
    ds_read_b64_tr_b16 a[152:153], v117 offset:8192
    buffer_load_dwordx4 a[4:7], v16, s[32:35], s64 offen offset:1024 sc1
    v_mfma_f32_16x16x32_bf16 v[204:207], a[124:127], a[60:63], v[204:207]
    ds_read_b64_tr_b16 a[154:155], v117 offset:10240
    v_mfma_f32_16x16x32_bf16 v[200:203], a[124:127], a[56:59], v[200:203]
    ds_read_b64_tr_b16 a[156:157], v117 offset:12288
    v_mfma_f32_16x16x32_bf16 v[200:203], a[120:123], a[48:51], v[200:203]
    ds_read_b64_tr_b16 a[158:159], v117 offset:14336
    s_waitcnt lgkmcnt(8)
    v_mfma_f32_16x16x32_bf16 v[208:211], a[128:131], a[48:51], v[208:211]
    ds_read_b64_tr_b16 a[160:161], v118 offset:8192
    buffer_load_dwordx4 a[8:11], v16, s[32:35], s64 offen offset:2048 sc1
    v_mfma_f32_16x16x32_bf16 v[208:211], a[132:135], a[56:59], v[208:211]
    ds_read_b64_tr_b16 a[162:163], v118 offset:10240
    v_mfma_f32_16x16x32_bf16 v[212:215], a[132:135], a[60:63], v[212:215]
    ds_read_b64_tr_b16 a[164:165], v118 offset:12288
    v_mfma_f32_16x16x32_bf16 v[212:215], a[128:131], a[52:55], v[212:215]
    ds_read_b64_tr_b16 a[166:167], v118 offset:14336
    v_mfma_f32_16x16x32_bf16 v[220:223], a[136:139], a[52:55], v[220:223]
    ds_read_b64_tr_b16 a[168:169], v119 offset:8192
    buffer_load_dwordx4 a[12:15], v16, s[32:35], s64 offen offset:3072 sc1
    v_mfma_f32_16x16x32_bf16 v[220:223], a[140:143], a[60:63], v[220:223]
    ds_read_b64_tr_b16 a[170:171], v119 offset:10240
    v_mfma_f32_16x16x32_bf16 v[216:219], a[140:143], a[56:59], v[216:219]
    ds_read_b64_tr_b16 a[172:173], v119 offset:12288
    s_add_u32 s64, s64, 4096
    v_mfma_f32_16x16x32_bf16 v[216:219], a[136:139], a[48:51], v[216:219]
    ds_read_b64_tr_b16 a[174:175], v119 offset:14336
    s_waitcnt vmcnt(9) lgkmcnt(8)
    s_barrier
    v_mfma_f32_16x16x32_bf16 v[192:195], a[144:147], a[64:67], v[192:195]
    ds_read_b64_tr_b16 a[112:113], v112 offset:32768
    buffer_load_dwordx4 a[16:19], v16, s[32:35], s64 offen offset:0 sc1
    v_mfma_f32_16x16x32_bf16 v[192:195], a[148:151], a[72:75], v[192:195]
    ds_read_b64_tr_b16 a[114:115], v112 offset:34816
    v_mfma_f32_16x16x32_bf16 v[196:199], a[148:151], a[76:79], v[196:199]
    ds_read_b64_tr_b16 a[116:117], v112 offset:36864
    v_mfma_f32_16x16x32_bf16 v[196:199], a[144:147], a[68:71], v[196:199]
    ds_read_b64_tr_b16 a[118:119], v112 offset:38912
    v_mfma_f32_16x16x32_bf16 v[204:207], a[152:155], a[68:71], v[204:207]
    ds_read_b64_tr_b16 a[120:121], v113 offset:32768
    buffer_load_dwordx4 a[20:23], v16, s[32:35], s64 offen offset:1024 sc1
    v_mfma_f32_16x16x32_bf16 v[204:207], a[156:159], a[76:79], v[204:207]
    ds_read_b64_tr_b16 a[122:123], v113 offset:34816
    v_mfma_f32_16x16x32_bf16 v[200:203], a[156:159], a[72:75], v[200:203]
    ds_read_b64_tr_b16 a[124:125], v113 offset:36864
    v_mfma_f32_16x16x32_bf16 v[200:203], a[152:155], a[64:67], v[200:203]
    ds_read_b64_tr_b16 a[126:127], v113 offset:38912
    s_waitcnt lgkmcnt(8)
    v_mfma_f32_16x16x32_bf16 v[208:211], a[160:163], a[64:67], v[208:211]
    ds_read_b64_tr_b16 a[128:129], v114 offset:32768
    buffer_load_dwordx4 a[24:27], v16, s[32:35], s64 offen offset:2048 sc1
    v_mfma_f32_16x16x32_bf16 v[208:211], a[164:167], a[72:75], v[208:211]
    ds_read_b64_tr_b16 a[130:131], v114 offset:34816
    v_mfma_f32_16x16x32_bf16 v[212:215], a[164:167], a[76:79], v[212:215]
    ds_read_b64_tr_b16 a[132:133], v114 offset:36864
    v_mfma_f32_16x16x32_bf16 v[212:215], a[160:163], a[68:71], v[212:215]
    ds_read_b64_tr_b16 a[134:135], v114 offset:38912
    v_mfma_f32_16x16x32_bf16 v[220:223], a[168:171], a[68:71], v[220:223]
    ds_read_b64_tr_b16 a[136:137], v115 offset:32768
    buffer_load_dwordx4 a[28:31], v16, s[32:35], s64 offen offset:3072 sc1
    v_mfma_f32_16x16x32_bf16 v[220:223], a[172:175], a[76:79], v[220:223]
    ds_read_b64_tr_b16 a[138:139], v115 offset:34816
    v_mfma_f32_16x16x32_bf16 v[216:219], a[172:175], a[72:75], v[216:219]
    ds_read_b64_tr_b16 a[140:141], v115 offset:36864
    s_add_u32 s64, s64, 4096
    v_mfma_f32_16x16x32_bf16 v[216:219], a[168:171], a[64:67], v[216:219]
    ds_read_b64_tr_b16 a[142:143], v115 offset:38912
    s_waitcnt lgkmcnt(8)
    v_mfma_f32_16x16x32_bf16 v[192:195], a[112:115], a[80:83], v[192:195]
    ds_read_b64_tr_b16 a[144:145], v112 offset:40960
    v_mfma_f32_16x16x32_bf16 v[192:195], a[116:119], a[88:91], v[192:195]
    ds_read_b64_tr_b16 a[146:147], v112 offset:43008
    v_mfma_f32_16x16x32_bf16 v[196:199], a[116:119], a[92:95], v[196:199]
    ds_read_b64_tr_b16 a[148:149], v112 offset:45056
    v_mfma_f32_16x16x32_bf16 v[196:199], a[112:115], a[84:87], v[196:199]
    ds_read_b64_tr_b16 a[150:151], v112 offset:47104
    v_mfma_f32_16x16x32_bf16 v[204:207], a[120:123], a[84:87], v[204:207]
    ds_read_b64_tr_b16 a[152:153], v113 offset:40960
    v_mfma_f32_16x16x32_bf16 v[204:207], a[124:127], a[92:95], v[204:207]
    ds_read_b64_tr_b16 a[154:155], v113 offset:43008
    v_mfma_f32_16x16x32_bf16 v[200:203], a[124:127], a[88:91], v[200:203]
    ds_read_b64_tr_b16 a[156:157], v113 offset:45056
    v_mfma_f32_16x16x32_bf16 v[200:203], a[120:123], a[80:83], v[200:203]
    ds_read_b64_tr_b16 a[158:159], v113 offset:47104
    s_waitcnt lgkmcnt(8)
    v_mfma_f32_16x16x32_bf16 v[208:211], a[128:131], a[80:83], v[208:211]
    ds_read_b64_tr_b16 a[160:161], v114 offset:40960
    v_mfma_f32_16x16x32_bf16 v[208:211], a[132:135], a[88:91], v[208:211]
    ds_read_b64_tr_b16 a[162:163], v114 offset:43008
    v_mfma_f32_16x16x32_bf16 v[212:215], a[132:135], a[92:95], v[212:215]
    ds_read_b64_tr_b16 a[164:165], v114 offset:45056
    v_mfma_f32_16x16x32_bf16 v[212:215], a[128:131], a[84:87], v[212:215]
    ds_read_b64_tr_b16 a[166:167], v114 offset:47104
    s_waitcnt vmcnt(7)
    s_mov_b32 s99, 0
L_ck3:
    v_xor_b32 v2, s92, v2
    v_xor_b32 v3, s93, v3
    v_or_b32 v2, v2, v3
    v_cmp_ne_u32 vcc, 0, v2
    s_cbranch_vccz L_ck3_ok
    buffer_load_dwordx2 v[2:3], v14, s[40:43], s69 offen sc0 sc1
    s_add_u32 s99, s99, 1
    s_cmp_lt_u32 s99, 0x200000
    s_waitcnt vmcnt(0)
    s_cbranch_scc1 L_ck3
L_ck3_ok:
    v_mfma_f32_16x16x32_bf16 v[220:223], a[136:139], a[84:87], v[220:223]
    ds_read_b64_tr_b16 a[168:169], v115 offset:40960
    v_mfma_f32_16x16x32_bf16 v[220:223], a[140:143], a[92:95], v[220:223]
    ds_read_b64_tr_b16 a[170:171], v115 offset:43008
    buffer_load_dwordx4 v[160:163], v16, s[40:43], s68 offen offset:0 sc1
    v_mfma_f32_16x16x32_bf16 v[216:219], a[140:143], a[88:91], v[216:219]
    ds_read_b64_tr_b16 a[172:173], v115 offset:45056
    v_mfma_f32_16x16x32_bf16 v[216:219], a[136:139], a[80:83], v[216:219]
    ds_read_b64_tr_b16 a[174:175], v115 offset:47104
    buffer_load_dwordx4 v[164:167], v16, s[40:43], s68 offen offset:1024 sc1
    s_waitcnt vmcnt(2) lgkmcnt(8)
    s_barrier
    v_mfma_f32_16x16x32_bf16 v[192:195], a[144:147], a[96:99], v[192:195]
    ds_read_b64_tr_b16 a[112:113], v112 offset:49152
    v_mfma_f32_16x16x32_bf16 v[192:195], a[148:151], a[104:107], v[192:195]
    ds_read_b64_tr_b16 a[114:115], v112 offset:51200
    buffer_load_dwordx4 v[168:171], v16, s[40:43], s68 offen offset:2048 sc1
    v_mfma_f32_16x16x32_bf16 v[196:199], a[148:151], a[108:111], v[196:199]
    ds_read_b64_tr_b16 a[116:117], v112 offset:53248
    v_mfma_f32_16x16x32_bf16 v[196:199], a[144:147], a[100:103], v[196:199]
    ds_read_b64_tr_b16 a[118:119], v112 offset:55296
    buffer_load_dwordx4 v[172:175], v16, s[40:43], s68 offen offset:3072 sc1
    v_mfma_f32_16x16x32_bf16 v[204:207], a[152:155], a[100:103], v[204:207]
    ds_read_b64_tr_b16 a[120:121], v113 offset:49152
    v_mfma_f32_16x16x32_bf16 v[204:207], a[156:159], a[108:111], v[204:207]
    ds_read_b64_tr_b16 a[122:123], v113 offset:51200
    v_mfma_f32_16x16x32_bf16 v[200:203], a[156:159], a[104:107], v[200:203]
    ds_read_b64_tr_b16 a[124:125], v113 offset:53248
    v_mfma_f32_16x16x32_bf16 v[200:203], a[152:155], a[96:99], v[200:203]
    ds_read_b64_tr_b16 a[126:127], v113 offset:55296
    s_waitcnt lgkmcnt(8)
    v_mfma_f32_16x16x32_bf16 v[208:211], a[160:163], a[96:99], v[208:211]
    ds_read_b64_tr_b16 a[128:129], v114 offset:49152
    v_mfma_f32_16x16x32_bf16 v[208:211], a[164:167], a[104:107], v[208:211]
    ds_read_b64_tr_b16 a[130:131], v114 offset:51200
    v_mfma_f32_16x16x32_bf16 v[212:215], a[164:167], a[108:111], v[212:215]
    ds_read_b64_tr_b16 a[132:133], v114 offset:53248
    v_mfma_f32_16x16x32_bf16 v[212:215], a[160:163], a[100:103], v[212:215]
    ds_read_b64_tr_b16 a[134:135], v114 offset:55296
    v_mfma_f32_16x16x32_bf16 v[220:223], a[168:171], a[100:103], v[220:223]
    ds_read_b64_tr_b16 a[136:137], v115 offset:49152
    v_mfma_f32_16x16x32_bf16 v[220:223], a[172:175], a[108:111], v[220:223]
    ds_read_b64_tr_b16 a[138:139], v115 offset:51200
    v_mfma_f32_16x16x32_bf16 v[216:219], a[172:175], a[104:107], v[216:219]
    ds_read_b64_tr_b16 a[140:141], v115 offset:53248
    v_mfma_f32_16x16x32_bf16 v[216:219], a[168:171], a[96:99], v[216:219]
    ds_read_b64_tr_b16 a[142:143], v115 offset:55296
    s_waitcnt lgkmcnt(8)
    v_mfma_f32_16x16x32_bf16 v[192:195], a[112:115], a[0:3], v[192:195]
    ds_read_b64_tr_b16 a[144:145], v112 offset:57344
    v_mfma_f32_16x16x32_bf16 v[192:195], a[116:119], a[8:11], v[192:195]
    ds_read_b64_tr_b16 a[146:147], v112 offset:59392
    v_mfma_f32_16x16x32_bf16 v[196:199], a[116:119], a[12:15], v[196:199]
    ds_read_b64_tr_b16 a[148:149], v112 offset:61440
    v_mfma_f32_16x16x32_bf16 v[196:199], a[112:115], a[4:7], v[196:199]
    ds_read_b64_tr_b16 a[150:151], v112 offset:63488
    v_mfma_f32_16x16x32_bf16 v[204:207], a[120:123], a[4:7], v[204:207]
    ds_read_b64_tr_b16 a[152:153], v113 offset:57344
    v_mfma_f32_16x16x32_bf16 v[204:207], a[124:127], a[12:15], v[204:207]
    ds_read_b64_tr_b16 a[154:155], v113 offset:59392
    v_mfma_f32_16x16x32_bf16 v[200:203], a[124:127], a[8:11], v[200:203]
    ds_read_b64_tr_b16 a[156:157], v113 offset:61440
    v_mfma_f32_16x16x32_bf16 v[200:203], a[120:123], a[0:3], v[200:203]
    ds_read_b64_tr_b16 a[158:159], v113 offset:63488
    s_waitcnt lgkmcnt(8)
    v_mfma_f32_16x16x32_bf16 v[208:211], a[128:131], a[0:3], v[208:211]
    ds_read_b64_tr_b16 a[160:161], v114 offset:57344
    v_mfma_f32_16x16x32_bf16 v[208:211], a[132:135], a[8:11], v[208:211]
    ds_read_b64_tr_b16 a[162:163], v114 offset:59392
    v_mfma_f32_16x16x32_bf16 v[212:215], a[132:135], a[12:15], v[212:215]
    ds_read_b64_tr_b16 a[164:165], v114 offset:61440
    v_mfma_f32_16x16x32_bf16 v[212:215], a[128:131], a[4:7], v[212:215]
    ds_read_b64_tr_b16 a[166:167], v114 offset:63488
    v_mfma_f32_16x16x32_bf16 v[220:223], a[136:139], a[4:7], v[220:223]
    ds_read_b64_tr_b16 a[168:169], v115 offset:57344
    v_mfma_f32_16x16x32_bf16 v[220:223], a[140:143], a[12:15], v[220:223]
    ds_read_b64_tr_b16 a[170:171], v115 offset:59392
    v_mfma_f32_16x16x32_bf16 v[216:219], a[140:143], a[8:11], v[216:219]
    ds_read_b64_tr_b16 a[172:173], v115 offset:61440
    v_mfma_f32_16x16x32_bf16 v[216:219], a[136:139], a[0:3], v[216:219]
    ds_read_b64_tr_b16 a[174:175], v115 offset:63488
    s_waitcnt lgkmcnt(8)
    v_mfma_f32_16x16x32_bf16 v[192:195], a[144:147], a[16:19], v[192:195]
    v_mfma_f32_16x16x32_bf16 v[192:195], a[148:151], a[24:27], v[192:195]
    v_mfma_f32_16x16x32_bf16 v[196:199], a[148:151], a[28:31], v[196:199]
    v_mfma_f32_16x16x32_bf16 v[196:199], a[144:147], a[20:23], v[196:199]
    v_mfma_f32_16x16x32_bf16 v[204:207], a[152:155], a[20:23], v[204:207]
    v_mfma_f32_16x16x32_bf16 v[204:207], a[156:159], a[28:31], v[204:207]
    v_mfma_f32_16x16x32_bf16 v[200:203], a[156:159], a[24:27], v[200:203]
    v_mfma_f32_16x16x32_bf16 v[200:203], a[152:155], a[16:19], v[200:203]
    s_waitcnt lgkmcnt(0)
    v_mfma_f32_16x16x32_bf16 v[208:211], a[160:163], a[16:19], v[208:211]
    v_mfma_f32_16x16x32_bf16 v[208:211], a[164:167], a[24:27], v[208:211]
    v_mfma_f32_16x16x32_bf16 v[212:215], a[164:167], a[28:31], v[212:215]
    v_mfma_f32_16x16x32_bf16 v[212:215], a[160:163], a[20:23], v[212:215]
    v_mfma_f32_16x16x32_bf16 v[220:223], a[168:171], a[20:23], v[220:223]
    v_mfma_f32_16x16x32_bf16 v[220:223], a[172:175], a[28:31], v[220:223]
    v_mfma_f32_16x16x32_bf16 v[216:219], a[172:175], a[24:27], v[216:219]
    v_mfma_f32_16x16x32_bf16 v[216:219], a[168:171], a[16:19], v[216:219]
    v_accvgpr_read_b32 v224, a200
    v_accvgpr_read_b32 v225, a201
    v_accvgpr_read_b32 v226, a202
    v_accvgpr_read_b32 v227, a203
    v_accvgpr_read_b32 v228, a204
    v_accvgpr_read_b32 v229, a205
    v_accvgpr_read_b32 v230, a206
    v_accvgpr_read_b32 v231, a207
    v_accvgpr_read_b32 v232, a208
    v_accvgpr_read_b32 v233, a209
    v_accvgpr_read_b32 v234, a210
    v_accvgpr_read_b32 v235, a211
    v_accvgpr_read_b32 v236, a212
    v_accvgpr_read_b32 v237, a213
    v_accvgpr_read_b32 v238, a214
    v_accvgpr_read_b32 v239, a215
    s_nop 0
    v_permlane16_swap_b32 v224, v226
    v_permlane16_swap_b32 v225, v227
    v_permlane16_swap_b32 v228, v230
    v_permlane16_swap_b32 v229, v231
    v_permlane16_swap_b32 v232, v234
    v_permlane16_swap_b32 v233, v235
    v_permlane16_swap_b32 v236, v238
    v_permlane16_swap_b32 v237, v239
    s_waitcnt vmcnt(0)
    v_lshlrev_b32 v240, 16, v160
    v_and_b32 v241, 0xffff0000, v160
    v_lshlrev_b32 v242, 16, v161
    v_and_b32 v243, 0xffff0000, v161
    v_pk_add_f32 v[128:129], v[128:129], v[240:241]
    v_pk_add_f32 v[130:131], v[130:131], v[242:243]
    v_pk_mul_f32 v[240:241], v[128:129], s[46:47]
    v_pk_mul_f32 v[242:243], v[130:131], s[46:47]
    v_exp_f32 v240, v240
    v_exp_f32 v241, v241
    v_exp_f32 v242, v242
    v_exp_f32 v243, v243
    v_lshlrev_b32 v244, 16, v224
    v_and_b32 v245, 0xffff0000, v224
    v_lshlrev_b32 v246, 16, v225
    v_and_b32 v247, 0xffff0000, v225
    v_pk_add_f32 v[240:241], v[240:241], 1.0 op_sel_hi:[1,0]
    v_pk_add_f32 v[242:243], v[242:243], 1.0 op_sel_hi:[1,0]
    v_rcp_f32 v240, v240
    v_rcp_f32 v241, v241
    v_rcp_f32 v242, v242
    v_rcp_f32 v243, v243
    v_pk_mul_f32 v[128:129], v[128:129], v[192:193]
    v_pk_mul_f32 v[130:131], v[130:131], v[194:195]
    v_pk_fma_f32 v[128:129], v[128:129], v[240:241], v[244:245]
    v_pk_fma_f32 v[130:131], v[130:131], v[242:243], v[246:247]
    v_cvt_pk_bf16_f32 v224, v128, v129
    v_cvt_pk_bf16_f32 v225, v130, v131
    v_lshlrev_b32 v240, 16, v164
    v_and_b32 v241, 0xffff0000, v164
    v_lshlrev_b32 v242, 16, v165
    v_and_b32 v243, 0xffff0000, v165
    v_pk_add_f32 v[136:137], v[136:137], v[240:241]
    v_pk_add_f32 v[138:139], v[138:139], v[242:243]
    v_pk_mul_f32 v[240:241], v[136:137], s[46:47]
    v_pk_mul_f32 v[242:243], v[138:139], s[46:47]
    v_exp_f32 v240, v240
    v_exp_f32 v241, v241
    v_exp_f32 v242, v242
    v_exp_f32 v243, v243
    v_lshlrev_b32 v244, 16, v226
    v_and_b32 v245, 0xffff0000, v226
    v_lshlrev_b32 v246, 16, v227
    v_and_b32 v247, 0xffff0000, v227
    v_pk_add_f32 v[240:241], v[240:241], 1.0 op_sel_hi:[1,0]
    v_pk_add_f32 v[242:243], v[242:243], 1.0 op_sel_hi:[1,0]
    v_rcp_f32 v240, v240
    v_rcp_f32 v241, v241
    v_rcp_f32 v242, v242
    v_rcp_f32 v243, v243
    v_pk_mul_f32 v[136:137], v[136:137], v[200:201]
    v_pk_mul_f32 v[138:139], v[138:139], v[202:203]
    v_pk_fma_f32 v[136:137], v[136:137], v[240:241], v[244:245]
    v_pk_fma_f32 v[138:139], v[138:139], v[242:243], v[246:247]
    v_cvt_pk_bf16_f32 v226, v136, v137
    v_cvt_pk_bf16_f32 v227, v138, v139
    s_nop 1
    v_permlane16_swap_b32 v224, v226
    v_permlane16_swap_b32 v225, v227
    buffer_store_dwordx4 v[224:227], v15, s[24:27], s96 offen offset:0
    v_lshlrev_b32 v240, 16, v168
    v_and_b32 v241, 0xffff0000, v168
    v_lshlrev_b32 v242, 16, v169
    v_and_b32 v243, 0xffff0000, v169
    v_pk_add_f32 v[144:145], v[144:145], v[240:241]
    v_pk_add_f32 v[146:147], v[146:147], v[242:243]
    v_pk_mul_f32 v[240:241], v[144:145], s[46:47]
    v_pk_mul_f32 v[242:243], v[146:147], s[46:47]
    v_exp_f32 v240, v240
    v_exp_f32 v241, v241
    v_exp_f32 v242, v242
    v_exp_f32 v243, v243
    v_lshlrev_b32 v244, 16, v228
    v_and_b32 v245, 0xffff0000, v228
    v_lshlrev_b32 v246, 16, v229
    v_and_b32 v247, 0xffff0000, v229
    v_pk_add_f32 v[240:241], v[240:241], 1.0 op_sel_hi:[1,0]
    v_pk_add_f32 v[242:243], v[242:243], 1.0 op_sel_hi:[1,0]
    v_rcp_f32 v240, v240
    v_rcp_f32 v241, v241
    v_rcp_f32 v242, v242
    v_rcp_f32 v243, v243
    v_pk_mul_f32 v[144:145], v[144:145], v[208:209]
    v_pk_mul_f32 v[146:147], v[146:147], v[210:211]
    v_pk_fma_f32 v[144:145], v[144:145], v[240:241], v[244:245]
    v_pk_fma_f32 v[146:147], v[146:147], v[242:243], v[246:247]
    v_cvt_pk_bf16_f32 v228, v144, v145
    v_cvt_pk_bf16_f32 v229, v146, v147
    v_lshlrev_b32 v240, 16, v172
    v_and_b32 v241, 0xffff0000, v172
    v_lshlrev_b32 v242, 16, v173
    v_and_b32 v243, 0xffff0000, v173
    v_pk_add_f32 v[152:153], v[152:153], v[240:241]
    v_pk_add_f32 v[154:155], v[154:155], v[242:243]
    v_pk_mul_f32 v[240:241], v[152:153], s[46:47]
    v_pk_mul_f32 v[242:243], v[154:155], s[46:47]
    v_exp_f32 v240, v240
    v_exp_f32 v241, v241
    v_exp_f32 v242, v242
    v_exp_f32 v243, v243
    v_lshlrev_b32 v244, 16, v230
    v_and_b32 v245, 0xffff0000, v230
    v_lshlrev_b32 v246, 16, v231
    v_and_b32 v247, 0xffff0000, v231
    v_pk_add_f32 v[240:241], v[240:241], 1.0 op_sel_hi:[1,0]
    v_pk_add_f32 v[242:243], v[242:243], 1.0 op_sel_hi:[1,0]
    v_rcp_f32 v240, v240
    v_rcp_f32 v241, v241
    v_rcp_f32 v242, v242
    v_rcp_f32 v243, v243
    v_pk_mul_f32 v[152:153], v[152:153], v[216:217]
    v_pk_mul_f32 v[154:155], v[154:155], v[218:219]
    v_pk_fma_f32 v[152:153], v[152:153], v[240:241], v[244:245]
    v_pk_fma_f32 v[154:155], v[154:155], v[242:243], v[246:247]
    v_cvt_pk_bf16_f32 v230, v152, v153
    v_cvt_pk_bf16_f32 v231, v154, v155
    s_nop 1
    v_permlane16_swap_b32 v228, v230
    v_permlane16_swap_b32 v229, v231
    buffer_store_dwordx4 v[228:231], v15, s[24:27], s96 offen offset:64
    v_lshlrev_b32 v240, 16, v162
    v_and_b32 v241, 0xffff0000, v162
    v_lshlrev_b32 v242, 16, v163
    v_and_b32 v243, 0xffff0000, v163
    v_pk_add_f32 v[132:133], v[132:133], v[240:241]
    v_pk_add_f32 v[134:135], v[134:135], v[242:243]
    v_pk_mul_f32 v[240:241], v[132:133], s[46:47]
    v_pk_mul_f32 v[242:243], v[134:135], s[46:47]
    v_exp_f32 v240, v240
    v_exp_f32 v241, v241
    v_exp_f32 v242, v242
    v_exp_f32 v243, v243
    v_lshlrev_b32 v244, 16, v232
    v_and_b32 v245, 0xffff0000, v232
    v_lshlrev_b32 v246, 16, v233
    v_and_b32 v247, 0xffff0000, v233
    v_pk_add_f32 v[240:241], v[240:241], 1.0 op_sel_hi:[1,0]
    v_pk_add_f32 v[242:243], v[242:243], 1.0 op_sel_hi:[1,0]
    v_rcp_f32 v240, v240
    v_rcp_f32 v241, v241
    v_rcp_f32 v242, v242
    v_rcp_f32 v243, v243
    v_pk_mul_f32 v[132:133], v[132:133], v[196:197]
    v_pk_mul_f32 v[134:135], v[134:135], v[198:199]
    v_pk_fma_f32 v[132:133], v[132:133], v[240:241], v[244:245]
    v_pk_fma_f32 v[134:135], v[134:135], v[242:243], v[246:247]
    v_cvt_pk_bf16_f32 v232, v132, v133
    v_cvt_pk_bf16_f32 v233, v134, v135
    v_lshlrev_b32 v240, 16, v166
    v_and_b32 v241, 0xffff0000, v166
    v_lshlrev_b32 v242, 16, v167
    v_and_b32 v243, 0xffff0000, v167
    v_pk_add_f32 v[140:141], v[140:141], v[240:241]
    v_pk_add_f32 v[142:143], v[142:143], v[242:243]
    v_pk_mul_f32 v[240:241], v[140:141], s[46:47]
    v_pk_mul_f32 v[242:243], v[142:143], s[46:47]
    v_exp_f32 v240, v240
    v_exp_f32 v241, v241
    v_exp_f32 v242, v242
    v_exp_f32 v243, v243
    v_lshlrev_b32 v244, 16, v234
    v_and_b32 v245, 0xffff0000, v234
    v_lshlrev_b32 v246, 16, v235
    v_and_b32 v247, 0xffff0000, v235
    v_pk_add_f32 v[240:241], v[240:241], 1.0 op_sel_hi:[1,0]
    v_pk_add_f32 v[242:243], v[242:243], 1.0 op_sel_hi:[1,0]
    v_rcp_f32 v240, v240
    v_rcp_f32 v241, v241
    v_rcp_f32 v242, v242
    v_rcp_f32 v243, v243
    v_pk_mul_f32 v[140:141], v[140:141], v[204:205]
    v_pk_mul_f32 v[142:143], v[142:143], v[206:207]
    v_pk_fma_f32 v[140:141], v[140:141], v[240:241], v[244:245]
    v_pk_fma_f32 v[142:143], v[142:143], v[242:243], v[246:247]
    v_cvt_pk_bf16_f32 v234, v140, v141
    v_cvt_pk_bf16_f32 v235, v142, v143
    s_nop 1
    v_permlane16_swap_b32 v232, v234
    v_permlane16_swap_b32 v233, v235
    buffer_store_dwordx4 v[232:235], v15, s[24:27], s97 offen offset:0
    v_lshlrev_b32 v240, 16, v170
    v_and_b32 v241, 0xffff0000, v170
    v_lshlrev_b32 v242, 16, v171
    v_and_b32 v243, 0xffff0000, v171
    v_pk_add_f32 v[148:149], v[148:149], v[240:241]
    v_pk_add_f32 v[150:151], v[150:151], v[242:243]
    v_pk_mul_f32 v[240:241], v[148:149], s[46:47]
    v_pk_mul_f32 v[242:243], v[150:151], s[46:47]
    v_exp_f32 v240, v240
    v_exp_f32 v241, v241
    v_exp_f32 v242, v242
    v_exp_f32 v243, v243
    v_lshlrev_b32 v244, 16, v236
    v_and_b32 v245, 0xffff0000, v236
    v_lshlrev_b32 v246, 16, v237
    v_and_b32 v247, 0xffff0000, v237
    v_pk_add_f32 v[240:241], v[240:241], 1.0 op_sel_hi:[1,0]
    v_pk_add_f32 v[242:243], v[242:243], 1.0 op_sel_hi:[1,0]
    v_rcp_f32 v240, v240
    v_rcp_f32 v241, v241
    v_rcp_f32 v242, v242
    v_rcp_f32 v243, v243
    v_pk_mul_f32 v[148:149], v[148:149], v[212:213]
    v_pk_mul_f32 v[150:151], v[150:151], v[214:215]
    v_pk_fma_f32 v[148:149], v[148:149], v[240:241], v[244:245]
    v_pk_fma_f32 v[150:151], v[150:151], v[242:243], v[246:247]
    v_cvt_pk_bf16_f32 v236, v148, v149
    v_cvt_pk_bf16_f32 v237, v150, v151
    v_lshlrev_b32 v240, 16, v174
    v_and_b32 v241, 0xffff0000, v174
    v_lshlrev_b32 v242, 16, v175
    v_and_b32 v243, 0xffff0000, v175
    v_pk_add_f32 v[156:157], v[156:157], v[240:241]
    v_pk_add_f32 v[158:159], v[158:159], v[242:243]
    v_pk_mul_f32 v[240:241], v[156:157], s[46:47]
    v_pk_mul_f32 v[242:243], v[158:159], s[46:47]
    v_exp_f32 v240, v240
    v_exp_f32 v241, v241
    v_exp_f32 v242, v242
    v_exp_f32 v243, v243
    v_lshlrev_b32 v244, 16, v238
    v_and_b32 v245, 0xffff0000, v238
    v_lshlrev_b32 v246, 16, v239
    v_and_b32 v247, 0xffff0000, v239
    v_pk_add_f32 v[240:241], v[240:241], 1.0 op_sel_hi:[1,0]
    v_pk_add_f32 v[242:243], v[242:243], 1.0 op_sel_hi:[1,0]
    v_rcp_f32 v240, v240
    v_rcp_f32 v241, v241
    v_rcp_f32 v242, v242
    v_rcp_f32 v243, v243
    v_pk_mul_f32 v[156:157], v[156:157], v[220:221]
    v_pk_mul_f32 v[158:159], v[158:159], v[222:223]
    v_pk_fma_f32 v[156:157], v[156:157], v[240:241], v[244:245]
    v_pk_fma_f32 v[158:159], v[158:159], v[242:243], v[246:247]
    v_cvt_pk_bf16_f32 v238, v156, v157
    v_cvt_pk_bf16_f32 v239, v158, v159
    s_nop 1
    v_permlane16_swap_b32 v236, v238
    v_permlane16_swap_b32 v237, v239
    buffer_store_dwordx4 v[236:239], v15, s[24:27], s97 offen offset:64
    s_add_u32 s76, s2, s3
    s_cmp_eq_u32 s76, 0
    s_cbranch_scc0 L_noep
    s_mov_b32 s76, 6029312
    v_mov_b32 v4, s92
    s_mov_b64 exec, 1
    buffer_store_dword v4, v16, s[40:43], s76 offen
    s_mov_b64 exec, -1
L_noep:
L_end:
    s_endpgm
L_codeend:
.section .rodata,"a"
.p2align 6
.amdhsa_kernel recurrent_scan__linear_attn_block__swiglu_ffn__prompt_kernel
  .amdhsa_next_free_vgpr 472
  .amdhsa_next_free_sgpr 102
  .amdhsa_accum_offset 256
  .amdhsa_group_segment_fixed_size 0
  .amdhsa_kernarg_size 80
  .amdhsa_user_sgpr_count 2
  .amdhsa_user_sgpr_kernarg_segment_ptr 1
  .amdhsa_system_sgpr_workgroup_id_x 1
  .amdhsa_float_denorm_mode_32 3
  .amdhsa_float_denorm_mode_16_64 3
.end_amdhsa_kernel
```
